```python
import torch

def _softmax(x, axis=-1):
    return torch.softmax(x, dim=axis)
def _gelu(x):
    return torch.nn.functional.gelu(x, approximate="tanh")
def _silu(x):
    return torch.nn.functional.silu(x)
def _sigmoid(x):
    return torch.sigmoid(x)
def _layernorm(x, axis=-1, eps=1e-5):
    m = x.mean(dim=axis, keepdim=True)
    v = x.var(dim=axis, keepdim=True, unbiased=False)
    return (x - m) / torch.sqrt(v + eps)
def _scatter_add(tgt, idx, src, axis=0):
    return tgt.clone().index_add_(axis, idx, src)
def _segment_sum(src, seg, n):
    out = torch.zeros((n,) + src.shape[1:], dtype=src.dtype)
    return out.index_add_(0, seg, src)
def _pad(x, pw):
    flat = tuple(v for pair in reversed(pw) for v in pair)
    return torch.nn.functional.pad(x, flat)

kernel_name = 'recurrent_scan__gqa_block_cached__glu_gated_glu__prompt'

def setup_inputs():

    _w = (lambda a: (lambda t: t.to(torch.bfloat16) if t.is_floating_point() else t)(torch.as_tensor(a)))
    def _A_setup():
        B, Sq, D = 1, 2048, 512
        Hq, Hkv, Sk, Dh = 32, 32, 2048, 128
        assert Hq % Hkv == 0, (Hq, Hkv)
        return {
            "x": _w((lambda *s: torch.randn(*s, dtype=torch.bfloat16) * 0.05)(B, Sq, D)),
            "k_cache": _w((lambda *s: torch.randn(*s, dtype=torch.bfloat16) * 1.6)(B, Hkv, Sk, Dh)),
            "v_cache": _w((lambda *s: torch.randn(*s, dtype=torch.bfloat16) * 0.2)(B, Hkv, Sk, Dh)),
            "wq": _w((lambda *s: torch.randn(*s, dtype=torch.bfloat16) * 1.6)(D, Hq * Dh) * (D ** -0.5)),
            "wo": _w((lambda *s: torch.randn(*s, dtype=torch.bfloat16) * 0.2)(Hq * Dh, D) * ((Hq * Dh) ** -0.5)),
        }
    _A_in = _A_setup()

    def _B_setup():
        B, S, D, F = 1, 2048, 512, 1376
        return {
            "x": _w((lambda *s: torch.randn(*s, dtype=torch.bfloat16) * 0.05)(B, S, D)),
            "w_gate": _w((lambda *s: torch.randn(*s, dtype=torch.bfloat16) * 0.2)(D, F)),
            "w_up": _w((lambda *s: torch.randn(*s, dtype=torch.bfloat16) * 0.1)(D, F)),
            "w_down": _w((lambda *s: torch.randn(*s, dtype=torch.bfloat16) * 0.1)(F, D)),
        }
    _B_in = _B_setup()

    return {
        "A_x": _A_in["x"],
        "A_k_cache": _A_in["k_cache"],
        "A_v_cache": _A_in["v_cache"],
        "A_wq": _A_in["wq"],
        "A_wo": _A_in["wo"],
        "B_x": _B_in["x"],
        "B_w_gate": _B_in["w_gate"],
        "B_w_up": _B_in["w_up"],
        "B_w_down": _B_in["w_down"],
    }

def reference(A_x, A_k_cache, A_v_cache, A_wq, A_wo, B_x, B_w_gate, B_w_up, B_w_down):
    def _A_ref(x, k_cache, v_cache, wq, wo):
        B, Sq, D = x.shape
        Hq, Dh = 32, 128
        Hkv = k_cache.shape[1]
        rep = Hq // Hkv
        q = (lambda x, *d: x.permute(*d))((x @ wq).reshape(B, Sq, Hq, Dh), 0, 2, 1, 3)
        k = (lambda x, n, axis: torch.repeat_interleave(x, n, dim=axis))(k_cache, rep, axis=1)
        v = (lambda x, n, axis: torch.repeat_interleave(x, n, dim=axis))(v_cache, rep, axis=1)
        scores = torch.einsum("bhqd,bhkd->bhqk", q, k) * (Dh ** -0.5)
        p = _softmax(scores, axis=-1)
        o = torch.einsum("bhqk,bhkd->bhqd", p, v)
        return (lambda x, *d: x.permute(*d))(o, 0, 2, 1, 3).reshape(B, Sq, Hq * Dh) @ wo

    def _B_ref(x, w_gate, w_up, w_down):
        g = torch.einsum("bsd,df->bsf", x, w_gate)
        u = torch.einsum("bsd,df->bsf", x, w_up)
        h = _sigmoid(g) * u
        return torch.einsum("bsf,fd->bsd", h, w_down)

    x = A_x
    xn = _layernorm(x, axis=-1)
    s = _A_ref(xn, A_k_cache, A_v_cache, A_wq, A_wo)
    g = _silu(_B_ref(xn, B_w_gate, B_w_up, B_w_down))
    return x + s * g
```

```asm
; @launch grid=(256,1,1) block=(256,1,1) lds=163840
.amdgcn_target "amdgcn-amd-amdhsa--gfx950"
.text
.globl recurrent_scan__gqa_block_cached__glu_gated_glu__prompt_kernel
.p2align 8
.type recurrent_scan__gqa_block_cached__glu_gated_glu__prompt_kernel,@function
recurrent_scan__gqa_block_cached__glu_gated_glu__prompt_kernel:
    s_cmp_ge_u32 s2, 256
    s_cbranch_scc1 L_end
    s_load_dwordx2 s[32:33], s[0:1], 0
    s_getpc_b64 s[88:89]
L_pc0:
    s_lshr_b32 s49, s2, 3
    s_lshl_b32 s49, s49, 11
    v_lshrrev_b32 v2, 4, v0
    v_lshl_add_u32 v2, v2, 7, s49
    v_min_u32 v2, L_codeend-L_pc0-4, v2
    v_add_co_u32 v2, vcc, s88, v2
    v_mov_b32 v3, s89
    s_nop 0
    v_addc_co_u32 v3, vcc, 0, v3, vcc
    global_load_dword v23, v[2:3], off
    v_lshrrev_b32 v50, 5, v0
    v_bfe_u32 v52, v0, 2, 3
    v_and_b32 v53, 3, v0
    v_lshlrev_b32 v54, 10, v50
    v_lshl_add_u32 v54, v52, 6, v54
    v_lshl_add_u32 v54, v53, 3, v54
    s_lshl_b32 s49, s2, 13
    s_mov_b32 s34, 2097152
    s_mov_b32 s35, 0x20000
    s_mov_b32 s48, 0
    s_waitcnt lgkmcnt(0)
    buffer_load_dwordx2 v[64:65], v54, s[32:35], s49 offen offset:0
    buffer_load_dwordx2 v[66:67], v54, s[32:35], s49 offen offset:32
    buffer_load_dwordx2 v[68:69], v54, s[32:35], s49 offen offset:512
    buffer_load_dwordx2 v[70:71], v54, s[32:35], s49 offen offset:544
L_start:
    s_load_dwordx2 s[92:93], s[0:1], 80
    s_load_dwordx2 s[4:5], s[0:1], 88
    s_load_dwordx2 s[16:17], s[0:1], 24
    s_load_dwordx4 s[20:23], s[0:1], 48
    s_load_dwordx4 s[8:11], s[0:1], 8
    s_memrealtime s[6:7]
    s_load_dwordx2 s[56:57], s[0:1], 0
    s_load_dwordx2 s[58:59], s[0:1], 32
    s_load_dwordx4 s[60:63], s[0:1], 64
    v_lshrrev_b32 v1, 6, v0
    v_and_b32 v0, 63, v0
    v_readfirstlane_b32 s36, v1
    s_and_b32 s37, s2, 7
    s_lshl_b32 s37, s37, 2
    s_bfe_u32 s49, s2, 0x20003
    s_add_u32 s37, s37, s49
    s_lshr_b32 s38, s2, 5
    s_and_b32 s54, s49, 2
    s_lshl_b32 s54, s54, 1
    s_mov_b32 s55, s54
    s_mov_b32 s3, s54
    v_and_b32 v51, 31, v0
    v_and_b32 v55, 1, v0
    v_lshlrev_b32 v55, 2, v55
    s_lshl_b32 s50, s38, 5
    s_and_b32 s47, s2, 31
    s_waitcnt lgkmcnt(0)
    s_movk_i32 s94, 256
    s_mov_b32 s95, 0x20000
    s_cmp_lg_u32 s48, 0
    s_cbranch_scc1 L_nox
    s_cmp_lt_u32 s36, 2
    s_cbranch_scc1 L_nox
    s_xor_b32 s51, s36, 2
    s_or_b32 s51, s51, s37
    s_lshl_b32 s51, s51, 8
    s_add_u32 s51, s51, s50
    v_mov_b32 v56, s6
    v_mov_b32 v57, s7
    v_or_b32 v56, 1, v56
    v_or_b32 v57, 0x40000000, v57
    v_mov_b32 v58, 0
    s_mov_b64 exec, 1
    buffer_store_dwordx2 v[56:57], v58, s[92:95], s51 offen sc1
    s_mov_b64 exec, -1
    s_lshl_b32 s51, s38, 1
    s_add_u32 s51, s51, s36
    s_sub_u32 s51, s51, 2
    s_mul_i32 s51, s51, 12
    s_lshl_b32 s52, s54, 6
    s_add_u32 s51, s51, s52
    v_lshrrev_b32 v56, 1, v0
    v_min_u32 v56, 11, v56
    v_add_u32 v56, s51, v56
    v_and_b32 v56, 511, v56
    v_lshlrev_b32 v57, 13, v56
    v_lshl_add_u32 v57, v55, 5, v57
    s_mov_b32 s18, 4194304
    s_mov_b32 s19, 0x20000
    s_lshl_b32 s52, s37, 8
    buffer_load_dword v23, v57, s[16:19], s52 offen
    v_mul_u32_u24 v57, 2752, v56
    v_mad_u32_u24 v57, v55, 23, v57
    s_mul_i32 s52, s37, 96
    s_mov_b32 s32, s20
    s_mov_b32 s33, s21
    s_mov_b32 s34, 1409024
    buffer_load_dword v23, v57, s[32:35], s52 offen
    s_mov_b32 s32, s22
    s_mov_b32 s33, s23
    buffer_load_dword v23, v57, s[32:35], s52 offen
L_nox:
    s_lshl_b32 s39, s36, 12
    v_and_b32 v40, 15, v0
    v_lshrrev_b32 v41, 4, v0
    v_lshrrev_b32 v42, 2, v0
    v_and_b32 v43, 3, v0
    s_lshl_b32 s49, s36, 4
    v_add_u32 v44, s49, v41
    v_lshlrev_b32 v45, 1, v41
    v_xor_b32 v45, v45, v40
    v_lshlrev_b32 v45, 4, v45
    v_xor_b32 v46, 128, v45
    v_lshl_add_u32 v10, v44, 13, v45
    v_lshl_add_u32 v11, v44, 13, v46
    v_add_u32 v11, 31744, v11
    v_add_u32 v12, 63488, v10
    v_add_u32 v13, 63488, v11
    v_lshl_add_u32 v5, v44, 8, v45
    v_lshl_add_u32 v6, v44, 8, v46
    v_lshlrev_b32 v9, 4, v0
    s_and_b32 s49, s36, 1
    s_mul_i32 s49, s49, 192
    s_mul_i32 s50, s37, 96
    s_mov_b32 s51, 10923
    s_movk_i32 s52, 2752
    v_add_u32 v45, s49, v0
    v_mul_u32_u24 v46, s51, v45
    v_lshrrev_b32 v46, 16, v46
    v_mul_u32_u24 v47, 6, v46
    v_sub_u32 v47, v45, v47
    v_lshl_add_u32 v47, v47, 4, s50
    v_mad_u32_u24 v48, v46, s52, v47
    v_cmp_gt_u32 vcc, s52, v47
    v_mov_b32 v49, 0x40000000
    s_nop 0
    v_cndmask_b32 v14, v49, v48, vcc
    v_add_u32 v45, s49, v0
    v_add_u32 v45, 64, v45
    v_mul_u32_u24 v46, s51, v45
    v_lshrrev_b32 v46, 16, v46
    v_mul_u32_u24 v47, 6, v46
    v_sub_u32 v47, v45, v47
    v_lshl_add_u32 v47, v47, 4, s50
    v_mad_u32_u24 v48, v46, s52, v47
    v_subrev_u32 v48, 1024, v48
    v_cmp_gt_u32 vcc, s52, v47
    v_mov_b32 v49, 0x40000000
    s_nop 0
    v_cndmask_b32 v15, v49, v48, vcc
    v_add_u32 v45, s49, v0
    v_add_u32 v45, 128, v45
    v_mul_u32_u24 v46, s51, v45
    v_lshrrev_b32 v46, 16, v46
    v_mul_u32_u24 v47, 6, v46
    v_sub_u32 v47, v45, v47
    v_lshl_add_u32 v47, v47, 4, s50
    v_mad_u32_u24 v48, v46, s52, v47
    v_subrev_u32 v48, 2048, v48
    v_cmp_gt_u32 vcc, s52, v47
    v_mov_b32 v49, 0x40000000
    s_nop 0
    v_cndmask_b32 v16, v49, v48, vcc
    s_and_b32 s40, s36, 1
    s_mul_i32 s40, s40, 3072
    s_lshr_b32 s49, s36, 1
    s_mul_i32 s49, s49, 6144
    s_add_u32 s40, s40, s49
    s_add_u32 s40, s40, 65536
    s_lshl_b32 s53, s38, 4
    s_lshl_b32 s50, s36, 2
    s_add_u32 s53, s53, s50
    s_lshl_b32 s49, s37, 8
    s_add_u32 s16, s16, s49
    s_addc_u32 s17, s17, 0
    s_sub_u32 s18, 4194304, s49
    s_mov_b32 s19, 0x20000
    s_cmp_ge_u32 s36, 2
    s_cselect_b32 s20, s22, s20
    s_cselect_b32 s21, s23, s21
    s_mov_b32 s22, 1409024
    s_mov_b32 s23, 0x20000
    s_lshl_b32 s50, s53, 14
    s_add_u32 s24, s4, s50
    s_addc_u32 s25, s5, 0
    s_mov_b32 s26, 65536
    s_mov_b32 s27, 0x20000
    s_add_u32 s28, s4, 25165824
    s_addc_u32 s29, s5, 0
    s_mov_b32 s30, 327680
    s_mov_b32 s31, 0x20000
    s_cmp_lg_u32 s48, 0
    s_cbranch_scc1 L_noln
    s_lshl_b32 s50, s38, 5
    s_cmp_lt_u32 s36, 2
    s_cbranch_scc1 L_w0
    s_waitcnt vmcnt(4)
    s_branch L_w1
L_w0:
    s_waitcnt vmcnt(0)
L_w1:
    v_lshlrev_b32 v80, 16, v64
    v_and_b32 v81, 0xffff0000, v64
    v_lshlrev_b32 v82, 16, v65
    v_and_b32 v83, 0xffff0000, v65
    v_lshlrev_b32 v84, 16, v66
    v_and_b32 v85, 0xffff0000, v66
    v_lshlrev_b32 v86, 16, v67
    v_and_b32 v87, 0xffff0000, v67
    v_lshlrev_b32 v88, 16, v68
    v_and_b32 v89, 0xffff0000, v68
    v_lshlrev_b32 v90, 16, v69
    v_and_b32 v91, 0xffff0000, v69
    v_lshlrev_b32 v92, 16, v70
    v_and_b32 v93, 0xffff0000, v70
    v_lshlrev_b32 v94, 16, v71
    v_and_b32 v95, 0xffff0000, v71
    v_pk_add_f32 v[100:101], v[80:81], v[82:83]
    v_pk_add_f32 v[102:103], v[84:85], v[86:87]
    v_pk_add_f32 v[104:105], v[88:89], v[90:91]
    v_pk_add_f32 v[106:107], v[92:93], v[94:95]
    v_pk_add_f32 v[100:101], v[100:101], v[102:103]
    v_pk_add_f32 v[104:105], v[104:105], v[106:107]
    v_pk_add_f32 v[72:73], v[100:101], v[104:105]
    v_add_f32 v72, v72, v73
    s_nop 1
    v_add_f32_dpp v72, v72, v72 row_ror:8 row_mask:0xf bank_mask:0xf
    s_nop 1
    v_add_f32_dpp v72, v72, v72 row_ror:4 row_mask:0xf bank_mask:0xf
    s_nop 1
    v_add_f32_dpp v72, v72, v72 row_ror:2 row_mask:0xf bank_mask:0xf
    s_nop 1
    v_add_f32_dpp v72, v72, v72 row_ror:1 row_mask:0xf bank_mask:0xf
    v_mov_b32 v73, v72
    s_nop 1
    v_permlane16_swap_b32 v72, v73
    s_nop 1
    v_add_f32 v72, v72, v73
    v_mul_f32 v72, 0x3b000000, v72
    v_pk_add_f32 v[100:101], v[80:81], v[72:73] op_sel_hi:[1,0] neg_lo:[0,1] neg_hi:[0,1]
    v_pk_add_f32 v[102:103], v[82:83], v[72:73] op_sel_hi:[1,0] neg_lo:[0,1] neg_hi:[0,1]
    v_pk_add_f32 v[104:105], v[84:85], v[72:73] op_sel_hi:[1,0] neg_lo:[0,1] neg_hi:[0,1]
    v_pk_add_f32 v[106:107], v[86:87], v[72:73] op_sel_hi:[1,0] neg_lo:[0,1] neg_hi:[0,1]
    v_pk_add_f32 v[108:109], v[88:89], v[72:73] op_sel_hi:[1,0] neg_lo:[0,1] neg_hi:[0,1]
    v_pk_add_f32 v[110:111], v[90:91], v[72:73] op_sel_hi:[1,0] neg_lo:[0,1] neg_hi:[0,1]
    v_pk_add_f32 v[112:113], v[92:93], v[72:73] op_sel_hi:[1,0] neg_lo:[0,1] neg_hi:[0,1]
    v_pk_add_f32 v[114:115], v[94:95], v[72:73] op_sel_hi:[1,0] neg_lo:[0,1] neg_hi:[0,1]
    v_pk_mul_f32 v[74:75], v[100:101], v[100:101]
    v_pk_mul_f32 v[76:77], v[102:103], v[102:103]
    v_pk_fma_f32 v[74:75], v[104:105], v[104:105], v[74:75]
    v_pk_fma_f32 v[76:77], v[106:107], v[106:107], v[76:77]
    v_pk_fma_f32 v[74:75], v[108:109], v[108:109], v[74:75]
    v_pk_fma_f32 v[76:77], v[110:111], v[110:111], v[76:77]
    v_pk_fma_f32 v[74:75], v[112:113], v[112:113], v[74:75]
    v_pk_fma_f32 v[76:77], v[114:115], v[114:115], v[76:77]
    v_pk_add_f32 v[74:75], v[74:75], v[76:77]
    v_add_f32 v74, v74, v75
    s_nop 1
    v_add_f32_dpp v74, v74, v74 row_ror:8 row_mask:0xf bank_mask:0xf
    s_nop 1
    v_add_f32_dpp v74, v74, v74 row_ror:4 row_mask:0xf bank_mask:0xf
    s_nop 1
    v_add_f32_dpp v74, v74, v74 row_ror:2 row_mask:0xf bank_mask:0xf
    s_nop 1
    v_add_f32_dpp v74, v74, v74 row_ror:1 row_mask:0xf bank_mask:0xf
    v_mov_b32 v75, v74
    s_nop 1
    v_permlane16_swap_b32 v74, v75
    s_nop 1
    v_add_f32 v74, v74, v75
    v_mul_f32 v74, 0x3b000000, v74
    v_cvt_pk_bf16_f32 v73, v72, v74
    v_lshlrev_b32 v72, 16, v73
    v_and_b32 v74, 0xffff0000, v73
    v_add_f32 v74, 0x3727c5ac, v74
    v_cvt_pk_bf16_f32 v74, v74, v74
    v_and_b32 v74, 0xffff0000, v74
    v_sqrt_f32 v74, v74
    v_pk_add_f32 v[80:81], v[80:81], v[72:73] op_sel_hi:[1,0] neg_lo:[0,1] neg_hi:[0,1]
    v_pk_add_f32 v[82:83], v[82:83], v[72:73] op_sel_hi:[1,0] neg_lo:[0,1] neg_hi:[0,1]
    v_pk_add_f32 v[84:85], v[84:85], v[72:73] op_sel_hi:[1,0] neg_lo:[0,1] neg_hi:[0,1]
    v_pk_add_f32 v[86:87], v[86:87], v[72:73] op_sel_hi:[1,0] neg_lo:[0,1] neg_hi:[0,1]
    v_pk_add_f32 v[88:89], v[88:89], v[72:73] op_sel_hi:[1,0] neg_lo:[0,1] neg_hi:[0,1]
    v_pk_add_f32 v[90:91], v[90:91], v[72:73] op_sel_hi:[1,0] neg_lo:[0,1] neg_hi:[0,1]
    v_pk_add_f32 v[92:93], v[92:93], v[72:73] op_sel_hi:[1,0] neg_lo:[0,1] neg_hi:[0,1]
    v_pk_add_f32 v[94:95], v[94:95], v[72:73] op_sel_hi:[1,0] neg_lo:[0,1] neg_hi:[0,1]
    v_cvt_pk_bf16_f32 v74, v74, v74
    v_and_b32 v74, 0xffff0000, v74
    v_rcp_f32 v76, v74
    v_cvt_pk_bf16_f32 v64, v80, v81
    v_cvt_pk_bf16_f32 v65, v82, v83
    v_cvt_pk_bf16_f32 v66, v84, v85
    v_cvt_pk_bf16_f32 v67, v86, v87
    v_cvt_pk_bf16_f32 v68, v88, v89
    v_cvt_pk_bf16_f32 v69, v90, v91
    v_cvt_pk_bf16_f32 v70, v92, v93
    v_cvt_pk_bf16_f32 v71, v94, v95
    v_lshlrev_b32 v80, 16, v64
    v_and_b32 v81, 0xffff0000, v64
    v_lshlrev_b32 v82, 16, v65
    v_and_b32 v83, 0xffff0000, v65
    v_lshlrev_b32 v84, 16, v66
    v_and_b32 v85, 0xffff0000, v66
    v_lshlrev_b32 v86, 16, v67
    v_and_b32 v87, 0xffff0000, v67
    v_lshlrev_b32 v88, 16, v68
    v_and_b32 v89, 0xffff0000, v68
    v_lshlrev_b32 v90, 16, v69
    v_and_b32 v91, 0xffff0000, v69
    v_lshlrev_b32 v92, 16, v70
    v_and_b32 v93, 0xffff0000, v70
    v_lshlrev_b32 v94, 16, v71
    v_and_b32 v95, 0xffff0000, v71
    v_pk_mul_f32 v[100:101], v[80:81], v[76:77] op_sel_hi:[1,0]
    v_pk_mul_f32 v[102:103], v[82:83], v[76:77] op_sel_hi:[1,0]
    v_pk_mul_f32 v[104:105], v[84:85], v[76:77] op_sel_hi:[1,0]
    v_pk_mul_f32 v[106:107], v[86:87], v[76:77] op_sel_hi:[1,0]
    v_pk_mul_f32 v[108:109], v[88:89], v[76:77] op_sel_hi:[1,0]
    v_pk_mul_f32 v[110:111], v[90:91], v[76:77] op_sel_hi:[1,0]
    v_pk_mul_f32 v[112:113], v[92:93], v[76:77] op_sel_hi:[1,0]
    v_pk_mul_f32 v[114:115], v[94:95], v[76:77] op_sel_hi:[1,0]
    v_pk_fma_f32 v[80:81], v[100:101], v[74:75], v[80:81] op_sel_hi:[1,0,1] neg_lo:[1,0,0] neg_hi:[1,0,0]
    v_pk_fma_f32 v[82:83], v[102:103], v[74:75], v[82:83] op_sel_hi:[1,0,1] neg_lo:[1,0,0] neg_hi:[1,0,0]
    v_pk_fma_f32 v[84:85], v[104:105], v[74:75], v[84:85] op_sel_hi:[1,0,1] neg_lo:[1,0,0] neg_hi:[1,0,0]
    v_pk_fma_f32 v[86:87], v[106:107], v[74:75], v[86:87] op_sel_hi:[1,0,1] neg_lo:[1,0,0] neg_hi:[1,0,0]
    v_pk_fma_f32 v[88:89], v[108:109], v[74:75], v[88:89] op_sel_hi:[1,0,1] neg_lo:[1,0,0] neg_hi:[1,0,0]
    v_pk_fma_f32 v[90:91], v[110:111], v[74:75], v[90:91] op_sel_hi:[1,0,1] neg_lo:[1,0,0] neg_hi:[1,0,0]
    v_pk_fma_f32 v[92:93], v[112:113], v[74:75], v[92:93] op_sel_hi:[1,0,1] neg_lo:[1,0,0] neg_hi:[1,0,0]
    v_pk_fma_f32 v[94:95], v[114:115], v[74:75], v[94:95] op_sel_hi:[1,0,1] neg_lo:[1,0,0] neg_hi:[1,0,0]
    v_pk_fma_f32 v[100:101], v[80:81], v[76:77], v[100:101] op_sel_hi:[1,0,1]
    v_pk_fma_f32 v[102:103], v[82:83], v[76:77], v[102:103] op_sel_hi:[1,0,1]
    v_pk_fma_f32 v[104:105], v[84:85], v[76:77], v[104:105] op_sel_hi:[1,0,1]
    v_pk_fma_f32 v[106:107], v[86:87], v[76:77], v[106:107] op_sel_hi:[1,0,1]
    v_pk_fma_f32 v[108:109], v[88:89], v[76:77], v[108:109] op_sel_hi:[1,0,1]
    v_pk_fma_f32 v[110:111], v[90:91], v[76:77], v[110:111] op_sel_hi:[1,0,1]
    v_pk_fma_f32 v[112:113], v[92:93], v[76:77], v[112:113] op_sel_hi:[1,0,1]
    v_pk_fma_f32 v[114:115], v[94:95], v[76:77], v[114:115] op_sel_hi:[1,0,1]
    v_cvt_pk_bf16_f32 v64, v100, v101
    v_cvt_pk_bf16_f32 v65, v102, v103
    v_cvt_pk_bf16_f32 v66, v104, v105
    v_cvt_pk_bf16_f32 v67, v106, v107
    v_cvt_pk_bf16_f32 v68, v108, v109
    v_cvt_pk_bf16_f32 v69, v110, v111
    v_cvt_pk_bf16_f32 v70, v112, v113
    v_cvt_pk_bf16_f32 v71, v114, v115
    v_lshlrev_b32 v51, 7, v51
    v_lshl_add_u32 v51, v50, 4, v51
    v_add_u32 v51, 131072, v51
    ds_write_b128 v51, v[64:67]
    ds_write_b128 v51, v[68:71] offset:4096
    v_add_u32 v53, s39, v9
    v_add_u32 v53, 131072, v53
    s_waitcnt lgkmcnt(0)
    s_barrier
    s_cmp_ge_u32 s36, 2
    s_cbranch_scc1 L_nost
    ds_read_b128 v[64:67], v53 offset:0
    ds_read_b128 v[68:71], v53 offset:1024
    ds_read_b128 v[72:75], v53 offset:2048
    ds_read_b128 v[76:79], v53 offset:3072
    s_mov_b32 s32, s4
    s_mov_b32 s33, s5
    s_mov_b32 s34, 2097152
    s_lshl_b32 s49, s38, 4
    s_lshr_b32 s50, s47, 1
    s_add_u32 s49, s49, s50
    s_lshl_b32 s49, s49, 1
    s_add_u32 s49, s49, s36
    s_lshl_b32 s49, s49, 13
    s_and_b32 s50, s47, 1
    s_lshl_b32 s50, s50, 7
    s_add_u32 s49, s49, s50
    s_add_u32 s50, s49, 4096
    v_lshrrev_b32 v56, 3, v0
    v_and_b32 v57, 7, v0
    v_lshlrev_b32 v56, 8, v56
    v_lshl_add_u32 v56, v57, 4, v56
    s_waitcnt lgkmcnt(3)
    buffer_store_dwordx4 v[64:67], v56, s[32:35], s49 offen offset:0 sc1
    s_waitcnt lgkmcnt(2)
    buffer_store_dwordx4 v[68:71], v56, s[32:35], s49 offen offset:2048 sc1
    s_waitcnt lgkmcnt(1)
    buffer_store_dwordx4 v[72:75], v56, s[32:35], s50 offen offset:0 sc1
    s_waitcnt lgkmcnt(0)
    buffer_store_dwordx4 v[76:79], v56, s[32:35], s50 offen offset:2048 sc1
    s_lshl_b32 s49, s38, 2
    s_lshr_b32 s50, s47, 3
    s_add_u32 s49, s49, s50
    s_lshl_b32 s49, s49, 10
    s_and_b32 s50, s47, 7
    s_lshl_b32 s50, s50, 1
    s_add_u32 s50, s50, s36
    s_lshl_b32 s50, s50, 3
    s_add_u32 s49, s49, s50
    s_add_u32 s49, s49, 24576
L_nost:
    s_mov_b32 s51, 262144
    s_lshl_b32 s47, s38, 5
    s_load_dwordx2 s[86:87], s[92:93], s47
    s_waitcnt lgkmcnt(0)
L_tagwa:
    s_min_u32 s52, s86, s87
    s_cmp_lg_u32 s52, 0
    s_cbranch_scc1 L_tagxa
    s_sub_u32 s51, s51, 1
    s_cbranch_scc1 L_tagxa
    buffer_load_dword v59, v55, s[92:95], s47 offen sc1
    s_waitcnt vmcnt(0)
    v_readlane_b32 s86, v59, 0
    v_readlane_b32 s87, v59, 1
    s_nop 3
    s_branch L_tagwa
L_tagxa:
    s_xor_b32 s87, s87, s86
    s_cmp_ge_u32 s36, 2
    s_cbranch_scc1 L_noln
    v_bfe_i32 v61, v0, 0, 1
    v_and_b32 v61, s87, v61
    v_xor_b32 v61, s86, v61
    v_lshrrev_b32 v56, 1, v0
    v_lshl_add_u32 v56, v56, 7, v55
    s_mov_b64 exec, 0xffff
    s_waitcnt vmcnt(0)
    buffer_store_dword v61, v56, s[28:31], s49 offen sc1
    s_mov_b64 exec, -1
L_noln:
    s_add_u32 m0, s39, 0
    s_lshl_b32 s49, s54, 19
    buffer_load_dwordx4 v10, s[16:19], s49 offen offset:0 lds
    buffer_load_dwordx4 v11, s[16:19], s49 offen offset:1024 lds
    buffer_load_dwordx4 v12, s[16:19], s49 offen offset:2048 lds
    buffer_load_dwordx4 v13, s[16:19], s49 offen offset:3072 lds
    s_add_u32 s54, s54, 1
    s_and_b32 s54, s54, 7
    s_add_u32 m0, s40, 0
    s_mul_i32 s49, s3, 176128
    buffer_load_dwordx4 v14, s[20:23], s49 offen offset:0 lds
    buffer_load_dwordx4 v15, s[20:23], s49 offen offset:1024 lds
    buffer_load_dwordx4 v16, s[20:23], s49 offen offset:2048 lds
    s_add_u32 s3, s3, 1
    s_and_b32 s3, s3, 7
    s_add_u32 m0, s39, 16384
    s_lshl_b32 s49, s54, 19
    buffer_load_dwordx4 v10, s[16:19], s49 offen offset:0 lds
    buffer_load_dwordx4 v11, s[16:19], s49 offen offset:1024 lds
    buffer_load_dwordx4 v12, s[16:19], s49 offen offset:2048 lds
    buffer_load_dwordx4 v13, s[16:19], s49 offen offset:3072 lds
    s_add_u32 s54, s54, 1
    s_and_b32 s54, s54, 7
    s_add_u32 m0, s40, 16384
    s_mul_i32 s49, s3, 176128
    buffer_load_dwordx4 v14, s[20:23], s49 offen offset:0 lds
    buffer_load_dwordx4 v15, s[20:23], s49 offen offset:1024 lds
    buffer_load_dwordx4 v16, s[20:23], s49 offen offset:2048 lds
    s_add_u32 s3, s3, 1
    s_and_b32 s3, s3, 7
    s_add_u32 m0, s39, 32768
    s_lshl_b32 s49, s54, 19
    buffer_load_dwordx4 v10, s[16:19], s49 offen offset:0 lds
    buffer_load_dwordx4 v11, s[16:19], s49 offen offset:1024 lds
    buffer_load_dwordx4 v12, s[16:19], s49 offen offset:2048 lds
    buffer_load_dwordx4 v13, s[16:19], s49 offen offset:3072 lds
    s_add_u32 s54, s54, 1
    s_and_b32 s54, s54, 7
    s_add_u32 m0, s40, 32768
    s_mul_i32 s49, s3, 176128
    buffer_load_dwordx4 v14, s[20:23], s49 offen offset:0 lds
    buffer_load_dwordx4 v15, s[20:23], s49 offen offset:1024 lds
    buffer_load_dwordx4 v16, s[20:23], s49 offen offset:2048 lds
    s_add_u32 s3, s3, 1
    s_and_b32 s3, s3, 7
    v_xor_b32 v45, v40, v41
    v_lshlrev_b32 v45, 4, v45
    v_lshl_add_u32 v1, v44, 8, v45
    v_xor_b32 v2, 64, v1
    v_xor_b32 v3, 128, v1
    v_xor_b32 v4, 192, v1
    v_and_b32 v45, 7, v42
    v_lshlrev_b32 v45, 1, v45
    v_xor_b32 v46, v45, v43
    v_lshlrev_b32 v46, 4, v46
    v_lshl_add_u32 v17, v42, 8, v46
    v_xor_b32 v18, 64, v17
    v_xor_b32 v19, 128, v17
    v_xor_b32 v20, 192, v17
    v_lshrrev_b32 v46, 1, v43
    v_xor_b32 v46, v45, v46
    v_lshlrev_b32 v46, 4, v46
    v_lshl_add_u32 v46, v42, 8, v46
    v_and_b32 v47, 1, v43
    v_lshl_add_u32 v46, v47, 3, v46
    v_add_u32 v24, 65536, v46
    v_xor_b32 v25, 32, v24
    v_xor_b32 v26, 64, v24
    v_xor_b32 v27, 96, v24
    v_xor_b32 v28, 128, v24
    v_xor_b32 v29, 160, v24
    v_xor_b32 v30, 192, v24
    v_xor_b32 v31, 224, v24
    v_mul_u32_u24 v46, 96, v42
    v_lshl_add_u32 v46, v43, 3, v46
    v_add_u32 v21, 65536, v46
    s_lshl_b32 s50, s37, 19
    s_add_u32 s12, s10, s50
    s_addc_u32 s13, s11, 0
    s_mov_b32 s14, 0x80000
    s_mov_b32 s15, 0x20000
    s_add_u32 s8, s8, s50
    s_addc_u32 s9, s9, 0
    s_mov_b32 s10, 0x80000
    s_mov_b32 s11, 0x20000
    s_add_u32 s51, s55, 3
    s_lshl_b32 s51, s51, 6
    s_mul_i32 s52, s38, 40
    s_add_u32 s51, s51, s52
    s_mul_i32 s52, s36, 10
    s_add_u32 s52, s52, s51
    v_lshrrev_b32 v56, 1, v0
    v_min_u32 v57, 9, v56
    v_add_u32 v57, s52, v57
    v_and_b32 v57, 511, v57
    v_lshlrev_b32 v57, 13, v57
    v_lshl_add_u32 v57, v55, 5, v57
    s_and_b32 s52, s36, 1
    s_mul_i32 s52, s52, 20
    s_add_u32 s52, s52, s51
    s_mul_i32 s51, s37, 96
    v_min_u32 v58, 19, v56
    v_add_u32 v58, s52, v58
    v_and_b32 v58, 511, v58
    v_mul_u32_u24 v58, 2752, v58
    v_mad_u32_u24 v58, v55, 23, v58
    v_add_u32 v58, s51, v58
    s_lshl_b32 s51, s38, 2
    s_add_u32 s51, s51, s36
    s_lshl_b32 s51, s51, 3
    s_and_b32 s52, s2, 7
    s_add_u32 s51, s51, s52
    s_lshl_b32 s51, s51, 7
    s_add_u32 s51, s51, 24576
    v_bfe_i32 v22, v0, 0, 1
    v_and_b32 v22, s87, v22
    v_xor_b32 v22, s86, v22
    v_and_b32 v7, 31, v0
    v_lshlrev_b32 v7, 2, v7
    s_mov_b32 s49, 262144
L_px:
    buffer_load_dword v8, v7, s[28:31], s51 offen sc1
    s_sub_u32 s49, s49, 1
    s_cbranch_scc1 L_px_x
    s_waitcnt vmcnt(0)
    v_cmp_ne_u32 vcc, v22, v8
    s_nop 1
    s_cbranch_vccnz L_px
L_px_x:
    s_lshl_b32 s41, s55, 11
    s_add_u32 s42, s41, 16384
    s_add_u32 s43, s41, 32768
    s_add_u32 s44, s41, 49152
    s_add_u32 s55, s55, 1
    s_and_b32 s55, s55, 7
    buffer_load_dwordx4 a[128:131], v9, s[24:27], s41 offen offset:0 sc1
    buffer_load_dwordx4 a[132:135], v9, s[24:27], s42 offen offset:0 sc1
    buffer_load_dwordx4 a[136:139], v9, s[24:27], s43 offen offset:0 sc1
    buffer_load_dwordx4 a[140:143], v9, s[24:27], s44 offen offset:0 sc1
    buffer_load_dwordx4 a[144:147], v9, s[24:27], s41 offen offset:1024 sc1
    buffer_load_dwordx4 a[148:151], v9, s[24:27], s42 offen offset:1024 sc1
    buffer_load_dwordx4 a[152:155], v9, s[24:27], s43 offen offset:1024 sc1
    buffer_load_dwordx4 a[156:159], v9, s[24:27], s44 offen offset:1024 sc1
    s_lshl_b32 s52, s53, 10
    s_lshl_b32 s51, s53, 9
    s_add_u32 s51, s51, 2097152
    s_add_u32 s28, s4, s51
    s_addc_u32 s29, s5, 0
    s_mov_b32 s30, 5572608
    s_mov_b32 s31, 0x20000
    s_add_u32 s50, s50, s52
    s_add_u32 s50, s50, 8388608
    s_add_u32 s32, s4, s50
    s_addc_u32 s33, s5, 0
    s_mov_b32 s34, 397312
    s_mov_b32 s35, 0x20000
    s_mov_b32 s45, 0
    s_mov_b32 s46, 0
    s_mov_b32 s6, 1040356334
    s_mov_b32 s7, 1040356334
    s_waitcnt vmcnt(8)
    s_barrier
    s_lshl_b32 s41, s55, 11
    s_add_u32 s42, s41, 16384
    s_add_u32 s43, s41, 32768
    s_add_u32 s44, s41, 49152
    s_add_u32 s55, s55, 1
    s_and_b32 s55, s55, 7
    buffer_load_dwordx4 a[160:163], v9, s[24:27], s41 offen offset:0 sc1
    buffer_load_dwordx4 a[164:167], v9, s[24:27], s42 offen offset:0 sc1
    buffer_load_dwordx4 a[168:171], v9, s[24:27], s43 offen offset:0 sc1
    buffer_load_dwordx4 a[172:175], v9, s[24:27], s44 offen offset:0 sc1
    buffer_load_dwordx4 a[176:179], v9, s[24:27], s41 offen offset:1024 sc1
    buffer_load_dwordx4 a[180:183], v9, s[24:27], s42 offen offset:1024 sc1
    buffer_load_dwordx4 a[184:187], v9, s[24:27], s43 offen offset:1024 sc1
    buffer_load_dwordx4 a[188:191], v9, s[24:27], s44 offen offset:1024 sc1
    s_barrier
    buffer_load_dword v23, v57, s[16:19], 0 offen
    buffer_load_dword v23, v58, s[20:23], 0 offen
    ds_read_b64_tr_b16 a[96:97], v17 offset:0
    ds_read_b64_tr_b16 a[98:99], v17 offset:4096
    ds_read_b64_tr_b16 a[100:101], v17 offset:8192
    ds_read_b64_tr_b16 a[102:103], v17 offset:12288
    ds_read_b64_tr_b16 a[104:105], v17 offset:8
    ds_read_b64_tr_b16 a[106:107], v17 offset:4104
    ds_read_b64_tr_b16 a[108:109], v17 offset:8200
    ds_read_b64_tr_b16 a[110:111], v17 offset:12296
    s_waitcnt vmcnt(10) lgkmcnt(4)
    v_mfma_f32_16x16x32_bf16 v[32:35], a[96:99], a[128:131], 0
    v_mfma_f32_16x16x32_bf16 v[32:35], a[100:103], a[144:147], v[32:35]
    ds_read_b64_tr_b16 a[112:113], v18 offset:0
    ds_read_b64_tr_b16 a[114:115], v18 offset:4096
    v_mfma_f32_16x16x32_bf16 v[64:67], a[100:103], a[148:151], 0
    v_mfma_f32_16x16x32_bf16 v[64:67], a[96:99], a[132:135], v[64:67]
    v_mfma_f32_16x16x32_bf16 v[96:99], a[96:99], a[136:139], 0
    ds_read_b64_tr_b16 a[116:117], v18 offset:8192
    ds_read_b64_tr_b16 a[118:119], v18 offset:12288
    v_mfma_f32_16x16x32_bf16 v[96:99], a[100:103], a[152:155], v[96:99]
    v_mfma_f32_16x16x32_bf16 v[128:131], a[100:103], a[156:159], 0
    v_mfma_f32_16x16x32_bf16 v[128:131], a[96:99], a[140:143], v[128:131]
    s_waitcnt lgkmcnt(4)
    v_mfma_f32_16x16x32_bf16 v[132:135], a[104:107], a[140:143], 0
    v_mfma_f32_16x16x32_bf16 v[132:135], a[108:111], a[156:159], v[132:135]
    ds_read_b64_tr_b16 a[120:121], v18 offset:8
    ds_read_b64_tr_b16 a[122:123], v18 offset:4104
    v_mfma_f32_16x16x32_bf16 v[100:103], a[108:111], a[152:155], 0
    v_mfma_f32_16x16x32_bf16 v[100:103], a[104:107], a[136:139], v[100:103]
    v_mfma_f32_16x16x32_bf16 v[68:71], a[104:107], a[132:135], 0
    ds_read_b64_tr_b16 a[124:125], v18 offset:8200
    ds_read_b64_tr_b16 a[126:127], v18 offset:12296
    v_mfma_f32_16x16x32_bf16 v[68:71], a[108:111], a[148:151], v[68:71]
    v_mfma_f32_16x16x32_bf16 v[36:39], a[108:111], a[144:147], 0
    v_mfma_f32_16x16x32_bf16 v[36:39], a[104:107], a[128:131], v[36:39]
    s_waitcnt lgkmcnt(4)
    v_mfma_f32_16x16x32_bf16 v[40:43], a[112:115], a[128:131], 0
    v_mfma_f32_16x16x32_bf16 v[40:43], a[116:119], a[144:147], v[40:43]
    ds_read_b64_tr_b16 a[96:97], v19 offset:0
    ds_read_b64_tr_b16 a[98:99], v19 offset:4096
    v_mfma_f32_16x16x32_bf16 v[72:75], a[116:119], a[148:151], 0
    v_mfma_f32_16x16x32_bf16 v[72:75], a[112:115], a[132:135], v[72:75]
    v_mfma_f32_16x16x32_bf16 v[104:107], a[112:115], a[136:139], 0
    ds_read_b64_tr_b16 a[100:101], v19 offset:8192
    ds_read_b64_tr_b16 a[102:103], v19 offset:12288
    v_mfma_f32_16x16x32_bf16 v[104:107], a[116:119], a[152:155], v[104:107]
    v_mfma_f32_16x16x32_bf16 v[136:139], a[116:119], a[156:159], 0
    v_mfma_f32_16x16x32_bf16 v[136:139], a[112:115], a[140:143], v[136:139]
    s_waitcnt lgkmcnt(4)
    v_mfma_f32_16x16x32_bf16 v[140:143], a[120:123], a[140:143], 0
    v_mfma_f32_16x16x32_bf16 v[140:143], a[124:127], a[156:159], v[140:143]
    ds_read_b64_tr_b16 a[104:105], v19 offset:8
    ds_read_b64_tr_b16 a[106:107], v19 offset:4104
    v_mfma_f32_16x16x32_bf16 v[108:111], a[124:127], a[152:155], 0
    v_mfma_f32_16x16x32_bf16 v[108:111], a[120:123], a[136:139], v[108:111]
    v_mfma_f32_16x16x32_bf16 v[76:79], a[120:123], a[132:135], 0
    ds_read_b64_tr_b16 a[108:109], v19 offset:8200
    ds_read_b64_tr_b16 a[110:111], v19 offset:12296
    v_mfma_f32_16x16x32_bf16 v[76:79], a[124:127], a[148:151], v[76:79]
    v_mfma_f32_16x16x32_bf16 v[44:47], a[124:127], a[144:147], 0
    v_mfma_f32_16x16x32_bf16 v[44:47], a[120:123], a[128:131], v[44:47]
    s_waitcnt lgkmcnt(4)
    v_mfma_f32_16x16x32_bf16 v[48:51], a[96:99], a[128:131], 0
    v_mfma_f32_16x16x32_bf16 v[48:51], a[100:103], a[144:147], v[48:51]
    ds_read_b64_tr_b16 a[112:113], v20 offset:0
    ds_read_b64_tr_b16 a[114:115], v20 offset:4096
    v_mfma_f32_16x16x32_bf16 v[80:83], a[100:103], a[148:151], 0
    v_mfma_f32_16x16x32_bf16 v[80:83], a[96:99], a[132:135], v[80:83]
    v_mfma_f32_16x16x32_bf16 v[112:115], a[96:99], a[136:139], 0
    ds_read_b64_tr_b16 a[116:117], v20 offset:8192
    ds_read_b64_tr_b16 a[118:119], v20 offset:12288
    v_mfma_f32_16x16x32_bf16 v[112:115], a[100:103], a[152:155], v[112:115]
    v_mfma_f32_16x16x32_bf16 v[144:147], a[100:103], a[156:159], 0
    v_mfma_f32_16x16x32_bf16 v[144:147], a[96:99], a[140:143], v[144:147]
    s_waitcnt lgkmcnt(4)
    v_mfma_f32_16x16x32_bf16 v[148:151], a[104:107], a[140:143], 0
    v_mfma_f32_16x16x32_bf16 v[148:151], a[108:111], a[156:159], v[148:151]
    ds_read_b64_tr_b16 a[120:121], v20 offset:8
    ds_read_b64_tr_b16 a[122:123], v20 offset:4104
    v_mfma_f32_16x16x32_bf16 v[116:119], a[108:111], a[152:155], 0
    v_mfma_f32_16x16x32_bf16 v[116:119], a[104:107], a[136:139], v[116:119]
    v_mfma_f32_16x16x32_bf16 v[84:87], a[104:107], a[132:135], 0
    ds_read_b64_tr_b16 a[124:125], v20 offset:8200
    ds_read_b64_tr_b16 a[126:127], v20 offset:12296
    v_mfma_f32_16x16x32_bf16 v[84:87], a[108:111], a[148:151], v[84:87]
    v_mfma_f32_16x16x32_bf16 v[52:55], a[108:111], a[144:147], 0
    v_mfma_f32_16x16x32_bf16 v[52:55], a[104:107], a[128:131], v[52:55]
    s_waitcnt lgkmcnt(4)
    v_mfma_f32_16x16x32_bf16 v[56:59], a[112:115], a[128:131], 0
    v_mfma_f32_16x16x32_bf16 v[56:59], a[116:119], a[144:147], v[56:59]
    ds_read_b64_tr_b16 a[96:97], v21 offset:0
    ds_read_b64_tr_b16 a[98:99], v21 offset:1536
    v_mfma_f32_16x16x32_bf16 v[88:91], a[116:119], a[148:151], 0
    v_mfma_f32_16x16x32_bf16 v[88:91], a[112:115], a[132:135], v[88:91]
    v_mfma_f32_16x16x32_bf16 v[120:123], a[112:115], a[136:139], 0
    ds_read_b64_tr_b16 a[100:101], v21 offset:3072
    ds_read_b64_tr_b16 a[102:103], v21 offset:4608
    v_mfma_f32_16x16x32_bf16 v[120:123], a[116:119], a[152:155], v[120:123]
    v_mfma_f32_16x16x32_bf16 v[152:155], a[116:119], a[156:159], 0
    v_mfma_f32_16x16x32_bf16 v[152:155], a[112:115], a[140:143], v[152:155]
    s_waitcnt lgkmcnt(4)
    v_mfma_f32_16x16x32_bf16 v[156:159], a[120:123], a[140:143], 0
    v_mfma_f32_16x16x32_bf16 v[156:159], a[124:127], a[156:159], v[156:159]
    ds_read_b64_tr_b16 a[104:105], v21 offset:6144
    ds_read_b64_tr_b16 a[106:107], v21 offset:7680
    v_mfma_f32_16x16x32_bf16 v[124:127], a[124:127], a[152:155], 0
    v_mfma_f32_16x16x32_bf16 v[124:127], a[120:123], a[136:139], v[124:127]
    v_mfma_f32_16x16x32_bf16 v[92:95], a[120:123], a[132:135], 0
    ds_read_b64_tr_b16 a[108:109], v21 offset:9216
    ds_read_b64_tr_b16 a[110:111], v21 offset:10752
    v_mfma_f32_16x16x32_bf16 v[92:95], a[124:127], a[148:151], v[92:95]
    v_mfma_f32_16x16x32_bf16 v[60:63], a[124:127], a[144:147], 0
    v_mfma_f32_16x16x32_bf16 v[60:63], a[120:123], a[128:131], v[60:63]
    s_waitcnt lgkmcnt(4)
    v_mfma_f32_16x16x32_bf16 v[160:163], a[96:99], a[128:131], 0
    v_mfma_f32_16x16x32_bf16 v[160:163], a[100:103], a[144:147], v[160:163]
    ds_read_b64_tr_b16 a[112:113], v21 offset:32
    ds_read_b64_tr_b16 a[114:115], v21 offset:1568
    v_mfma_f32_16x16x32_bf16 v[164:167], a[100:103], a[148:151], 0
    v_mfma_f32_16x16x32_bf16 v[164:167], a[96:99], a[132:135], v[164:167]
    v_mfma_f32_16x16x32_bf16 v[168:171], a[96:99], a[136:139], 0
    ds_read_b64_tr_b16 a[116:117], v21 offset:3104
    ds_read_b64_tr_b16 a[118:119], v21 offset:4640
    v_mfma_f32_16x16x32_bf16 v[168:171], a[100:103], a[152:155], v[168:171]
    v_mfma_f32_16x16x32_bf16 v[172:175], a[100:103], a[156:159], 0
    v_mfma_f32_16x16x32_bf16 v[172:175], a[96:99], a[140:143], v[172:175]
    s_waitcnt lgkmcnt(4)
    v_mfma_f32_16x16x32_bf16 v[188:191], a[104:107], a[140:143], 0
    v_mfma_f32_16x16x32_bf16 v[188:191], a[108:111], a[156:159], v[188:191]
    ds_read_b64_tr_b16 a[120:121], v21 offset:6176
    ds_read_b64_tr_b16 a[122:123], v21 offset:7712
    v_mfma_f32_16x16x32_bf16 v[184:187], a[108:111], a[152:155], 0
    v_mfma_f32_16x16x32_bf16 v[184:187], a[104:107], a[136:139], v[184:187]
    v_mfma_f32_16x16x32_bf16 v[180:183], a[104:107], a[132:135], 0
    ds_read_b64_tr_b16 a[124:125], v21 offset:9248
    ds_read_b64_tr_b16 a[126:127], v21 offset:10784
    v_mfma_f32_16x16x32_bf16 v[180:183], a[108:111], a[148:151], v[180:183]
    v_mfma_f32_16x16x32_bf16 v[176:179], a[108:111], a[144:147], 0
    v_mfma_f32_16x16x32_bf16 v[176:179], a[104:107], a[128:131], v[176:179]
    s_waitcnt lgkmcnt(4)
    v_mfma_f32_16x16x32_bf16 v[192:195], a[112:115], a[128:131], 0
    v_mfma_f32_16x16x32_bf16 v[192:195], a[116:119], a[144:147], v[192:195]
    ds_read_b64_tr_b16 a[96:97], v21 offset:64
    ds_read_b64_tr_b16 a[98:99], v21 offset:1600
    v_mfma_f32_16x16x32_bf16 v[196:199], a[116:119], a[148:151], 0
    v_mfma_f32_16x16x32_bf16 v[196:199], a[112:115], a[132:135], v[196:199]
    v_mfma_f32_16x16x32_bf16 v[200:203], a[112:115], a[136:139], 0
    ds_read_b64_tr_b16 a[100:101], v21 offset:3136
    ds_read_b64_tr_b16 a[102:103], v21 offset:4672
    v_mfma_f32_16x16x32_bf16 v[200:203], a[116:119], a[152:155], v[200:203]
    v_mfma_f32_16x16x32_bf16 v[204:207], a[116:119], a[156:159], 0
    v_mfma_f32_16x16x32_bf16 v[204:207], a[112:115], a[140:143], v[204:207]
    s_waitcnt lgkmcnt(4)
    v_mfma_f32_16x16x32_bf16 v[220:223], a[120:123], a[140:143], 0
    s_lshl_b32 s41, s55, 11
    v_mfma_f32_16x16x32_bf16 v[220:223], a[124:127], a[156:159], v[220:223]
    s_add_u32 s42, s41, 16384
    ds_read_b64_tr_b16 a[104:105], v21 offset:6208
    ds_read_b64_tr_b16 a[106:107], v21 offset:7744
    v_mfma_f32_16x16x32_bf16 v[216:219], a[124:127], a[152:155], 0
    s_add_u32 s43, s41, 32768
    v_mfma_f32_16x16x32_bf16 v[216:219], a[120:123], a[136:139], v[216:219]
    s_add_u32 s44, s41, 49152
    v_mfma_f32_16x16x32_bf16 v[212:215], a[120:123], a[132:135], 0
    s_add_u32 s55, s55, 1
    ds_read_b64_tr_b16 a[108:109], v21 offset:9280
    ds_read_b64_tr_b16 a[110:111], v21 offset:10816
    v_mfma_f32_16x16x32_bf16 v[212:215], a[124:127], a[148:151], v[212:215]
    s_and_b32 s55, s55, 7
    buffer_load_dwordx4 a[192:195], v9, s[24:27], s41 offen offset:0 sc1
    v_mfma_f32_16x16x32_bf16 v[208:211], a[124:127], a[144:147], 0
    v_mfma_f32_16x16x32_bf16 v[208:211], a[120:123], a[128:131], v[208:211]
    s_waitcnt lgkmcnt(4)
    v_mfma_f32_16x16x32_bf16 v[224:227], a[96:99], a[128:131], 0
    v_mfma_f32_16x16x32_bf16 v[224:227], a[100:103], a[144:147], v[224:227]
    ds_read_b64_tr_b16 a[112:113], v17 offset:16384
    ds_read_b64_tr_b16 a[114:115], v17 offset:20480
    v_mfma_f32_16x16x32_bf16 v[228:231], a[100:103], a[148:151], 0
    v_mfma_f32_16x16x32_bf16 v[228:231], a[96:99], a[132:135], v[228:231]
    buffer_load_dwordx4 a[196:199], v9, s[24:27], s42 offen offset:0 sc1
    v_mfma_f32_16x16x32_bf16 v[232:235], a[96:99], a[136:139], 0
    ds_read_b64_tr_b16 a[116:117], v17 offset:24576
    ds_read_b64_tr_b16 a[118:119], v17 offset:28672
    v_mfma_f32_16x16x32_bf16 v[232:235], a[100:103], a[152:155], v[232:235]
    v_mfma_f32_16x16x32_bf16 v[236:239], a[100:103], a[156:159], 0
    v_mfma_f32_16x16x32_bf16 v[236:239], a[96:99], a[140:143], v[236:239]
    s_waitcnt lgkmcnt(4)
    v_mfma_f32_16x16x32_bf16 v[252:255], a[104:107], a[140:143], 0
    v_mfma_f32_16x16x32_bf16 v[252:255], a[108:111], a[156:159], v[252:255]
    ds_read_b64_tr_b16 a[120:121], v17 offset:16392
    ds_read_b64_tr_b16 a[122:123], v17 offset:20488
    v_mfma_f32_16x16x32_bf16 v[248:251], a[108:111], a[152:155], 0
    buffer_load_dwordx4 a[200:203], v9, s[24:27], s43 offen offset:0 sc1
    v_mfma_f32_16x16x32_bf16 v[248:251], a[104:107], a[136:139], v[248:251]
    v_mfma_f32_16x16x32_bf16 v[244:247], a[104:107], a[132:135], 0
    ds_read_b64_tr_b16 a[124:125], v17 offset:24584
    ds_read_b64_tr_b16 a[126:127], v17 offset:28680
    v_mfma_f32_16x16x32_bf16 v[244:247], a[108:111], a[148:151], v[244:247]
    v_mfma_f32_16x16x32_bf16 v[240:243], a[108:111], a[144:147], 0
    v_mfma_f32_16x16x32_bf16 v[240:243], a[104:107], a[128:131], v[240:243]
    s_waitcnt vmcnt(5) lgkmcnt(4)
    v_mfma_f32_16x16x32_bf16 v[32:35], a[112:115], a[160:163], v[32:35]
    buffer_load_dwordx4 a[204:207], v9, s[24:27], s44 offen offset:0 sc1
    v_mfma_f32_16x16x32_bf16 v[32:35], a[116:119], a[176:179], v[32:35]
    ds_read_b64_tr_b16 a[96:97], v18 offset:16384
    ds_read_b64_tr_b16 a[98:99], v18 offset:20480
    v_mfma_f32_16x16x32_bf16 v[64:67], a[116:119], a[180:183], v[64:67]
    v_mfma_f32_16x16x32_bf16 v[64:67], a[112:115], a[164:167], v[64:67]
    v_mfma_f32_16x16x32_bf16 v[96:99], a[112:115], a[168:171], v[96:99]
    ds_read_b64_tr_b16 a[100:101], v18 offset:24576
    ds_read_b64_tr_b16 a[102:103], v18 offset:28672
    v_mfma_f32_16x16x32_bf16 v[96:99], a[116:119], a[184:187], v[96:99]
    v_mfma_f32_16x16x32_bf16 v[128:131], a[116:119], a[188:191], v[128:131]
    buffer_load_dwordx4 a[208:211], v9, s[24:27], s41 offen offset:1024 sc1
    v_mfma_f32_16x16x32_bf16 v[128:131], a[112:115], a[172:175], v[128:131]
    s_waitcnt lgkmcnt(4)
    v_mfma_f32_16x16x32_bf16 v[132:135], a[120:123], a[172:175], v[132:135]
    v_mfma_f32_16x16x32_bf16 v[132:135], a[124:127], a[188:191], v[132:135]
    ds_read_b64_tr_b16 a[104:105], v18 offset:16392
    ds_read_b64_tr_b16 a[106:107], v18 offset:20488
    v_mfma_f32_16x16x32_bf16 v[100:103], a[124:127], a[184:187], v[100:103]
    v_mfma_f32_16x16x32_bf16 v[100:103], a[120:123], a[168:171], v[100:103]
    v_mfma_f32_16x16x32_bf16 v[68:71], a[120:123], a[164:167], v[68:71]
    ds_read_b64_tr_b16 a[108:109], v18 offset:24584
    ds_read_b64_tr_b16 a[110:111], v18 offset:28680
    v_mfma_f32_16x16x32_bf16 v[68:71], a[124:127], a[180:183], v[68:71]
    buffer_load_dwordx4 a[212:215], v9, s[24:27], s42 offen offset:1024 sc1
    v_mfma_f32_16x16x32_bf16 v[36:39], a[124:127], a[176:179], v[36:39]
    v_mfma_f32_16x16x32_bf16 v[36:39], a[120:123], a[160:163], v[36:39]
    s_waitcnt lgkmcnt(4)
    v_mfma_f32_16x16x32_bf16 v[40:43], a[96:99], a[160:163], v[40:43]
    v_mfma_f32_16x16x32_bf16 v[40:43], a[100:103], a[176:179], v[40:43]
    ds_read_b64_tr_b16 a[112:113], v19 offset:16384
    ds_read_b64_tr_b16 a[114:115], v19 offset:20480
    v_mfma_f32_16x16x32_bf16 v[72:75], a[100:103], a[180:183], v[72:75]
    v_mfma_f32_16x16x32_bf16 v[72:75], a[96:99], a[164:167], v[72:75]
    buffer_load_dwordx4 a[216:219], v9, s[24:27], s43 offen offset:1024 sc1
    v_mfma_f32_16x16x32_bf16 v[104:107], a[96:99], a[168:171], v[104:107]
    ds_read_b64_tr_b16 a[116:117], v19 offset:24576
    ds_read_b64_tr_b16 a[118:119], v19 offset:28672
    v_mfma_f32_16x16x32_bf16 v[104:107], a[100:103], a[184:187], v[104:107]
    v_mfma_f32_16x16x32_bf16 v[136:139], a[100:103], a[188:191], v[136:139]
    v_mfma_f32_16x16x32_bf16 v[136:139], a[96:99], a[172:175], v[136:139]
    s_waitcnt lgkmcnt(4)
    v_mfma_f32_16x16x32_bf16 v[140:143], a[104:107], a[172:175], v[140:143]
    v_mfma_f32_16x16x32_bf16 v[140:143], a[108:111], a[188:191], v[140:143]
    ds_read_b64_tr_b16 a[120:121], v19 offset:16392
    ds_read_b64_tr_b16 a[122:123], v19 offset:20488
    v_mfma_f32_16x16x32_bf16 v[108:111], a[108:111], a[184:187], v[108:111]
    buffer_load_dwordx4 a[220:223], v9, s[24:27], s44 offen offset:1024 sc1
    v_mfma_f32_16x16x32_bf16 v[108:111], a[104:107], a[168:171], v[108:111]
    s_add_u32 m0, s39, 49152
    v_mfma_f32_16x16x32_bf16 v[76:79], a[104:107], a[164:167], v[76:79]
    s_lshl_b32 s49, s54, 19
    ds_read_b64_tr_b16 a[124:125], v19 offset:24584
    ds_read_b64_tr_b16 a[126:127], v19 offset:28680
    v_mfma_f32_16x16x32_bf16 v[76:79], a[108:111], a[180:183], v[76:79]
    v_mfma_f32_16x16x32_bf16 v[44:47], a[108:111], a[176:179], v[44:47]
    v_mfma_f32_16x16x32_bf16 v[44:47], a[104:107], a[160:163], v[44:47]
    s_waitcnt lgkmcnt(4)
    v_mfma_f32_16x16x32_bf16 v[48:51], a[112:115], a[160:163], v[48:51]
    buffer_load_dwordx4 v10, s[16:19], s49 offen offset:0 lds
    v_mfma_f32_16x16x32_bf16 v[48:51], a[116:119], a[176:179], v[48:51]
    ds_read_b64_tr_b16 a[96:97], v20 offset:16384
    ds_read_b64_tr_b16 a[98:99], v20 offset:20480
    v_mfma_f32_16x16x32_bf16 v[80:83], a[116:119], a[180:183], v[80:83]
    v_mfma_f32_16x16x32_bf16 v[80:83], a[112:115], a[164:167], v[80:83]
    v_mfma_f32_16x16x32_bf16 v[112:115], a[112:115], a[168:171], v[112:115]
    ds_read_b64_tr_b16 a[100:101], v20 offset:24576
    ds_read_b64_tr_b16 a[102:103], v20 offset:28672
    v_mfma_f32_16x16x32_bf16 v[112:115], a[116:119], a[184:187], v[112:115]
    v_mfma_f32_16x16x32_bf16 v[144:147], a[116:119], a[188:191], v[144:147]
    buffer_load_dwordx4 v11, s[16:19], s49 offen offset:1024 lds
    v_mfma_f32_16x16x32_bf16 v[144:147], a[112:115], a[172:175], v[144:147]
    s_waitcnt lgkmcnt(4)
    v_mfma_f32_16x16x32_bf16 v[148:151], a[120:123], a[172:175], v[148:151]
    v_mfma_f32_16x16x32_bf16 v[148:151], a[124:127], a[188:191], v[148:151]
    ds_read_b64_tr_b16 a[104:105], v20 offset:16392
    ds_read_b64_tr_b16 a[106:107], v20 offset:20488
    v_mfma_f32_16x16x32_bf16 v[116:119], a[124:127], a[184:187], v[116:119]
    v_mfma_f32_16x16x32_bf16 v[116:119], a[120:123], a[168:171], v[116:119]
    v_mfma_f32_16x16x32_bf16 v[84:87], a[120:123], a[164:167], v[84:87]
    ds_read_b64_tr_b16 a[108:109], v20 offset:24584
    ds_read_b64_tr_b16 a[110:111], v20 offset:28680
    v_mfma_f32_16x16x32_bf16 v[84:87], a[124:127], a[180:183], v[84:87]
    buffer_load_dwordx4 v12, s[16:19], s49 offen offset:2048 lds
    v_mfma_f32_16x16x32_bf16 v[52:55], a[124:127], a[176:179], v[52:55]
    v_mfma_f32_16x16x32_bf16 v[52:55], a[120:123], a[160:163], v[52:55]
    s_waitcnt lgkmcnt(4)
    v_mfma_f32_16x16x32_bf16 v[56:59], a[96:99], a[160:163], v[56:59]
    v_mfma_f32_16x16x32_bf16 v[56:59], a[100:103], a[176:179], v[56:59]
    ds_read_b64_tr_b16 a[112:113], v21 offset:16384
    ds_read_b64_tr_b16 a[114:115], v21 offset:17920
    v_mfma_f32_16x16x32_bf16 v[88:91], a[100:103], a[180:183], v[88:91]
    v_mfma_f32_16x16x32_bf16 v[88:91], a[96:99], a[164:167], v[88:91]
    buffer_load_dwordx4 v13, s[16:19], s49 offen offset:3072 lds
    v_mfma_f32_16x16x32_bf16 v[120:123], a[96:99], a[168:171], v[120:123]
    s_add_u32 s54, s54, 1
    ds_read_b64_tr_b16 a[116:117], v21 offset:19456
    ds_read_b64_tr_b16 a[118:119], v21 offset:20992
    v_mfma_f32_16x16x32_bf16 v[120:123], a[100:103], a[184:187], v[120:123]
    s_and_b32 s54, s54, 7
    v_mfma_f32_16x16x32_bf16 v[152:155], a[100:103], a[188:191], v[152:155]
    s_lshl_b32 s41, s55, 11
    v_mfma_f32_16x16x32_bf16 v[152:155], a[96:99], a[172:175], v[152:155]
    s_waitcnt lgkmcnt(4)
    v_mfma_f32_16x16x32_bf16 v[156:159], a[104:107], a[172:175], v[156:159]
    s_add_u32 s42, s41, 16384
    v_mfma_f32_16x16x32_bf16 v[156:159], a[108:111], a[188:191], v[156:159]
    s_add_u32 s43, s41, 32768
    ds_read_b64_tr_b16 a[120:121], v21 offset:22528
    ds_read_b64_tr_b16 a[122:123], v21 offset:24064
    v_mfma_f32_16x16x32_bf16 v[124:127], a[108:111], a[184:187], v[124:127]
    s_add_u32 s44, s41, 49152
    v_mfma_f32_16x16x32_bf16 v[124:127], a[104:107], a[168:171], v[124:127]
    s_add_u32 s55, s55, 1
    v_mfma_f32_16x16x32_bf16 v[92:95], a[104:107], a[164:167], v[92:95]
    s_and_b32 s55, s55, 7
    ds_read_b64_tr_b16 a[124:125], v21 offset:25600
    ds_read_b64_tr_b16 a[126:127], v21 offset:27136
    v_mfma_f32_16x16x32_bf16 v[92:95], a[108:111], a[180:183], v[92:95]
    buffer_load_dwordx4 a[224:227], v9, s[24:27], s41 offen offset:0 sc1
    v_mfma_f32_16x16x32_bf16 v[60:63], a[108:111], a[176:179], v[60:63]
    v_mfma_f32_16x16x32_bf16 v[60:63], a[104:107], a[160:163], v[60:63]
    s_waitcnt lgkmcnt(4)
    v_mfma_f32_16x16x32_bf16 v[160:163], a[112:115], a[160:163], v[160:163]
    v_mfma_f32_16x16x32_bf16 v[160:163], a[116:119], a[176:179], v[160:163]
    ds_read_b64_tr_b16 a[96:97], v21 offset:16416
    ds_read_b64_tr_b16 a[98:99], v21 offset:17952
    v_mfma_f32_16x16x32_bf16 v[164:167], a[116:119], a[180:183], v[164:167]
    v_mfma_f32_16x16x32_bf16 v[164:167], a[112:115], a[164:167], v[164:167]
    buffer_load_dwordx4 a[228:231], v9, s[24:27], s42 offen offset:0 sc1
    v_mfma_f32_16x16x32_bf16 v[168:171], a[112:115], a[168:171], v[168:171]
    ds_read_b64_tr_b16 a[100:101], v21 offset:19488
    ds_read_b64_tr_b16 a[102:103], v21 offset:21024
    v_mfma_f32_16x16x32_bf16 v[168:171], a[116:119], a[184:187], v[168:171]
    v_mfma_f32_16x16x32_bf16 v[172:175], a[116:119], a[188:191], v[172:175]
    v_mfma_f32_16x16x32_bf16 v[172:175], a[112:115], a[172:175], v[172:175]
    s_waitcnt lgkmcnt(4)
    v_mfma_f32_16x16x32_bf16 v[188:191], a[120:123], a[172:175], v[188:191]
    v_mfma_f32_16x16x32_bf16 v[188:191], a[124:127], a[188:191], v[188:191]
    ds_read_b64_tr_b16 a[104:105], v21 offset:22560
    ds_read_b64_tr_b16 a[106:107], v21 offset:24096
    v_mfma_f32_16x16x32_bf16 v[184:187], a[124:127], a[184:187], v[184:187]
    buffer_load_dwordx4 a[232:235], v9, s[24:27], s43 offen offset:0 sc1
    v_mfma_f32_16x16x32_bf16 v[184:187], a[120:123], a[168:171], v[184:187]
    v_mfma_f32_16x16x32_bf16 v[180:183], a[120:123], a[164:167], v[180:183]
    ds_read_b64_tr_b16 a[108:109], v21 offset:25632
    ds_read_b64_tr_b16 a[110:111], v21 offset:27168
    v_mfma_f32_16x16x32_bf16 v[180:183], a[124:127], a[180:183], v[180:183]
    v_mfma_f32_16x16x32_bf16 v[176:179], a[124:127], a[176:179], v[176:179]
    v_mfma_f32_16x16x32_bf16 v[176:179], a[120:123], a[160:163], v[176:179]
    s_waitcnt lgkmcnt(4)
    v_mfma_f32_16x16x32_bf16 v[192:195], a[96:99], a[160:163], v[192:195]
    buffer_load_dwordx4 a[236:239], v9, s[24:27], s44 offen offset:0 sc1
    v_mfma_f32_16x16x32_bf16 v[192:195], a[100:103], a[176:179], v[192:195]
    ds_read_b64_tr_b16 a[112:113], v21 offset:16448
    ds_read_b64_tr_b16 a[114:115], v21 offset:17984
    v_mfma_f32_16x16x32_bf16 v[196:199], a[100:103], a[180:183], v[196:199]
    v_mfma_f32_16x16x32_bf16 v[196:199], a[96:99], a[164:167], v[196:199]
    v_mfma_f32_16x16x32_bf16 v[200:203], a[96:99], a[168:171], v[200:203]
    ds_read_b64_tr_b16 a[116:117], v21 offset:19520
    ds_read_b64_tr_b16 a[118:119], v21 offset:21056
    v_mfma_f32_16x16x32_bf16 v[200:203], a[100:103], a[184:187], v[200:203]
    v_mfma_f32_16x16x32_bf16 v[204:207], a[100:103], a[188:191], v[204:207]
    buffer_load_dwordx4 a[240:243], v9, s[24:27], s41 offen offset:1024 sc1
    v_mfma_f32_16x16x32_bf16 v[204:207], a[96:99], a[172:175], v[204:207]
    s_waitcnt lgkmcnt(4)
    v_mfma_f32_16x16x32_bf16 v[220:223], a[104:107], a[172:175], v[220:223]
    v_mfma_f32_16x16x32_bf16 v[220:223], a[108:111], a[188:191], v[220:223]
    ds_read_b64_tr_b16 a[120:121], v21 offset:22592
    ds_read_b64_tr_b16 a[122:123], v21 offset:24128
    v_mfma_f32_16x16x32_bf16 v[216:219], a[108:111], a[184:187], v[216:219]
    v_mfma_f32_16x16x32_bf16 v[216:219], a[104:107], a[168:171], v[216:219]
    v_mfma_f32_16x16x32_bf16 v[212:215], a[104:107], a[164:167], v[212:215]
    ds_read_b64_tr_b16 a[124:125], v21 offset:25664
    ds_read_b64_tr_b16 a[126:127], v21 offset:27200
    v_mfma_f32_16x16x32_bf16 v[212:215], a[108:111], a[180:183], v[212:215]
    buffer_load_dwordx4 a[244:247], v9, s[24:27], s42 offen offset:1024 sc1
    v_mfma_f32_16x16x32_bf16 v[208:211], a[108:111], a[176:179], v[208:211]
    v_mfma_f32_16x16x32_bf16 v[208:211], a[104:107], a[160:163], v[208:211]
    s_waitcnt lgkmcnt(4)
    v_mfma_f32_16x16x32_bf16 v[224:227], a[112:115], a[160:163], v[224:227]
    v_mfma_f32_16x16x32_bf16 v[224:227], a[116:119], a[176:179], v[224:227]
    ds_read_b64_tr_b16 a[96:97], v17 offset:32768
    ds_read_b64_tr_b16 a[98:99], v17 offset:36864
    v_mfma_f32_16x16x32_bf16 v[228:231], a[116:119], a[180:183], v[228:231]
    v_mfma_f32_16x16x32_bf16 v[228:231], a[112:115], a[164:167], v[228:231]
    buffer_load_dwordx4 a[248:251], v9, s[24:27], s43 offen offset:1024 sc1
    v_mfma_f32_16x16x32_bf16 v[232:235], a[112:115], a[168:171], v[232:235]
    ds_read_b64_tr_b16 a[100:101], v17 offset:40960
    ds_read_b64_tr_b16 a[102:103], v17 offset:45056
    v_mfma_f32_16x16x32_bf16 v[232:235], a[116:119], a[184:187], v[232:235]
    v_mfma_f32_16x16x32_bf16 v[236:239], a[116:119], a[188:191], v[236:239]
    v_mfma_f32_16x16x32_bf16 v[236:239], a[112:115], a[172:175], v[236:239]
    s_waitcnt lgkmcnt(4)
    v_mfma_f32_16x16x32_bf16 v[252:255], a[120:123], a[172:175], v[252:255]
    v_mfma_f32_16x16x32_bf16 v[252:255], a[124:127], a[188:191], v[252:255]
    ds_read_b64_tr_b16 a[104:105], v17 offset:32776
    ds_read_b64_tr_b16 a[106:107], v17 offset:36872
    v_mfma_f32_16x16x32_bf16 v[248:251], a[124:127], a[184:187], v[248:251]
    buffer_load_dwordx4 a[252:255], v9, s[24:27], s44 offen offset:1024 sc1
    v_mfma_f32_16x16x32_bf16 v[248:251], a[120:123], a[168:171], v[248:251]
    s_add_u32 m0, s40, 49152
    v_mfma_f32_16x16x32_bf16 v[244:247], a[120:123], a[164:167], v[244:247]
    s_mul_i32 s49, s3, 176128
    ds_read_b64_tr_b16 a[108:109], v17 offset:40968
    ds_read_b64_tr_b16 a[110:111], v17 offset:45064
    v_mfma_f32_16x16x32_bf16 v[244:247], a[124:127], a[180:183], v[244:247]
    v_mfma_f32_16x16x32_bf16 v[240:243], a[124:127], a[176:179], v[240:243]
    v_mfma_f32_16x16x32_bf16 v[240:243], a[120:123], a[160:163], v[240:243]
    s_waitcnt vmcnt(12) lgkmcnt(4)
    v_mfma_f32_16x16x32_bf16 v[32:35], a[96:99], a[192:195], v[32:35]
    buffer_load_dwordx4 v14, s[20:23], s49 offen offset:0 lds
    v_mfma_f32_16x16x32_bf16 v[32:35], a[100:103], a[208:211], v[32:35]
    ds_read_b64_tr_b16 a[112:113], v18 offset:32768
    ds_read_b64_tr_b16 a[114:115], v18 offset:36864
    v_mfma_f32_16x16x32_bf16 v[64:67], a[100:103], a[212:215], v[64:67]
    v_mfma_f32_16x16x32_bf16 v[64:67], a[96:99], a[196:199], v[64:67]
    v_mfma_f32_16x16x32_bf16 v[96:99], a[96:99], a[200:203], v[96:99]
    ds_read_b64_tr_b16 a[116:117], v18 offset:40960
    ds_read_b64_tr_b16 a[118:119], v18 offset:45056
    v_mfma_f32_16x16x32_bf16 v[96:99], a[100:103], a[216:219], v[96:99]
    v_mfma_f32_16x16x32_bf16 v[128:131], a[100:103], a[220:223], v[128:131]
    buffer_load_dwordx4 v15, s[20:23], s49 offen offset:1024 lds
    v_mfma_f32_16x16x32_bf16 v[128:131], a[96:99], a[204:207], v[128:131]
    s_waitcnt lgkmcnt(4)
    v_mfma_f32_16x16x32_bf16 v[132:135], a[104:107], a[204:207], v[132:135]
    v_mfma_f32_16x16x32_bf16 v[132:135], a[108:111], a[220:223], v[132:135]
    ds_read_b64_tr_b16 a[120:121], v18 offset:32776
    ds_read_b64_tr_b16 a[122:123], v18 offset:36872
    v_mfma_f32_16x16x32_bf16 v[100:103], a[108:111], a[216:219], v[100:103]
    v_mfma_f32_16x16x32_bf16 v[100:103], a[104:107], a[200:203], v[100:103]
    v_mfma_f32_16x16x32_bf16 v[68:71], a[104:107], a[196:199], v[68:71]
    ds_read_b64_tr_b16 a[124:125], v18 offset:40968
    ds_read_b64_tr_b16 a[126:127], v18 offset:45064
    v_mfma_f32_16x16x32_bf16 v[68:71], a[108:111], a[212:215], v[68:71]
    buffer_load_dwordx4 v16, s[20:23], s49 offen offset:2048 lds
    v_mfma_f32_16x16x32_bf16 v[36:39], a[108:111], a[208:211], v[36:39]
    s_add_u32 s3, s3, 1
    v_mfma_f32_16x16x32_bf16 v[36:39], a[104:107], a[192:195], v[36:39]
    s_waitcnt lgkmcnt(4)
    v_mfma_f32_16x16x32_bf16 v[40:43], a[112:115], a[192:195], v[40:43]
    s_and_b32 s3, s3, 7
    v_mfma_f32_16x16x32_bf16 v[40:43], a[116:119], a[208:211], v[40:43]
    s_lshl_b32 s41, s55, 11
    ds_read_b64_tr_b16 a[96:97], v19 offset:32768
    ds_read_b64_tr_b16 a[98:99], v19 offset:36864
    v_mfma_f32_16x16x32_bf16 v[72:75], a[116:119], a[212:215], v[72:75]
    s_add_u32 s42, s41, 16384
    v_mfma_f32_16x16x32_bf16 v[72:75], a[112:115], a[196:199], v[72:75]
    s_add_u32 s43, s41, 32768
    v_mfma_f32_16x16x32_bf16 v[104:107], a[112:115], a[200:203], v[104:107]
    s_add_u32 s44, s41, 49152
    ds_read_b64_tr_b16 a[100:101], v19 offset:40960
    ds_read_b64_tr_b16 a[102:103], v19 offset:45056
    v_mfma_f32_16x16x32_bf16 v[104:107], a[116:119], a[216:219], v[104:107]
    s_add_u32 s55, s55, 1
    v_mfma_f32_16x16x32_bf16 v[136:139], a[116:119], a[220:223], v[136:139]
    s_and_b32 s55, s55, 7
    buffer_load_dwordx4 a[128:131], v9, s[24:27], s41 offen offset:0 sc1
    v_mfma_f32_16x16x32_bf16 v[136:139], a[112:115], a[204:207], v[136:139]
    s_waitcnt lgkmcnt(4)
    v_mfma_f32_16x16x32_bf16 v[140:143], a[120:123], a[204:207], v[140:143]
    v_mfma_f32_16x16x32_bf16 v[140:143], a[124:127], a[220:223], v[140:143]
    ds_read_b64_tr_b16 a[104:105], v19 offset:32776
    ds_read_b64_tr_b16 a[106:107], v19 offset:36872
    v_mfma_f32_16x16x32_bf16 v[108:111], a[124:127], a[216:219], v[108:111]
    v_mfma_f32_16x16x32_bf16 v[108:111], a[120:123], a[200:203], v[108:111]
    v_mfma_f32_16x16x32_bf16 v[76:79], a[120:123], a[196:199], v[76:79]
    ds_read_b64_tr_b16 a[108:109], v19 offset:40968
    ds_read_b64_tr_b16 a[110:111], v19 offset:45064
    v_mfma_f32_16x16x32_bf16 v[76:79], a[124:127], a[212:215], v[76:79]
    buffer_load_dwordx4 a[132:135], v9, s[24:27], s42 offen offset:0 sc1
    v_mfma_f32_16x16x32_bf16 v[44:47], a[124:127], a[208:211], v[44:47]
    v_mfma_f32_16x16x32_bf16 v[44:47], a[120:123], a[192:195], v[44:47]
    s_waitcnt lgkmcnt(4)
    v_mfma_f32_16x16x32_bf16 v[48:51], a[96:99], a[192:195], v[48:51]
    v_mfma_f32_16x16x32_bf16 v[48:51], a[100:103], a[208:211], v[48:51]
    ds_read_b64_tr_b16 a[112:113], v20 offset:32768
    ds_read_b64_tr_b16 a[114:115], v20 offset:36864
    v_mfma_f32_16x16x32_bf16 v[80:83], a[100:103], a[212:215], v[80:83]
    v_mfma_f32_16x16x32_bf16 v[80:83], a[96:99], a[196:199], v[80:83]
    buffer_load_dwordx4 a[136:139], v9, s[24:27], s43 offen offset:0 sc1
    v_mfma_f32_16x16x32_bf16 v[112:115], a[96:99], a[200:203], v[112:115]
    ds_read_b64_tr_b16 a[116:117], v20 offset:40960
    ds_read_b64_tr_b16 a[118:119], v20 offset:45056
    v_mfma_f32_16x16x32_bf16 v[112:115], a[100:103], a[216:219], v[112:115]
    v_mfma_f32_16x16x32_bf16 v[144:147], a[100:103], a[220:223], v[144:147]
    v_mfma_f32_16x16x32_bf16 v[144:147], a[96:99], a[204:207], v[144:147]
    s_waitcnt lgkmcnt(4)
    v_mfma_f32_16x16x32_bf16 v[148:151], a[104:107], a[204:207], v[148:151]
    v_mfma_f32_16x16x32_bf16 v[148:151], a[108:111], a[220:223], v[148:151]
    ds_read_b64_tr_b16 a[120:121], v20 offset:32776
    ds_read_b64_tr_b16 a[122:123], v20 offset:36872
    v_mfma_f32_16x16x32_bf16 v[116:119], a[108:111], a[216:219], v[116:119]
    buffer_load_dwordx4 a[140:143], v9, s[24:27], s44 offen offset:0 sc1
    v_mfma_f32_16x16x32_bf16 v[116:119], a[104:107], a[200:203], v[116:119]
    v_mfma_f32_16x16x32_bf16 v[84:87], a[104:107], a[196:199], v[84:87]
    ds_read_b64_tr_b16 a[124:125], v20 offset:40968
    ds_read_b64_tr_b16 a[126:127], v20 offset:45064
    v_mfma_f32_16x16x32_bf16 v[84:87], a[108:111], a[212:215], v[84:87]
    v_mfma_f32_16x16x32_bf16 v[52:55], a[108:111], a[208:211], v[52:55]
    v_mfma_f32_16x16x32_bf16 v[52:55], a[104:107], a[192:195], v[52:55]
    s_waitcnt lgkmcnt(4)
    v_mfma_f32_16x16x32_bf16 v[56:59], a[112:115], a[192:195], v[56:59]
    buffer_load_dwordx4 a[144:147], v9, s[24:27], s41 offen offset:1024 sc1
    v_mfma_f32_16x16x32_bf16 v[56:59], a[116:119], a[208:211], v[56:59]
    ds_read_b64_tr_b16 a[96:97], v21 offset:32768
    ds_read_b64_tr_b16 a[98:99], v21 offset:34304
    v_mfma_f32_16x16x32_bf16 v[88:91], a[116:119], a[212:215], v[88:91]
    v_mfma_f32_16x16x32_bf16 v[88:91], a[112:115], a[196:199], v[88:91]
    v_mfma_f32_16x16x32_bf16 v[120:123], a[112:115], a[200:203], v[120:123]
    ds_read_b64_tr_b16 a[100:101], v21 offset:35840
    ds_read_b64_tr_b16 a[102:103], v21 offset:37376
    v_mfma_f32_16x16x32_bf16 v[120:123], a[116:119], a[216:219], v[120:123]
    v_mfma_f32_16x16x32_bf16 v[152:155], a[116:119], a[220:223], v[152:155]
    buffer_load_dwordx4 a[148:151], v9, s[24:27], s42 offen offset:1024 sc1
    v_mfma_f32_16x16x32_bf16 v[152:155], a[112:115], a[204:207], v[152:155]
    s_waitcnt lgkmcnt(4)
    v_mfma_f32_16x16x32_bf16 v[156:159], a[120:123], a[204:207], v[156:159]
    v_mfma_f32_16x16x32_bf16 v[156:159], a[124:127], a[220:223], v[156:159]
    ds_read_b64_tr_b16 a[104:105], v21 offset:38912
    ds_read_b64_tr_b16 a[106:107], v21 offset:40448
    v_mfma_f32_16x16x32_bf16 v[124:127], a[124:127], a[216:219], v[124:127]
    v_mfma_f32_16x16x32_bf16 v[124:127], a[120:123], a[200:203], v[124:127]
    v_mfma_f32_16x16x32_bf16 v[92:95], a[120:123], a[196:199], v[92:95]
    ds_read_b64_tr_b16 a[108:109], v21 offset:41984
    ds_read_b64_tr_b16 a[110:111], v21 offset:43520
    v_mfma_f32_16x16x32_bf16 v[92:95], a[124:127], a[212:215], v[92:95]
    buffer_load_dwordx4 a[152:155], v9, s[24:27], s43 offen offset:1024 sc1
    v_mfma_f32_16x16x32_bf16 v[60:63], a[124:127], a[208:211], v[60:63]
    v_mfma_f32_16x16x32_bf16 v[60:63], a[120:123], a[192:195], v[60:63]
    s_waitcnt lgkmcnt(4)
    v_mfma_f32_16x16x32_bf16 v[160:163], a[96:99], a[192:195], v[160:163]
    v_mfma_f32_16x16x32_bf16 v[160:163], a[100:103], a[208:211], v[160:163]
    s_barrier
    ds_read_b64_tr_b16 a[112:113], v21 offset:32800
    ds_read_b64_tr_b16 a[114:115], v21 offset:34336
    v_mfma_f32_16x16x32_bf16 v[164:167], a[100:103], a[212:215], v[164:167]
    v_mfma_f32_16x16x32_bf16 v[164:167], a[96:99], a[196:199], v[164:167]
    buffer_load_dwordx4 a[156:159], v9, s[24:27], s44 offen offset:1024 sc1
    v_mfma_f32_16x16x32_bf16 v[168:171], a[96:99], a[200:203], v[168:171]
    s_lshr_b32 s49, s2, 3
    ds_read_b64_tr_b16 a[116:117], v21 offset:35872
    ds_read_b64_tr_b16 a[118:119], v21 offset:37408
    v_mfma_f32_16x16x32_bf16 v[168:171], a[100:103], a[216:219], v[168:171]
    s_lshl_b32 s49, s49, 2
    v_mfma_f32_16x16x32_bf16 v[172:175], a[100:103], a[220:223], v[172:175]
    s_add_u32 s49, s49, s36
    v_mfma_f32_16x16x32_bf16 v[172:175], a[96:99], a[204:207], v[172:175]
    s_waitcnt lgkmcnt(4)
    v_mfma_f32_16x16x32_bf16 v[188:191], a[104:107], a[204:207], v[188:191]
    s_lshl_b32 s49, s49, 8
    v_mfma_f32_16x16x32_bf16 v[188:191], a[108:111], a[220:223], v[188:191]
    s_getpc_b64 s[84:85]
    ds_read_b64_tr_b16 a[120:121], v21 offset:38944
    ds_read_b64_tr_b16 a[122:123], v21 offset:40480
    v_mfma_f32_16x16x32_bf16 v[184:187], a[108:111], a[216:219], v[184:187]
    v_and_b32 v22, 1, v0
    v_lshl_add_u32 v22, v22, 7, s49
    v_mfma_f32_16x16x32_bf16 v[184:187], a[104:107], a[200:203], v[184:187]
    v_add_co_u32 v22, vcc, s84, v22
    v_mov_b32 v23, s85
    v_mfma_f32_16x16x32_bf16 v[180:183], a[104:107], a[196:199], v[180:183]
    ds_read_b64_tr_b16 a[124:125], v21 offset:42016
    ds_read_b64_tr_b16 a[126:127], v21 offset:43552
    v_mfma_f32_16x16x32_bf16 v[180:183], a[108:111], a[212:215], v[180:183]
    v_nop
    v_addc_co_u32 v23, vcc, 0, v23, vcc
    v_mfma_f32_16x16x32_bf16 v[176:179], a[108:111], a[208:211], v[176:179]
    global_load_dword v8, v[22:23], off
    v_mfma_f32_16x16x32_bf16 v[176:179], a[104:107], a[192:195], v[176:179]
    s_waitcnt lgkmcnt(4)
    v_mfma_f32_16x16x32_bf16 v[192:195], a[112:115], a[192:195], v[192:195]
    s_add_u32 m0, s40, 0
    v_mfma_f32_16x16x32_bf16 v[192:195], a[116:119], a[208:211], v[192:195]
    s_mul_i32 s49, s3, 176128
    ds_read_b64_tr_b16 a[96:97], v21 offset:32832
    ds_read_b64_tr_b16 a[98:99], v21 offset:34368
    v_mfma_f32_16x16x32_bf16 v[196:199], a[116:119], a[212:215], v[196:199]
    v_mfma_f32_16x16x32_bf16 v[196:199], a[112:115], a[196:199], v[196:199]
    v_mfma_f32_16x16x32_bf16 v[200:203], a[112:115], a[200:203], v[200:203]
    ds_read_b64_tr_b16 a[100:101], v21 offset:35904
    ds_read_b64_tr_b16 a[102:103], v21 offset:37440
    v_mfma_f32_16x16x32_bf16 v[200:203], a[116:119], a[216:219], v[200:203]
    buffer_load_dwordx4 v14, s[20:23], s49 offen offset:0 lds
    v_mfma_f32_16x16x32_bf16 v[204:207], a[116:119], a[220:223], v[204:207]
    v_mfma_f32_16x16x32_bf16 v[204:207], a[112:115], a[204:207], v[204:207]
    s_waitcnt lgkmcnt(4)
    v_mfma_f32_16x16x32_bf16 v[220:223], a[120:123], a[204:207], v[220:223]
    v_mfma_f32_16x16x32_bf16 v[220:223], a[124:127], a[220:223], v[220:223]
    ds_read_b64_tr_b16 a[104:105], v21 offset:38976
    ds_read_b64_tr_b16 a[106:107], v21 offset:40512
    v_mfma_f32_16x16x32_bf16 v[216:219], a[124:127], a[216:219], v[216:219]
    v_mfma_f32_16x16x32_bf16 v[216:219], a[120:123], a[200:203], v[216:219]
    buffer_load_dwordx4 v15, s[20:23], s49 offen offset:1024 lds
    v_mfma_f32_16x16x32_bf16 v[212:215], a[120:123], a[196:199], v[212:215]
    ds_read_b64_tr_b16 a[108:109], v21 offset:42048
    ds_read_b64_tr_b16 a[110:111], v21 offset:43584
    v_mfma_f32_16x16x32_bf16 v[212:215], a[124:127], a[212:215], v[212:215]
    v_mfma_f32_16x16x32_bf16 v[208:211], a[124:127], a[208:211], v[208:211]
    v_mfma_f32_16x16x32_bf16 v[208:211], a[120:123], a[192:195], v[208:211]
    s_waitcnt lgkmcnt(4)
    v_mfma_f32_16x16x32_bf16 v[224:227], a[96:99], a[192:195], v[224:227]
    s_waitcnt vmcnt(11)
    v_mfma_f32_16x16x32_bf16 v[224:227], a[100:103], a[208:211], v[224:227]
    s_barrier
    ds_read_b64_tr_b16 a[112:113], v17 offset:49152
    ds_read_b64_tr_b16 a[114:115], v17 offset:53248
    v_mfma_f32_16x16x32_bf16 v[228:231], a[100:103], a[212:215], v[228:231]
    buffer_load_dwordx4 v16, s[20:23], s49 offen offset:2048 lds
    v_mfma_f32_16x16x32_bf16 v[228:231], a[96:99], a[196:199], v[228:231]
    s_add_u32 s3, s3, 1
    v_mfma_f32_16x16x32_bf16 v[232:235], a[96:99], a[200:203], v[232:235]
    s_and_b32 s3, s3, 7
    ds_read_b64_tr_b16 a[116:117], v17 offset:57344
    ds_read_b64_tr_b16 a[118:119], v17 offset:61440
    v_mfma_f32_16x16x32_bf16 v[232:235], a[100:103], a[216:219], v[232:235]
    s_add_u32 m0, s40, 16384
    v_mfma_f32_16x16x32_bf16 v[236:239], a[100:103], a[220:223], v[236:239]
    s_mul_i32 s49, s3, 176128
    v_mfma_f32_16x16x32_bf16 v[236:239], a[96:99], a[204:207], v[236:239]
    s_waitcnt lgkmcnt(4)
    v_mfma_f32_16x16x32_bf16 v[252:255], a[104:107], a[204:207], v[252:255]
    buffer_load_dwordx4 v14, s[20:23], s49 offen offset:0 lds
    v_mfma_f32_16x16x32_bf16 v[252:255], a[108:111], a[220:223], v[252:255]
    ds_read_b64_tr_b16 a[120:121], v17 offset:49160
    ds_read_b64_tr_b16 a[122:123], v17 offset:53256
    v_mfma_f32_16x16x32_bf16 v[248:251], a[108:111], a[216:219], v[248:251]
    v_mfma_f32_16x16x32_bf16 v[248:251], a[104:107], a[200:203], v[248:251]
    v_mfma_f32_16x16x32_bf16 v[244:247], a[104:107], a[196:199], v[244:247]
    ds_read_b64_tr_b16 a[124:125], v17 offset:57352
    ds_read_b64_tr_b16 a[126:127], v17 offset:61448
    v_mfma_f32_16x16x32_bf16 v[244:247], a[108:111], a[212:215], v[244:247]
    v_mfma_f32_16x16x32_bf16 v[240:243], a[108:111], a[208:211], v[240:243]
    buffer_load_dwordx4 v15, s[20:23], s49 offen offset:1024 lds
    v_mfma_f32_16x16x32_bf16 v[240:243], a[104:107], a[192:195], v[240:243]
    s_waitcnt vmcnt(17) lgkmcnt(4)
    v_mfma_f32_16x16x32_bf16 v[32:35], a[112:115], a[224:227], v[32:35]
    v_mfma_f32_16x16x32_bf16 v[32:35], a[116:119], a[240:243], v[32:35]
    ds_read_b64_tr_b16 a[96:97], v18 offset:49152
    ds_read_b64_tr_b16 a[98:99], v18 offset:53248
    v_mfma_f32_16x16x32_bf16 v[64:67], a[116:119], a[244:247], v[64:67]
    v_mfma_f32_16x16x32_bf16 v[64:67], a[112:115], a[228:231], v[64:67]
    v_mfma_f32_16x16x32_bf16 v[96:99], a[112:115], a[232:235], v[96:99]
    ds_read_b64_tr_b16 a[100:101], v18 offset:57344
    ds_read_b64_tr_b16 a[102:103], v18 offset:61440
    v_mfma_f32_16x16x32_bf16 v[96:99], a[116:119], a[248:251], v[96:99]
    buffer_load_dwordx4 v16, s[20:23], s49 offen offset:2048 lds
    v_mfma_f32_16x16x32_bf16 v[128:131], a[116:119], a[252:255], v[128:131]
    s_add_u32 s3, s3, 1
    v_mfma_f32_16x16x32_bf16 v[128:131], a[112:115], a[236:239], v[128:131]
    s_waitcnt lgkmcnt(4)
    v_mfma_f32_16x16x32_bf16 v[132:135], a[120:123], a[236:239], v[132:135]
    s_and_b32 s3, s3, 7
    v_mfma_f32_16x16x32_bf16 v[132:135], a[124:127], a[252:255], v[132:135]
    s_lshl_b32 s41, s55, 11
    ds_read_b64_tr_b16 a[104:105], v18 offset:49160
    ds_read_b64_tr_b16 a[106:107], v18 offset:53256
    v_mfma_f32_16x16x32_bf16 v[100:103], a[124:127], a[248:251], v[100:103]
    s_add_u32 s42, s41, 16384
    v_mfma_f32_16x16x32_bf16 v[100:103], a[120:123], a[232:235], v[100:103]
    s_add_u32 s43, s41, 32768
    v_mfma_f32_16x16x32_bf16 v[68:71], a[120:123], a[228:231], v[68:71]
    s_add_u32 s44, s41, 49152
    ds_read_b64_tr_b16 a[108:109], v18 offset:57352
    ds_read_b64_tr_b16 a[110:111], v18 offset:61448
    v_mfma_f32_16x16x32_bf16 v[68:71], a[124:127], a[244:247], v[68:71]
    s_add_u32 s55, s55, 1
    v_mfma_f32_16x16x32_bf16 v[36:39], a[124:127], a[240:243], v[36:39]
    s_and_b32 s55, s55, 7
    buffer_load_dwordx4 a[160:163], v9, s[24:27], s41 offen offset:0 sc1
    v_mfma_f32_16x16x32_bf16 v[36:39], a[120:123], a[224:227], v[36:39]
    s_waitcnt lgkmcnt(4)
    v_mfma_f32_16x16x32_bf16 v[40:43], a[96:99], a[224:227], v[40:43]
    v_mfma_f32_16x16x32_bf16 v[40:43], a[100:103], a[240:243], v[40:43]
    ds_read_b64_tr_b16 a[112:113], v19 offset:49152
    ds_read_b64_tr_b16 a[114:115], v19 offset:53248
    v_mfma_f32_16x16x32_bf16 v[72:75], a[100:103], a[244:247], v[72:75]
    v_mfma_f32_16x16x32_bf16 v[72:75], a[96:99], a[228:231], v[72:75]
    v_mfma_f32_16x16x32_bf16 v[104:107], a[96:99], a[232:235], v[104:107]
    ds_read_b64_tr_b16 a[116:117], v19 offset:57344
    ds_read_b64_tr_b16 a[118:119], v19 offset:61440
    v_mfma_f32_16x16x32_bf16 v[104:107], a[100:103], a[248:251], v[104:107]
    buffer_load_dwordx4 a[164:167], v9, s[24:27], s42 offen offset:0 sc1
    v_mfma_f32_16x16x32_bf16 v[136:139], a[100:103], a[252:255], v[136:139]
    v_mfma_f32_16x16x32_bf16 v[136:139], a[96:99], a[236:239], v[136:139]
    s_waitcnt lgkmcnt(4)
    v_mfma_f32_16x16x32_bf16 v[140:143], a[104:107], a[236:239], v[140:143]
    v_mfma_f32_16x16x32_bf16 v[140:143], a[108:111], a[252:255], v[140:143]
    ds_read_b64_tr_b16 a[120:121], v19 offset:49160
    ds_read_b64_tr_b16 a[122:123], v19 offset:53256
    v_mfma_f32_16x16x32_bf16 v[108:111], a[108:111], a[248:251], v[108:111]
    v_mfma_f32_16x16x32_bf16 v[108:111], a[104:107], a[232:235], v[108:111]
    buffer_load_dwordx4 a[168:171], v9, s[24:27], s43 offen offset:0 sc1
    v_mfma_f32_16x16x32_bf16 v[76:79], a[104:107], a[228:231], v[76:79]
    ds_read_b64_tr_b16 a[124:125], v19 offset:57352
    ds_read_b64_tr_b16 a[126:127], v19 offset:61448
    v_mfma_f32_16x16x32_bf16 v[76:79], a[108:111], a[244:247], v[76:79]
    v_mfma_f32_16x16x32_bf16 v[44:47], a[108:111], a[240:243], v[44:47]
    v_mfma_f32_16x16x32_bf16 v[44:47], a[104:107], a[224:227], v[44:47]
    s_waitcnt lgkmcnt(4)
    v_mfma_f32_16x16x32_bf16 v[48:51], a[112:115], a[224:227], v[48:51]
    v_mfma_f32_16x16x32_bf16 v[48:51], a[116:119], a[240:243], v[48:51]
    ds_read_b64_tr_b16 a[96:97], v20 offset:49152
    ds_read_b64_tr_b16 a[98:99], v20 offset:53248
    v_mfma_f32_16x16x32_bf16 v[80:83], a[116:119], a[244:247], v[80:83]
    buffer_load_dwordx4 a[172:175], v9, s[24:27], s44 offen offset:0 sc1
    v_mfma_f32_16x16x32_bf16 v[80:83], a[112:115], a[228:231], v[80:83]
    v_mfma_f32_16x16x32_bf16 v[112:115], a[112:115], a[232:235], v[112:115]
    ds_read_b64_tr_b16 a[100:101], v20 offset:57344
    ds_read_b64_tr_b16 a[102:103], v20 offset:61440
    v_mfma_f32_16x16x32_bf16 v[112:115], a[116:119], a[248:251], v[112:115]
    v_mfma_f32_16x16x32_bf16 v[144:147], a[116:119], a[252:255], v[144:147]
    v_mfma_f32_16x16x32_bf16 v[144:147], a[112:115], a[236:239], v[144:147]
    s_waitcnt lgkmcnt(4)
    v_mfma_f32_16x16x32_bf16 v[148:151], a[120:123], a[236:239], v[148:151]
    buffer_load_dwordx4 a[176:179], v9, s[24:27], s41 offen offset:1024 sc1
    v_mfma_f32_16x16x32_bf16 v[148:151], a[124:127], a[252:255], v[148:151]
    ds_read_b64_tr_b16 a[104:105], v20 offset:49160
    ds_read_b64_tr_b16 a[106:107], v20 offset:53256
    v_mfma_f32_16x16x32_bf16 v[116:119], a[124:127], a[248:251], v[116:119]
    v_mfma_f32_16x16x32_bf16 v[116:119], a[120:123], a[232:235], v[116:119]
    v_mfma_f32_16x16x32_bf16 v[84:87], a[120:123], a[228:231], v[84:87]
    ds_read_b64_tr_b16 a[108:109], v20 offset:57352
    ds_read_b64_tr_b16 a[110:111], v20 offset:61448
    v_mfma_f32_16x16x32_bf16 v[84:87], a[124:127], a[244:247], v[84:87]
    v_mfma_f32_16x16x32_bf16 v[52:55], a[124:127], a[240:243], v[52:55]
    buffer_load_dwordx4 a[180:183], v9, s[24:27], s42 offen offset:1024 sc1
    v_mfma_f32_16x16x32_bf16 v[52:55], a[120:123], a[224:227], v[52:55]
    s_waitcnt lgkmcnt(4)
    v_mfma_f32_16x16x32_bf16 v[56:59], a[96:99], a[224:227], v[56:59]
    v_mfma_f32_16x16x32_bf16 v[56:59], a[100:103], a[240:243], v[56:59]
    s_barrier
    ds_read_b64_tr_b16 a[112:113], v21 offset:49152
    ds_read_b64_tr_b16 a[114:115], v21 offset:50688
    v_mfma_f32_16x16x32_bf16 v[88:91], a[100:103], a[244:247], v[88:91]
    v_mfma_f32_16x16x32_bf16 v[88:91], a[96:99], a[228:231], v[88:91]
    v_mfma_f32_16x16x32_bf16 v[120:123], a[96:99], a[232:235], v[120:123]
    ds_read_b64_tr_b16 a[116:117], v21 offset:52224
    ds_read_b64_tr_b16 a[118:119], v21 offset:53760
    v_mfma_f32_16x16x32_bf16 v[120:123], a[100:103], a[248:251], v[120:123]
    buffer_load_dwordx4 a[184:187], v9, s[24:27], s43 offen offset:1024 sc1
    v_mfma_f32_16x16x32_bf16 v[152:155], a[100:103], a[252:255], v[152:155]
    v_mfma_f32_16x16x32_bf16 v[152:155], a[96:99], a[236:239], v[152:155]
    s_waitcnt lgkmcnt(4)
    v_mfma_f32_16x16x32_bf16 v[156:159], a[104:107], a[236:239], v[156:159]
    v_mfma_f32_16x16x32_bf16 v[156:159], a[108:111], a[252:255], v[156:159]
    ds_read_b64_tr_b16 a[120:121], v21 offset:55296
    ds_read_b64_tr_b16 a[122:123], v21 offset:56832
    v_mfma_f32_16x16x32_bf16 v[124:127], a[108:111], a[248:251], v[124:127]
    v_mfma_f32_16x16x32_bf16 v[124:127], a[104:107], a[232:235], v[124:127]
    buffer_load_dwordx4 a[188:191], v9, s[24:27], s44 offen offset:1024 sc1
    v_mfma_f32_16x16x32_bf16 v[92:95], a[104:107], a[228:231], v[92:95]
    s_lshl_b32 s41, s55, 11
    ds_read_b64_tr_b16 a[124:125], v21 offset:58368
    ds_read_b64_tr_b16 a[126:127], v21 offset:59904
    v_mfma_f32_16x16x32_bf16 v[92:95], a[108:111], a[244:247], v[92:95]
    s_add_u32 s42, s41, 16384
    v_mfma_f32_16x16x32_bf16 v[60:63], a[108:111], a[240:243], v[60:63]
    s_add_u32 s43, s41, 32768
    v_mfma_f32_16x16x32_bf16 v[60:63], a[104:107], a[224:227], v[60:63]
    s_waitcnt lgkmcnt(4)
    v_mfma_f32_16x16x32_bf16 v[160:163], a[112:115], a[224:227], v[160:163]
    s_add_u32 s44, s41, 49152
    v_mfma_f32_16x16x32_bf16 v[160:163], a[116:119], a[240:243], v[160:163]
    s_add_u32 s55, s55, 1
    ds_read_b64_tr_b16 a[96:97], v21 offset:49184
    ds_read_b64_tr_b16 a[98:99], v21 offset:50720
    v_mfma_f32_16x16x32_bf16 v[164:167], a[116:119], a[244:247], v[164:167]
    s_and_b32 s55, s55, 7
    buffer_load_dwordx4 a[192:195], v9, s[24:27], s41 offen offset:0 sc1
    v_mfma_f32_16x16x32_bf16 v[164:167], a[112:115], a[228:231], v[164:167]
    v_mfma_f32_16x16x32_bf16 v[168:171], a[112:115], a[232:235], v[168:171]
    ds_read_b64_tr_b16 a[100:101], v21 offset:52256
    ds_read_b64_tr_b16 a[102:103], v21 offset:53792
    v_mfma_f32_16x16x32_bf16 v[168:171], a[116:119], a[248:251], v[168:171]
    v_mfma_f32_16x16x32_bf16 v[172:175], a[116:119], a[252:255], v[172:175]
    v_mfma_f32_16x16x32_bf16 v[172:175], a[112:115], a[236:239], v[172:175]
    s_waitcnt lgkmcnt(4)
    v_mfma_f32_16x16x32_bf16 v[188:191], a[120:123], a[236:239], v[188:191]
    buffer_load_dwordx4 a[196:199], v9, s[24:27], s42 offen offset:0 sc1
    v_mfma_f32_16x16x32_bf16 v[188:191], a[124:127], a[252:255], v[188:191]
    ds_read_b64_tr_b16 a[104:105], v21 offset:55328
    ds_read_b64_tr_b16 a[106:107], v21 offset:56864
    v_mfma_f32_16x16x32_bf16 v[184:187], a[124:127], a[248:251], v[184:187]
    v_mfma_f32_16x16x32_bf16 v[184:187], a[120:123], a[232:235], v[184:187]
    v_mfma_f32_16x16x32_bf16 v[180:183], a[120:123], a[228:231], v[180:183]
    ds_read_b64_tr_b16 a[108:109], v21 offset:58400
    ds_read_b64_tr_b16 a[110:111], v21 offset:59936
    v_mfma_f32_16x16x32_bf16 v[180:183], a[124:127], a[244:247], v[180:183]
    v_mfma_f32_16x16x32_bf16 v[176:179], a[124:127], a[240:243], v[176:179]
    buffer_load_dwordx4 a[200:203], v9, s[24:27], s43 offen offset:0 sc1
    v_mfma_f32_16x16x32_bf16 v[176:179], a[120:123], a[224:227], v[176:179]
    s_waitcnt lgkmcnt(4)
    v_mfma_f32_16x16x32_bf16 v[192:195], a[96:99], a[224:227], v[192:195]
    v_mfma_f32_16x16x32_bf16 v[192:195], a[100:103], a[240:243], v[192:195]
    ds_read_b64_tr_b16 a[112:113], v21 offset:49216
    ds_read_b64_tr_b16 a[114:115], v21 offset:50752
    v_mfma_f32_16x16x32_bf16 v[196:199], a[100:103], a[244:247], v[196:199]
    v_mfma_f32_16x16x32_bf16 v[196:199], a[96:99], a[228:231], v[196:199]
    v_mfma_f32_16x16x32_bf16 v[200:203], a[96:99], a[232:235], v[200:203]
    ds_read_b64_tr_b16 a[116:117], v21 offset:52288
    ds_read_b64_tr_b16 a[118:119], v21 offset:53824
    v_mfma_f32_16x16x32_bf16 v[200:203], a[100:103], a[248:251], v[200:203]
    buffer_load_dwordx4 a[204:207], v9, s[24:27], s44 offen offset:0 sc1
    v_mfma_f32_16x16x32_bf16 v[204:207], a[100:103], a[252:255], v[204:207]
    s_add_u32 m0, s40, 32768
    v_mfma_f32_16x16x32_bf16 v[204:207], a[96:99], a[236:239], v[204:207]
    s_waitcnt lgkmcnt(4)
    v_mfma_f32_16x16x32_bf16 v[220:223], a[104:107], a[236:239], v[220:223]
    s_mul_i32 s49, s3, 176128
    v_mfma_f32_16x16x32_bf16 v[220:223], a[108:111], a[252:255], v[220:223]
    ds_read_b64_tr_b16 a[120:121], v21 offset:55360
    ds_read_b64_tr_b16 a[122:123], v21 offset:56896
    v_mfma_f32_16x16x32_bf16 v[216:219], a[108:111], a[248:251], v[216:219]
    v_mfma_f32_16x16x32_bf16 v[216:219], a[104:107], a[232:235], v[216:219]
    buffer_load_dwordx4 v14, s[20:23], s49 offen offset:0 lds
    v_mfma_f32_16x16x32_bf16 v[212:215], a[104:107], a[228:231], v[212:215]
    ds_read_b64_tr_b16 a[124:125], v21 offset:58432
    ds_read_b64_tr_b16 a[126:127], v21 offset:59968
    v_mfma_f32_16x16x32_bf16 v[212:215], a[108:111], a[244:247], v[212:215]
    v_mfma_f32_16x16x32_bf16 v[208:211], a[108:111], a[240:243], v[208:211]
    v_mfma_f32_16x16x32_bf16 v[208:211], a[104:107], a[224:227], v[208:211]
    s_waitcnt lgkmcnt(4)
    v_mfma_f32_16x16x32_bf16 v[224:227], a[112:115], a[224:227], v[224:227]
    s_waitcnt vmcnt(16)
    v_mfma_f32_16x16x32_bf16 v[224:227], a[116:119], a[240:243], v[224:227]
    s_barrier
    ds_read_b64_tr_b16 a[96:97], v21 offset:0
    ds_read_b64_tr_b16 a[98:99], v21 offset:1536
    v_mfma_f32_16x16x32_bf16 v[228:231], a[116:119], a[244:247], v[228:231]
    buffer_load_dwordx4 v15, s[20:23], s49 offen offset:1024 lds
    v_mfma_f32_16x16x32_bf16 v[228:231], a[112:115], a[228:231], v[228:231]
    v_mfma_f32_16x16x32_bf16 v[232:235], a[112:115], a[232:235], v[232:235]
    ds_read_b64_tr_b16 a[100:101], v21 offset:3072
    ds_read_b64_tr_b16 a[102:103], v21 offset:4608
    v_mfma_f32_16x16x32_bf16 v[232:235], a[116:119], a[248:251], v[232:235]
    v_mfma_f32_16x16x32_bf16 v[236:239], a[116:119], a[252:255], v[236:239]
    v_mfma_f32_16x16x32_bf16 v[236:239], a[112:115], a[236:239], v[236:239]
    s_waitcnt lgkmcnt(4)
    v_mfma_f32_16x16x32_bf16 v[252:255], a[120:123], a[236:239], v[252:255]
    v_mfma_f32_16x16x32_bf16 v[252:255], a[124:127], a[252:255], v[252:255]
    s_barrier
    ds_read_b64_tr_b16 a[104:105], v21 offset:6144
    ds_read_b64_tr_b16 a[106:107], v21 offset:7680
    v_mfma_f32_16x16x32_bf16 v[248:251], a[124:127], a[248:251], v[248:251]
    buffer_load_dwordx4 v16, s[20:23], s49 offen offset:2048 lds
    v_mfma_f32_16x16x32_bf16 v[248:251], a[120:123], a[232:235], v[248:251]
    s_add_u32 s3, s3, 1
    v_mfma_f32_16x16x32_bf16 v[244:247], a[120:123], a[228:231], v[244:247]
    s_and_b32 s3, s3, 7
    ds_read_b64_tr_b16 a[108:109], v21 offset:9216
    ds_read_b64_tr_b16 a[110:111], v21 offset:10752
    v_mfma_f32_16x16x32_bf16 v[244:247], a[124:127], a[244:247], v[244:247]
    v_mfma_f32_16x16x32_bf16 v[240:243], a[124:127], a[240:243], v[240:243]
    v_mfma_f32_16x16x32_bf16 v[240:243], a[120:123], a[224:227], v[240:243]
    s_waitcnt vmcnt(22) lgkmcnt(4)
    v_mfma_f32_16x16x32_bf16 v[160:163], a[96:99], a[128:131], v[160:163]
    buffer_load_dwordx4 a[208:211], v9, s[24:27], s41 offen offset:1024 sc1
    v_mfma_f32_16x16x32_bf16 v[160:163], a[100:103], a[144:147], v[160:163]
    ds_read_b64_tr_b16 a[112:113], v21 offset:32
    ds_read_b64_tr_b16 a[114:115], v21 offset:1568
    v_mfma_f32_16x16x32_bf16 v[164:167], a[100:103], a[148:151], v[164:167]
    v_mfma_f32_16x16x32_bf16 v[164:167], a[96:99], a[132:135], v[164:167]
    v_mfma_f32_16x16x32_bf16 v[168:171], a[96:99], a[136:139], v[168:171]
    ds_read_b64_tr_b16 a[116:117], v21 offset:3104
    ds_read_b64_tr_b16 a[118:119], v21 offset:4640
    v_mfma_f32_16x16x32_bf16 v[168:171], a[100:103], a[152:155], v[168:171]
    buffer_load_dwordx4 a[212:215], v9, s[24:27], s42 offen offset:1024 sc1
    v_mfma_f32_16x16x32_bf16 v[172:175], a[100:103], a[156:159], v[172:175]
    v_mfma_f32_16x16x32_bf16 v[172:175], a[96:99], a[140:143], v[172:175]
    s_waitcnt lgkmcnt(4)
    v_mfma_f32_16x16x32_bf16 v[188:191], a[104:107], a[140:143], v[188:191]
    v_mfma_f32_16x16x32_bf16 v[188:191], a[108:111], a[156:159], v[188:191]
    ds_read_b64_tr_b16 a[120:121], v21 offset:6176
    ds_read_b64_tr_b16 a[122:123], v21 offset:7712
    v_mfma_f32_16x16x32_bf16 v[184:187], a[108:111], a[152:155], v[184:187]
    buffer_load_dwordx4 a[216:219], v9, s[24:27], s43 offen offset:1024 sc1
    v_mfma_f32_16x16x32_bf16 v[184:187], a[104:107], a[136:139], v[184:187]
    v_mfma_f32_16x16x32_bf16 v[180:183], a[104:107], a[132:135], v[180:183]
    ds_read_b64_tr_b16 a[124:125], v21 offset:9248
    ds_read_b64_tr_b16 a[126:127], v21 offset:10784
    v_mfma_f32_16x16x32_bf16 v[180:183], a[108:111], a[148:151], v[180:183]
    v_mfma_f32_16x16x32_bf16 v[176:179], a[108:111], a[144:147], v[176:179]
    buffer_load_dwordx4 a[220:223], v9, s[24:27], s44 offen offset:1024 sc1
    v_mfma_f32_16x16x32_bf16 v[176:179], a[104:107], a[128:131], v[176:179]
    s_waitcnt lgkmcnt(4)
    v_mfma_f32_16x16x32_bf16 v[192:195], a[112:115], a[128:131], v[192:195]
    s_add_u32 m0, s40, 49152
    v_mfma_f32_16x16x32_bf16 v[192:195], a[116:119], a[144:147], v[192:195]
    s_mul_i32 s49, s3, 176128
    ds_read_b64_tr_b16 a[96:97], v21 offset:64
    ds_read_b64_tr_b16 a[98:99], v21 offset:1600
    v_mfma_f32_16x16x32_bf16 v[196:199], a[116:119], a[148:151], v[196:199]
    buffer_load_dwordx4 v14, s[20:23], s49 offen offset:0 lds
    v_mfma_f32_16x16x32_bf16 v[196:199], a[112:115], a[132:135], v[196:199]
    v_mfma_f32_16x16x32_bf16 v[200:203], a[112:115], a[136:139], v[200:203]
    ds_read_b64_tr_b16 a[100:101], v21 offset:3136
    ds_read_b64_tr_b16 a[102:103], v21 offset:4672
    v_mfma_f32_16x16x32_bf16 v[200:203], a[116:119], a[152:155], v[200:203]
    v_mfma_f32_16x16x32_bf16 v[204:207], a[116:119], a[156:159], v[204:207]
    buffer_load_dwordx4 v15, s[20:23], s49 offen offset:1024 lds
    v_mfma_f32_16x16x32_bf16 v[204:207], a[112:115], a[140:143], v[204:207]
    s_waitcnt lgkmcnt(4)
    v_mfma_f32_16x16x32_bf16 v[220:223], a[120:123], a[140:143], v[220:223]
    v_mfma_f32_16x16x32_bf16 v[220:223], a[124:127], a[156:159], v[220:223]
    ds_read_b64_tr_b16 a[104:105], v21 offset:6208
    ds_read_b64_tr_b16 a[106:107], v21 offset:7744
    v_mfma_f32_16x16x32_bf16 v[216:219], a[124:127], a[152:155], v[216:219]
    buffer_load_dwordx4 v16, s[20:23], s49 offen offset:2048 lds
    v_mfma_f32_16x16x32_bf16 v[216:219], a[120:123], a[136:139], v[216:219]
    s_add_u32 s3, s3, 1
    v_mfma_f32_16x16x32_bf16 v[212:215], a[120:123], a[132:135], v[212:215]
    s_and_b32 s3, s3, 7
    ds_read_b64_tr_b16 a[108:109], v21 offset:9280
    ds_read_b64_tr_b16 a[110:111], v21 offset:10816
    v_mfma_f32_16x16x32_bf16 v[212:215], a[124:127], a[148:151], v[212:215]
    s_lshl_b32 s41, s55, 11
    v_mfma_f32_16x16x32_bf16 v[208:211], a[124:127], a[144:147], v[208:211]
    s_add_u32 s42, s41, 16384
    v_mfma_f32_16x16x32_bf16 v[208:211], a[120:123], a[128:131], v[208:211]
    s_waitcnt lgkmcnt(4)
    v_mfma_f32_16x16x32_bf16 v[224:227], a[96:99], a[128:131], v[224:227]
    s_waitcnt vmcnt(22)
    v_mfma_f32_16x16x32_bf16 v[224:227], a[100:103], a[144:147], v[224:227]
    s_barrier
    ds_read_b64_tr_b16 a[112:113], v21 offset:16384
    ds_read_b64_tr_b16 a[114:115], v21 offset:17920
    v_mfma_f32_16x16x32_bf16 v[228:231], a[100:103], a[148:151], v[228:231]
    s_add_u32 s43, s41, 32768
    v_mfma_f32_16x16x32_bf16 v[228:231], a[96:99], a[132:135], v[228:231]
    s_add_u32 s44, s41, 49152
    v_mfma_f32_16x16x32_bf16 v[232:235], a[96:99], a[136:139], v[232:235]
    s_add_u32 s55, s55, 1
    ds_read_b64_tr_b16 a[116:117], v21 offset:19456
    ds_read_b64_tr_b16 a[118:119], v21 offset:20992
    v_mfma_f32_16x16x32_bf16 v[232:235], a[100:103], a[152:155], v[232:235]
    s_and_b32 s55, s55, 7
    buffer_load_dwordx4 a[224:227], v9, s[24:27], s41 offen offset:0 sc1
    v_mfma_f32_16x16x32_bf16 v[236:239], a[100:103], a[156:159], v[236:239]
    v_mfma_f32_16x16x32_bf16 v[236:239], a[96:99], a[140:143], v[236:239]
    s_waitcnt lgkmcnt(4)
    v_mfma_f32_16x16x32_bf16 v[252:255], a[104:107], a[140:143], v[252:255]
    v_mfma_f32_16x16x32_bf16 v[252:255], a[108:111], a[156:159], v[252:255]
    ds_read_b64_tr_b16 a[120:121], v21 offset:22528
    ds_read_b64_tr_b16 a[122:123], v21 offset:24064
    v_mfma_f32_16x16x32_bf16 v[248:251], a[108:111], a[152:155], v[248:251]
    buffer_load_dwordx4 a[228:231], v9, s[24:27], s42 offen offset:0 sc1
    v_mfma_f32_16x16x32_bf16 v[248:251], a[104:107], a[136:139], v[248:251]
    v_mfma_f32_16x16x32_bf16 v[244:247], a[104:107], a[132:135], v[244:247]
    ds_read_b64_tr_b16 a[124:125], v21 offset:25600
    ds_read_b64_tr_b16 a[126:127], v21 offset:27136
    v_mfma_f32_16x16x32_bf16 v[244:247], a[108:111], a[148:151], v[244:247]
    v_mfma_f32_16x16x32_bf16 v[240:243], a[108:111], a[144:147], v[240:243]
    buffer_load_dwordx4 a[232:235], v9, s[24:27], s43 offen offset:0 sc1
    v_mfma_f32_16x16x32_bf16 v[240:243], a[104:107], a[128:131], v[240:243]
    s_waitcnt vmcnt(17) lgkmcnt(4)
    v_mfma_f32_16x16x32_bf16 v[160:163], a[112:115], a[160:163], v[160:163]
    v_mfma_f32_16x16x32_bf16 v[160:163], a[116:119], a[176:179], v[160:163]
    ds_read_b64_tr_b16 a[96:97], v21 offset:16416
    ds_read_b64_tr_b16 a[98:99], v21 offset:17952
    v_mfma_f32_16x16x32_bf16 v[164:167], a[116:119], a[180:183], v[164:167]
    buffer_load_dwordx4 a[236:239], v9, s[24:27], s44 offen offset:0 sc1
    v_mfma_f32_16x16x32_bf16 v[164:167], a[112:115], a[164:167], v[164:167]
    v_mfma_f32_16x16x32_bf16 v[168:171], a[112:115], a[168:171], v[168:171]
    ds_read_b64_tr_b16 a[100:101], v21 offset:19488
    ds_read_b64_tr_b16 a[102:103], v21 offset:21024
    v_mfma_f32_16x16x32_bf16 v[168:171], a[116:119], a[184:187], v[168:171]
    v_mfma_f32_16x16x32_bf16 v[172:175], a[116:119], a[188:191], v[172:175]
    buffer_load_dwordx4 a[240:243], v9, s[24:27], s41 offen offset:1024 sc1
    v_mfma_f32_16x16x32_bf16 v[172:175], a[112:115], a[172:175], v[172:175]
    s_waitcnt lgkmcnt(4)
    v_mfma_f32_16x16x32_bf16 v[188:191], a[120:123], a[172:175], v[188:191]
    v_mfma_f32_16x16x32_bf16 v[188:191], a[124:127], a[188:191], v[188:191]
    ds_read_b64_tr_b16 a[104:105], v21 offset:22560
    ds_read_b64_tr_b16 a[106:107], v21 offset:24096
    v_mfma_f32_16x16x32_bf16 v[184:187], a[124:127], a[184:187], v[184:187]
    buffer_load_dwordx4 a[244:247], v9, s[24:27], s42 offen offset:1024 sc1
    v_mfma_f32_16x16x32_bf16 v[184:187], a[120:123], a[168:171], v[184:187]
    v_mfma_f32_16x16x32_bf16 v[180:183], a[120:123], a[164:167], v[180:183]
    ds_read_b64_tr_b16 a[108:109], v21 offset:25632
    ds_read_b64_tr_b16 a[110:111], v21 offset:27168
    v_mfma_f32_16x16x32_bf16 v[180:183], a[124:127], a[180:183], v[180:183]
    v_mfma_f32_16x16x32_bf16 v[176:179], a[124:127], a[176:179], v[176:179]
    buffer_load_dwordx4 a[248:251], v9, s[24:27], s43 offen offset:1024 sc1
    v_mfma_f32_16x16x32_bf16 v[176:179], a[120:123], a[160:163], v[176:179]
    s_waitcnt lgkmcnt(4)
    v_mfma_f32_16x16x32_bf16 v[192:195], a[96:99], a[160:163], v[192:195]
    v_mfma_f32_16x16x32_bf16 v[192:195], a[100:103], a[176:179], v[192:195]
    ds_read_b64_tr_b16 a[112:113], v21 offset:16448
    ds_read_b64_tr_b16 a[114:115], v21 offset:17984
    v_mfma_f32_16x16x32_bf16 v[196:199], a[100:103], a[180:183], v[196:199]
    buffer_load_dwordx4 a[252:255], v9, s[24:27], s44 offen offset:1024 sc1
    v_mfma_f32_16x16x32_bf16 v[196:199], a[96:99], a[164:167], v[196:199]
    s_add_u32 m0, s39, 0
    v_mfma_f32_16x16x32_bf16 v[200:203], a[96:99], a[168:171], v[200:203]
    s_lshl_b32 s49, s54, 19
    ds_read_b64_tr_b16 a[116:117], v21 offset:19520
    ds_read_b64_tr_b16 a[118:119], v21 offset:21056
    v_mfma_f32_16x16x32_bf16 v[200:203], a[100:103], a[184:187], v[200:203]
    v_mfma_f32_16x16x32_bf16 v[204:207], a[100:103], a[188:191], v[204:207]
    buffer_load_dwordx4 v10, s[16:19], s49 offen offset:0 lds
    v_mfma_f32_16x16x32_bf16 v[204:207], a[96:99], a[172:175], v[204:207]
    s_waitcnt lgkmcnt(4)
    v_mfma_f32_16x16x32_bf16 v[220:223], a[104:107], a[172:175], v[220:223]
    v_mfma_f32_16x16x32_bf16 v[220:223], a[108:111], a[188:191], v[220:223]
    ds_read_b64_tr_b16 a[120:121], v21 offset:22592
    ds_read_b64_tr_b16 a[122:123], v21 offset:24128
    v_mfma_f32_16x16x32_bf16 v[216:219], a[108:111], a[184:187], v[216:219]
    buffer_load_dwordx4 v11, s[16:19], s49 offen offset:1024 lds
    v_mfma_f32_16x16x32_bf16 v[216:219], a[104:107], a[168:171], v[216:219]
    v_mfma_f32_16x16x32_bf16 v[212:215], a[104:107], a[164:167], v[212:215]
    ds_read_b64_tr_b16 a[124:125], v21 offset:25664
    ds_read_b64_tr_b16 a[126:127], v21 offset:27200
    v_mfma_f32_16x16x32_bf16 v[212:215], a[108:111], a[180:183], v[212:215]
    v_mfma_f32_16x16x32_bf16 v[208:211], a[108:111], a[176:179], v[208:211]
    buffer_load_dwordx4 v12, s[16:19], s49 offen offset:2048 lds
    v_mfma_f32_16x16x32_bf16 v[208:211], a[104:107], a[160:163], v[208:211]
    s_waitcnt lgkmcnt(4)
    v_mfma_f32_16x16x32_bf16 v[224:227], a[112:115], a[160:163], v[224:227]
    s_waitcnt vmcnt(18)
    v_mfma_f32_16x16x32_bf16 v[224:227], a[116:119], a[176:179], v[224:227]
    s_barrier
    ds_read_b64_tr_b16 a[96:97], v21 offset:32768
    ds_read_b64_tr_b16 a[98:99], v21 offset:34304
    v_mfma_f32_16x16x32_bf16 v[228:231], a[116:119], a[180:183], v[228:231]
    buffer_load_dwordx4 v13, s[16:19], s49 offen offset:3072 lds
    v_mfma_f32_16x16x32_bf16 v[228:231], a[112:115], a[164:167], v[228:231]
    s_add_u32 s54, s54, 1
    v_mfma_f32_16x16x32_bf16 v[232:235], a[112:115], a[168:171], v[232:235]
    s_and_b32 s54, s54, 7
    ds_read_b64_tr_b16 a[100:101], v21 offset:35840
    ds_read_b64_tr_b16 a[102:103], v21 offset:37376
    v_mfma_f32_16x16x32_bf16 v[232:235], a[116:119], a[184:187], v[232:235]
    s_add_u32 m0, s39, 16384
    v_mfma_f32_16x16x32_bf16 v[236:239], a[116:119], a[188:191], v[236:239]
    s_lshl_b32 s49, s54, 19
    buffer_load_dwordx4 v10, s[16:19], s49 offen offset:0 lds
    v_mfma_f32_16x16x32_bf16 v[236:239], a[112:115], a[172:175], v[236:239]
    s_waitcnt lgkmcnt(4)
    v_mfma_f32_16x16x32_bf16 v[252:255], a[120:123], a[172:175], v[252:255]
    v_mfma_f32_16x16x32_bf16 v[252:255], a[124:127], a[188:191], v[252:255]
    ds_read_b64_tr_b16 a[104:105], v21 offset:38912
    ds_read_b64_tr_b16 a[106:107], v21 offset:40448
    v_mfma_f32_16x16x32_bf16 v[248:251], a[124:127], a[184:187], v[248:251]
    buffer_load_dwordx4 v11, s[16:19], s49 offen offset:1024 lds
    v_mfma_f32_16x16x32_bf16 v[248:251], a[120:123], a[168:171], v[248:251]
    v_mfma_f32_16x16x32_bf16 v[244:247], a[120:123], a[164:167], v[244:247]
    ds_read_b64_tr_b16 a[108:109], v21 offset:41984
    ds_read_b64_tr_b16 a[110:111], v21 offset:43520
    v_mfma_f32_16x16x32_bf16 v[244:247], a[124:127], a[180:183], v[244:247]
    v_mfma_f32_16x16x32_bf16 v[240:243], a[124:127], a[176:179], v[240:243]
    buffer_load_dwordx4 v12, s[16:19], s49 offen offset:2048 lds
    v_mfma_f32_16x16x32_bf16 v[240:243], a[120:123], a[160:163], v[240:243]
    s_waitcnt vmcnt(18) lgkmcnt(4)
    v_mfma_f32_16x16x32_bf16 v[160:163], a[96:99], a[192:195], v[160:163]
    v_mfma_f32_16x16x32_bf16 v[160:163], a[100:103], a[208:211], v[160:163]
    ds_read_b64_tr_b16 a[112:113], v21 offset:32800
    ds_read_b64_tr_b16 a[114:115], v21 offset:34336
    v_mfma_f32_16x16x32_bf16 v[164:167], a[100:103], a[212:215], v[164:167]
    buffer_load_dwordx4 v13, s[16:19], s49 offen offset:3072 lds
    v_mfma_f32_16x16x32_bf16 v[164:167], a[96:99], a[196:199], v[164:167]
    s_add_u32 s54, s54, 1
    v_mfma_f32_16x16x32_bf16 v[168:171], a[96:99], a[200:203], v[168:171]
    s_and_b32 s54, s54, 7
    ds_read_b64_tr_b16 a[116:117], v21 offset:35872
    ds_read_b64_tr_b16 a[118:119], v21 offset:37408
    v_mfma_f32_16x16x32_bf16 v[168:171], a[100:103], a[216:219], v[168:171]
    s_add_u32 m0, s39, 32768
    v_mfma_f32_16x16x32_bf16 v[172:175], a[100:103], a[220:223], v[172:175]
    s_lshl_b32 s49, s54, 19
    buffer_load_dwordx4 v10, s[16:19], s49 offen offset:0 lds
    v_mfma_f32_16x16x32_bf16 v[172:175], a[96:99], a[204:207], v[172:175]
    s_waitcnt lgkmcnt(4)
    v_mfma_f32_16x16x32_bf16 v[188:191], a[104:107], a[204:207], v[188:191]
    v_mfma_f32_16x16x32_bf16 v[188:191], a[108:111], a[220:223], v[188:191]
    ds_read_b64_tr_b16 a[120:121], v21 offset:38944
    ds_read_b64_tr_b16 a[122:123], v21 offset:40480
    v_mfma_f32_16x16x32_bf16 v[184:187], a[108:111], a[216:219], v[184:187]
    buffer_load_dwordx4 v11, s[16:19], s49 offen offset:1024 lds
    v_mfma_f32_16x16x32_bf16 v[184:187], a[104:107], a[200:203], v[184:187]
    v_mfma_f32_16x16x32_bf16 v[180:183], a[104:107], a[196:199], v[180:183]
    ds_read_b64_tr_b16 a[124:125], v21 offset:42016
    ds_read_b64_tr_b16 a[126:127], v21 offset:43552
    v_mfma_f32_16x16x32_bf16 v[180:183], a[108:111], a[212:215], v[180:183]
    v_mfma_f32_16x16x32_bf16 v[176:179], a[108:111], a[208:211], v[176:179]
    buffer_load_dwordx4 v12, s[16:19], s49 offen offset:2048 lds
    v_mfma_f32_16x16x32_bf16 v[176:179], a[104:107], a[192:195], v[176:179]
    s_waitcnt lgkmcnt(4)
    v_mfma_f32_16x16x32_bf16 v[192:195], a[112:115], a[192:195], v[192:195]
    v_mfma_f32_16x16x32_bf16 v[192:195], a[116:119], a[208:211], v[192:195]
    ds_read_b64_tr_b16 a[96:97], v21 offset:32832
    ds_read_b64_tr_b16 a[98:99], v21 offset:34368
    v_mfma_f32_16x16x32_bf16 v[196:199], a[116:119], a[212:215], v[196:199]
    buffer_load_dwordx4 v13, s[16:19], s49 offen offset:3072 lds
    v_mfma_f32_16x16x32_bf16 v[196:199], a[112:115], a[196:199], v[196:199]
    s_add_u32 s54, s54, 1
    v_mfma_f32_16x16x32_bf16 v[200:203], a[112:115], a[200:203], v[200:203]
    s_and_b32 s54, s54, 7
    ds_read_b64_tr_b16 a[100:101], v21 offset:35904
    ds_read_b64_tr_b16 a[102:103], v21 offset:37440
    v_mfma_f32_16x16x32_bf16 v[200:203], a[116:119], a[216:219], v[200:203]
    s_add_u32 m0, s39, 49152
    v_mfma_f32_16x16x32_bf16 v[204:207], a[116:119], a[220:223], v[204:207]
    s_lshl_b32 s49, s54, 19
    buffer_load_dwordx4 v10, s[16:19], s49 offen offset:0 lds
    v_mfma_f32_16x16x32_bf16 v[204:207], a[112:115], a[204:207], v[204:207]
    s_waitcnt lgkmcnt(4)
    v_mfma_f32_16x16x32_bf16 v[220:223], a[120:123], a[204:207], v[220:223]
    v_mfma_f32_16x16x32_bf16 v[220:223], a[124:127], a[220:223], v[220:223]
    ds_read_b64_tr_b16 a[104:105], v21 offset:38976
    ds_read_b64_tr_b16 a[106:107], v21 offset:40512
    v_mfma_f32_16x16x32_bf16 v[216:219], a[124:127], a[216:219], v[216:219]
    buffer_load_dwordx4 v11, s[16:19], s49 offen offset:1024 lds
    v_mfma_f32_16x16x32_bf16 v[216:219], a[120:123], a[200:203], v[216:219]
    v_mfma_f32_16x16x32_bf16 v[212:215], a[120:123], a[196:199], v[212:215]
    ds_read_b64_tr_b16 a[108:109], v21 offset:42048
    ds_read_b64_tr_b16 a[110:111], v21 offset:43584
    v_mfma_f32_16x16x32_bf16 v[212:215], a[124:127], a[212:215], v[212:215]
    v_mfma_f32_16x16x32_bf16 v[208:211], a[124:127], a[208:211], v[208:211]
    buffer_load_dwordx4 v12, s[16:19], s49 offen offset:2048 lds
    v_mfma_f32_16x16x32_bf16 v[208:211], a[120:123], a[192:195], v[208:211]
    s_waitcnt lgkmcnt(4)
    v_mfma_f32_16x16x32_bf16 v[224:227], a[96:99], a[192:195], v[224:227]
    s_waitcnt vmcnt(23)
    v_mfma_f32_16x16x32_bf16 v[224:227], a[100:103], a[208:211], v[224:227]
    s_barrier
    ds_read_b64_tr_b16 a[112:113], v21 offset:49152
    ds_read_b64_tr_b16 a[114:115], v21 offset:50688
    v_mfma_f32_16x16x32_bf16 v[228:231], a[100:103], a[212:215], v[228:231]
    buffer_load_dwordx4 v13, s[16:19], s49 offen offset:3072 lds
    v_mfma_f32_16x16x32_bf16 v[228:231], a[96:99], a[196:199], v[228:231]
    s_add_u32 s54, s54, 1
    v_mfma_f32_16x16x32_bf16 v[232:235], a[96:99], a[200:203], v[232:235]
    s_and_b32 s54, s54, 7
    ds_read_b64_tr_b16 a[116:117], v21 offset:52224
    ds_read_b64_tr_b16 a[118:119], v21 offset:53760
    v_mfma_f32_16x16x32_bf16 v[232:235], a[100:103], a[216:219], v[232:235]
    s_lshr_b32 s49, s2, 3
    v_mfma_f32_16x16x32_bf16 v[236:239], a[100:103], a[220:223], v[236:239]
    s_lshl_b32 s49, s49, 2
    v_mfma_f32_16x16x32_bf16 v[236:239], a[96:99], a[204:207], v[236:239]
    s_waitcnt lgkmcnt(4)
    v_mfma_f32_16x16x32_bf16 v[252:255], a[104:107], a[204:207], v[252:255]
    s_add_u32 s49, s49, s36
    v_and_b32 v10, 15, v0
    v_and_b32 v11, 0xff, v1
    v_mfma_f32_16x16x32_bf16 v[252:255], a[108:111], a[220:223], v[252:255]
    s_lshl_b32 s49, s49, 8
    ds_read_b64_tr_b16 a[120:121], v21 offset:55296
    ds_read_b64_tr_b16 a[122:123], v21 offset:56832
    v_mfma_f32_16x16x32_bf16 v[248:251], a[108:111], a[216:219], v[248:251]
    s_getpc_b64 s[84:85]
    v_and_b32 v22, 1, v0
    v_lshl_add_u32 v22, v22, 7, s49
    v_mfma_f32_16x16x32_bf16 v[248:251], a[104:107], a[200:203], v[248:251]
    v_add_co_u32 v22, vcc, s84, v22
    v_mov_b32 v23, s85
    v_mfma_f32_16x16x32_bf16 v[244:247], a[104:107], a[196:199], v[244:247]
    ds_read_b64_tr_b16 a[124:125], v21 offset:58368
    ds_read_b64_tr_b16 a[126:127], v21 offset:59904
    v_mfma_f32_16x16x32_bf16 v[244:247], a[108:111], a[212:215], v[244:247]
    v_nop
    v_addc_co_u32 v23, vcc, 0, v23, vcc
    v_mfma_f32_16x16x32_bf16 v[240:243], a[108:111], a[208:211], v[240:243]
    global_load_dword v8, v[22:23], off
    v_lshl_add_u32 v10, v10, 8, v11
    v_mfma_f32_16x16x32_bf16 v[240:243], a[104:107], a[192:195], v[240:243]
    s_waitcnt vmcnt(17) lgkmcnt(4)
    v_xor_b32 v11, 64, v10
    v_xor_b32 v12, 128, v10
    v_mfma_f32_16x16x32_bf16 v[160:163], a[112:115], a[224:227], v[160:163]
    s_lshl_b32 s49, s38, 2
    v_xor_b32 v13, 192, v10
    v_mfma_f32_16x16x32_bf16 v[160:163], a[116:119], a[240:243], v[160:163]
    s_add_u32 s49, s49, s36
    ds_read_b64_tr_b16 a[96:97], v21 offset:49184
    ds_read_b64_tr_b16 a[98:99], v21 offset:50720
    v_mfma_f32_16x16x32_bf16 v[164:167], a[116:119], a[244:247], v[164:167]
    s_mul_i32 s49, s49, 3072
    v_min_u32 v7, 23, v0
    v_lshlrev_b32 v7, 7, v7
    v_mfma_f32_16x16x32_bf16 v[164:167], a[112:115], a[228:231], v[164:167]
    buffer_load_dword v8, v7, s[8:11], s49 offen
    v_mfma_f32_16x16x32_bf16 v[168:171], a[112:115], a[232:235], v[168:171]
    ds_read_b64_tr_b16 a[100:101], v21 offset:52256
    ds_read_b64_tr_b16 a[102:103], v21 offset:53792
    v_mfma_f32_16x16x32_bf16 v[168:171], a[116:119], a[248:251], v[168:171]
    v_mfma_f32_16x16x32_bf16 v[172:175], a[116:119], a[252:255], v[172:175]
    v_mfma_f32_16x16x32_bf16 v[172:175], a[112:115], a[236:239], v[172:175]
    s_waitcnt lgkmcnt(4)
    v_mfma_f32_16x16x32_bf16 v[188:191], a[120:123], a[236:239], v[188:191]
    buffer_load_dword v8, v7, s[12:15], s49 offen
    v_mfma_f32_16x16x32_bf16 v[188:191], a[124:127], a[252:255], v[188:191]
    ds_read_b64_tr_b16 a[104:105], v21 offset:55328
    ds_read_b64_tr_b16 a[106:107], v21 offset:56864
    v_mfma_f32_16x16x32_bf16 v[184:187], a[124:127], a[248:251], v[184:187]
    v_mfma_f32_16x16x32_bf16 v[184:187], a[120:123], a[232:235], v[184:187]
    v_mfma_f32_16x16x32_bf16 v[180:183], a[120:123], a[228:231], v[180:183]
    ds_read_b64_tr_b16 a[108:109], v21 offset:58400
    ds_read_b64_tr_b16 a[110:111], v21 offset:59936
    v_mfma_f32_16x16x32_bf16 v[180:183], a[124:127], a[244:247], v[180:183]
    v_mfma_f32_16x16x32_bf16 v[176:179], a[124:127], a[240:243], v[176:179]
    v_mfma_f32_16x16x32_bf16 v[176:179], a[120:123], a[224:227], v[176:179]
    s_waitcnt lgkmcnt(4)
    v_mfma_f32_16x16x32_bf16 v[192:195], a[96:99], a[224:227], v[192:195]
    v_mfma_f32_16x16x32_bf16 v[192:195], a[100:103], a[240:243], v[192:195]
    ds_read_b64_tr_b16 a[112:113], v21 offset:49216
    ds_read_b64_tr_b16 a[114:115], v21 offset:50752
    v_mfma_f32_16x16x32_bf16 v[196:199], a[100:103], a[244:247], v[196:199]
    v_mfma_f32_16x16x32_bf16 v[196:199], a[96:99], a[228:231], v[196:199]
    v_mfma_f32_16x16x32_bf16 v[200:203], a[96:99], a[232:235], v[200:203]
    ds_read_b64_tr_b16 a[116:117], v21 offset:52288
    ds_read_b64_tr_b16 a[118:119], v21 offset:53824
    v_mfma_f32_16x16x32_bf16 v[200:203], a[100:103], a[248:251], v[200:203]
    v_mfma_f32_16x16x32_bf16 v[204:207], a[100:103], a[252:255], v[204:207]
    v_mfma_f32_16x16x32_bf16 v[204:207], a[96:99], a[236:239], v[204:207]
    s_waitcnt lgkmcnt(4)
    v_mfma_f32_16x16x32_bf16 v[220:223], a[104:107], a[236:239], v[220:223]
    v_mfma_f32_16x16x32_bf16 v[220:223], a[108:111], a[252:255], v[220:223]
    ds_read_b64_tr_b16 a[120:121], v21 offset:55360
    ds_read_b64_tr_b16 a[122:123], v21 offset:56896
    v_mfma_f32_16x16x32_bf16 v[216:219], a[108:111], a[248:251], v[216:219]
    v_mfma_f32_16x16x32_bf16 v[216:219], a[104:107], a[232:235], v[216:219]
    v_mfma_f32_16x16x32_bf16 v[212:215], a[104:107], a[228:231], v[212:215]
    ds_read_b64_tr_b16 a[124:125], v21 offset:58432
    ds_read_b64_tr_b16 a[126:127], v21 offset:59968
    v_mfma_f32_16x16x32_bf16 v[212:215], a[108:111], a[244:247], v[212:215]
    v_mfma_f32_16x16x32_bf16 v[208:211], a[108:111], a[240:243], v[208:211]
    v_mfma_f32_16x16x32_bf16 v[208:211], a[104:107], a[224:227], v[208:211]
    s_waitcnt lgkmcnt(4)
    v_mfma_f32_16x16x32_bf16 v[224:227], a[112:115], a[224:227], v[224:227]
    s_waitcnt vmcnt(15)
    v_mfma_f32_16x16x32_bf16 v[224:227], a[116:119], a[240:243], v[224:227]
    s_barrier
    ds_read_b64_tr_b16 a[96:97], v17 offset:0
    ds_read_b64_tr_b16 a[98:99], v17 offset:4096
    v_mfma_f32_16x16x32_bf16 v[228:231], a[116:119], a[244:247], v[228:231]
    v_mfma_f32_16x16x32_bf16 v[228:231], a[112:115], a[228:231], v[228:231]
    v_mfma_f32_16x16x32_bf16 v[232:235], a[112:115], a[232:235], v[232:235]
    ds_read_b64_tr_b16 a[100:101], v17 offset:8192
    ds_read_b64_tr_b16 a[102:103], v17 offset:12288
    v_mfma_f32_16x16x32_bf16 v[232:235], a[116:119], a[248:251], v[232:235]
    v_mfma_f32_16x16x32_bf16 v[236:239], a[116:119], a[252:255], v[236:239]
    v_mfma_f32_16x16x32_bf16 v[236:239], a[112:115], a[236:239], v[236:239]
    s_waitcnt lgkmcnt(4)
    v_mfma_f32_16x16x32_bf16 v[252:255], a[120:123], a[236:239], v[252:255]
    v_mfma_f32_16x16x32_bf16 v[252:255], a[124:127], a[252:255], v[252:255]
    ds_read_b64_tr_b16 a[104:105], v17 offset:8
    ds_read_b64_tr_b16 a[106:107], v17 offset:4104
    v_mfma_f32_16x16x32_bf16 v[248:251], a[124:127], a[248:251], v[248:251]
    v_mfma_f32_16x16x32_bf16 v[248:251], a[120:123], a[232:235], v[248:251]
    v_mfma_f32_16x16x32_bf16 v[244:247], a[120:123], a[228:231], v[244:247]
    ds_read_b64_tr_b16 a[108:109], v17 offset:8200
    ds_read_b64_tr_b16 a[110:111], v17 offset:12296
    v_mfma_f32_16x16x32_bf16 v[244:247], a[124:127], a[244:247], v[244:247]
    v_mfma_f32_16x16x32_bf16 v[240:243], a[124:127], a[240:243], v[240:243]
    v_mfma_f32_16x16x32_bf16 v[240:243], a[120:123], a[224:227], v[240:243]
    s_waitcnt lgkmcnt(4)
    v_mfma_f32_16x16x32_bf16 v[32:35], a[96:99], a[128:131], v[32:35]
    v_mfma_f32_16x16x32_bf16 v[32:35], a[100:103], a[144:147], v[32:35]
    ds_read_b64_tr_b16 a[112:113], v18 offset:0
    ds_read_b64_tr_b16 a[114:115], v18 offset:4096
    v_mfma_f32_16x16x32_bf16 v[64:67], a[100:103], a[148:151], v[64:67]
    v_mfma_f32_16x16x32_bf16 v[64:67], a[96:99], a[132:135], v[64:67]
    v_mfma_f32_16x16x32_bf16 v[96:99], a[96:99], a[136:139], v[96:99]
    ds_read_b64_tr_b16 a[116:117], v18 offset:8192
    ds_read_b64_tr_b16 a[118:119], v18 offset:12288
    v_mfma_f32_16x16x32_bf16 v[96:99], a[100:103], a[152:155], v[96:99]
    v_mfma_f32_16x16x32_bf16 v[128:131], a[100:103], a[156:159], v[128:131]
    v_mfma_f32_16x16x32_bf16 v[128:131], a[96:99], a[140:143], v[128:131]
    s_waitcnt lgkmcnt(4)
    v_mfma_f32_16x16x32_bf16 v[132:135], a[104:107], a[140:143], v[132:135]
    v_mul_f32 v192, 0xbfb8aa3b, v192
    v_mul_f32 v193, 0xbfb8aa3b, v193
    v_mfma_f32_16x16x32_bf16 v[132:135], a[108:111], a[156:159], v[132:135]
    ds_read_b64_tr_b16 a[120:121], v18 offset:8
    ds_read_b64_tr_b16 a[122:123], v18 offset:4104
    v_mfma_f32_16x16x32_bf16 v[100:103], a[108:111], a[152:155], v[100:103]
    v_mul_f32 v194, 0xbfb8aa3b, v194
    v_mul_f32 v195, 0xbfb8aa3b, v195
    v_mfma_f32_16x16x32_bf16 v[100:103], a[104:107], a[136:139], v[100:103]
    v_mul_f32 v196, 0xbfb8aa3b, v196
    v_mul_f32 v197, 0xbfb8aa3b, v197
    v_mfma_f32_16x16x32_bf16 v[68:71], a[104:107], a[132:135], v[68:71]
    ds_read_b64_tr_b16 a[124:125], v18 offset:8200
    ds_read_b64_tr_b16 a[126:127], v18 offset:12296
    v_mfma_f32_16x16x32_bf16 v[68:71], a[108:111], a[148:151], v[68:71]
    v_mul_f32 v198, 0xbfb8aa3b, v198
    v_mul_f32 v199, 0xbfb8aa3b, v199
    v_mfma_f32_16x16x32_bf16 v[36:39], a[108:111], a[144:147], v[36:39]
    v_exp_f32 v192, v192
    v_mfma_f32_16x16x32_bf16 v[36:39], a[104:107], a[128:131], v[36:39]
    s_waitcnt lgkmcnt(4)
    v_exp_f32 v193, v193
    v_mfma_f32_16x16x32_bf16 v[40:43], a[112:115], a[128:131], v[40:43]
    v_exp_f32 v194, v194
    v_mfma_f32_16x16x32_bf16 v[40:43], a[116:119], a[144:147], v[40:43]
    ds_read_b64_tr_b16 a[96:97], v19 offset:0
    ds_read_b64_tr_b16 a[98:99], v19 offset:4096
    v_mfma_f32_16x16x32_bf16 v[72:75], a[116:119], a[148:151], v[72:75]
    v_exp_f32 v195, v195
    v_mfma_f32_16x16x32_bf16 v[72:75], a[112:115], a[132:135], v[72:75]
    v_exp_f32 v196, v196
    v_mfma_f32_16x16x32_bf16 v[104:107], a[112:115], a[136:139], v[104:107]
    ds_read_b64_tr_b16 a[100:101], v19 offset:8192
    ds_read_b64_tr_b16 a[102:103], v19 offset:12288
    v_mfma_f32_16x16x32_bf16 v[104:107], a[116:119], a[152:155], v[104:107]
    v_exp_f32 v197, v197
    v_mfma_f32_16x16x32_bf16 v[136:139], a[116:119], a[156:159], v[136:139]
    v_exp_f32 v198, v198
    v_mfma_f32_16x16x32_bf16 v[136:139], a[112:115], a[140:143], v[136:139]
    s_waitcnt lgkmcnt(4)
    v_exp_f32 v199, v199
    v_mfma_f32_16x16x32_bf16 v[140:143], a[120:123], a[140:143], v[140:143]
    v_add_f32 v192, 1.0, v192
    v_add_f32 v193, 1.0, v193
    v_mfma_f32_16x16x32_bf16 v[140:143], a[124:127], a[156:159], v[140:143]
    ds_read_b64_tr_b16 a[104:105], v19 offset:8
    ds_read_b64_tr_b16 a[106:107], v19 offset:4104
    v_mfma_f32_16x16x32_bf16 v[108:111], a[124:127], a[152:155], v[108:111]
    v_add_f32 v194, 1.0, v194
    v_add_f32 v195, 1.0, v195
    v_mfma_f32_16x16x32_bf16 v[108:111], a[120:123], a[136:139], v[108:111]
    v_add_f32 v196, 1.0, v196
    v_add_f32 v197, 1.0, v197
    v_mfma_f32_16x16x32_bf16 v[76:79], a[120:123], a[132:135], v[76:79]
    ds_read_b64_tr_b16 a[108:109], v19 offset:8200
    ds_read_b64_tr_b16 a[110:111], v19 offset:12296
    v_mfma_f32_16x16x32_bf16 v[76:79], a[124:127], a[148:151], v[76:79]
    v_add_f32 v198, 1.0, v198
    v_add_f32 v199, 1.0, v199
    v_mfma_f32_16x16x32_bf16 v[44:47], a[124:127], a[144:147], v[44:47]
    v_rcp_f32 v192, v192
    v_mfma_f32_16x16x32_bf16 v[44:47], a[120:123], a[128:131], v[44:47]
    s_waitcnt lgkmcnt(4)
    v_rcp_f32 v193, v193
    v_mfma_f32_16x16x32_bf16 v[48:51], a[96:99], a[128:131], v[48:51]
    v_rcp_f32 v194, v194
    v_mfma_f32_16x16x32_bf16 v[48:51], a[100:103], a[144:147], v[48:51]
    ds_read_b64_tr_b16 a[112:113], v20 offset:0
    ds_read_b64_tr_b16 a[114:115], v20 offset:4096
    v_mfma_f32_16x16x32_bf16 v[80:83], a[100:103], a[148:151], v[80:83]
    v_rcp_f32 v195, v195
    v_mfma_f32_16x16x32_bf16 v[80:83], a[96:99], a[132:135], v[80:83]
    v_rcp_f32 v196, v196
    v_mfma_f32_16x16x32_bf16 v[112:115], a[96:99], a[136:139], v[112:115]
    ds_read_b64_tr_b16 a[116:117], v20 offset:8192
    ds_read_b64_tr_b16 a[118:119], v20 offset:12288
    v_mfma_f32_16x16x32_bf16 v[112:115], a[100:103], a[152:155], v[112:115]
    v_rcp_f32 v197, v197
    v_mfma_f32_16x16x32_bf16 v[144:147], a[100:103], a[156:159], v[144:147]
    v_rcp_f32 v198, v198
    v_mfma_f32_16x16x32_bf16 v[144:147], a[96:99], a[140:143], v[144:147]
    s_waitcnt lgkmcnt(4)
    v_rcp_f32 v199, v199
    v_mfma_f32_16x16x32_bf16 v[148:151], a[104:107], a[140:143], v[148:151]
    v_mul_f32 v192, v192, v208
    v_mul_f32 v193, v193, v209
    v_mfma_f32_16x16x32_bf16 v[148:151], a[108:111], a[156:159], v[148:151]
    ds_read_b64_tr_b16 a[120:121], v20 offset:8
    ds_read_b64_tr_b16 a[122:123], v20 offset:4104
    v_mfma_f32_16x16x32_bf16 v[116:119], a[108:111], a[152:155], v[116:119]
    v_mul_f32 v194, v194, v210
    v_mul_f32 v195, v195, v211
    v_mfma_f32_16x16x32_bf16 v[116:119], a[104:107], a[136:139], v[116:119]
    v_mul_f32 v196, v196, v212
    v_mul_f32 v197, v197, v213
    v_mfma_f32_16x16x32_bf16 v[84:87], a[104:107], a[132:135], v[84:87]
    ds_read_b64_tr_b16 a[124:125], v20 offset:8200
    ds_read_b64_tr_b16 a[126:127], v20 offset:12296
    v_mfma_f32_16x16x32_bf16 v[84:87], a[108:111], a[148:151], v[84:87]
    v_mul_f32 v198, v198, v214
    v_mul_f32 v199, v199, v215
    v_mfma_f32_16x16x32_bf16 v[52:55], a[108:111], a[144:147], v[52:55]
    v_cvt_pk_bf16_f32 v208, v192, v193
    v_cvt_pk_bf16_f32 v209, v194, v195
    v_mfma_f32_16x16x32_bf16 v[52:55], a[104:107], a[128:131], v[52:55]
    s_waitcnt lgkmcnt(4)
    v_cvt_pk_bf16_f32 v210, v196, v197
    v_cvt_pk_bf16_f32 v211, v198, v199
    v_mfma_f32_16x16x32_bf16 v[56:59], a[112:115], a[128:131], v[56:59]
    s_waitcnt vmcnt(11)
    v_mul_f32 v200, 0xbfb8aa3b, v200
    v_mul_f32 v201, 0xbfb8aa3b, v201
    v_mfma_f32_16x16x32_bf16 v[56:59], a[116:119], a[144:147], v[56:59]
    s_barrier
    ds_read_b64_tr_b16 a[96:97], v17 offset:16384
    ds_read_b64_tr_b16 a[98:99], v17 offset:20480
    v_mfma_f32_16x16x32_bf16 v[88:91], a[116:119], a[148:151], v[88:91]
    v_mul_f32 v202, 0xbfb8aa3b, v202
    v_mul_f32 v203, 0xbfb8aa3b, v203
    v_mfma_f32_16x16x32_bf16 v[88:91], a[112:115], a[132:135], v[88:91]
    v_mul_f32 v204, 0xbfb8aa3b, v204
    v_mul_f32 v205, 0xbfb8aa3b, v205
    v_mfma_f32_16x16x32_bf16 v[120:123], a[112:115], a[136:139], v[120:123]
    ds_read_b64_tr_b16 a[100:101], v17 offset:24576
    ds_read_b64_tr_b16 a[102:103], v17 offset:28672
    v_mfma_f32_16x16x32_bf16 v[120:123], a[116:119], a[152:155], v[120:123]
    v_mul_f32 v206, 0xbfb8aa3b, v206
    v_mul_f32 v207, 0xbfb8aa3b, v207
    v_mfma_f32_16x16x32_bf16 v[152:155], a[116:119], a[156:159], v[152:155]
    v_exp_f32 v200, v200
    v_mfma_f32_16x16x32_bf16 v[152:155], a[112:115], a[140:143], v[152:155]
    s_waitcnt lgkmcnt(4)
    v_exp_f32 v201, v201
    v_mfma_f32_16x16x32_bf16 v[156:159], a[120:123], a[140:143], v[156:159]
    v_exp_f32 v202, v202
    v_mfma_f32_16x16x32_bf16 v[156:159], a[124:127], a[156:159], v[156:159]
    ds_read_b64_tr_b16 a[104:105], v17 offset:16392
    ds_read_b64_tr_b16 a[106:107], v17 offset:20488
    v_mfma_f32_16x16x32_bf16 v[124:127], a[124:127], a[152:155], v[124:127]
    v_exp_f32 v203, v203
    v_mfma_f32_16x16x32_bf16 v[124:127], a[120:123], a[136:139], v[124:127]
    v_exp_f32 v204, v204
    v_mfma_f32_16x16x32_bf16 v[92:95], a[120:123], a[132:135], v[92:95]
    ds_read_b64_tr_b16 a[108:109], v17 offset:24584
    ds_read_b64_tr_b16 a[110:111], v17 offset:28680
    v_mfma_f32_16x16x32_bf16 v[92:95], a[124:127], a[148:151], v[92:95]
    v_exp_f32 v205, v205
    v_mfma_f32_16x16x32_bf16 v[60:63], a[124:127], a[144:147], v[60:63]
    v_exp_f32 v206, v206
    v_mfma_f32_16x16x32_bf16 v[60:63], a[120:123], a[128:131], v[60:63]
    s_waitcnt lgkmcnt(4)
    v_exp_f32 v207, v207
    v_mfma_f32_16x16x32_bf16 v[32:35], a[96:99], a[160:163], v[32:35]
    v_add_f32 v200, 1.0, v200
    v_add_f32 v201, 1.0, v201
    v_mfma_f32_16x16x32_bf16 v[32:35], a[100:103], a[176:179], v[32:35]
    ds_read_b64_tr_b16 a[112:113], v18 offset:16384
    ds_read_b64_tr_b16 a[114:115], v18 offset:20480
    v_mfma_f32_16x16x32_bf16 v[64:67], a[100:103], a[180:183], v[64:67]
    v_add_f32 v202, 1.0, v202
    v_add_f32 v203, 1.0, v203
    v_mfma_f32_16x16x32_bf16 v[64:67], a[96:99], a[164:167], v[64:67]
    v_add_f32 v204, 1.0, v204
    v_add_f32 v205, 1.0, v205
    v_mfma_f32_16x16x32_bf16 v[96:99], a[96:99], a[168:171], v[96:99]
    ds_read_b64_tr_b16 a[116:117], v18 offset:24576
    ds_read_b64_tr_b16 a[118:119], v18 offset:28672
    v_mfma_f32_16x16x32_bf16 v[96:99], a[100:103], a[184:187], v[96:99]
    v_add_f32 v206, 1.0, v206
    v_add_f32 v207, 1.0, v207
    v_mfma_f32_16x16x32_bf16 v[128:131], a[100:103], a[188:191], v[128:131]
    v_rcp_f32 v200, v200
    v_mfma_f32_16x16x32_bf16 v[128:131], a[96:99], a[172:175], v[128:131]
    s_waitcnt lgkmcnt(4)
    v_rcp_f32 v201, v201
    v_mfma_f32_16x16x32_bf16 v[132:135], a[104:107], a[172:175], v[132:135]
    v_rcp_f32 v202, v202
    v_mfma_f32_16x16x32_bf16 v[132:135], a[108:111], a[188:191], v[132:135]
    ds_read_b64_tr_b16 a[120:121], v18 offset:16392
    ds_read_b64_tr_b16 a[122:123], v18 offset:20488
    v_mfma_f32_16x16x32_bf16 v[100:103], a[108:111], a[184:187], v[100:103]
    v_rcp_f32 v203, v203
    v_mfma_f32_16x16x32_bf16 v[100:103], a[104:107], a[168:171], v[100:103]
    v_rcp_f32 v204, v204
    v_mfma_f32_16x16x32_bf16 v[68:71], a[104:107], a[164:167], v[68:71]
    ds_read_b64_tr_b16 a[124:125], v18 offset:24584
    ds_read_b64_tr_b16 a[126:127], v18 offset:28680
    v_mfma_f32_16x16x32_bf16 v[68:71], a[108:111], a[180:183], v[68:71]
    v_rcp_f32 v205, v205
    v_mfma_f32_16x16x32_bf16 v[36:39], a[108:111], a[176:179], v[36:39]
    v_rcp_f32 v206, v206
    v_mfma_f32_16x16x32_bf16 v[36:39], a[104:107], a[160:163], v[36:39]
    s_waitcnt lgkmcnt(4)
    v_rcp_f32 v207, v207
    v_mfma_f32_16x16x32_bf16 v[40:43], a[112:115], a[160:163], v[40:43]
    v_mul_f32 v200, v200, v216
    v_mul_f32 v201, v201, v217
    v_mfma_f32_16x16x32_bf16 v[40:43], a[116:119], a[176:179], v[40:43]
    ds_read_b64_tr_b16 a[96:97], v19 offset:16384
    ds_read_b64_tr_b16 a[98:99], v19 offset:20480
    v_mfma_f32_16x16x32_bf16 v[72:75], a[116:119], a[180:183], v[72:75]
    v_mul_f32 v202, v202, v218
    v_mul_f32 v203, v203, v219
    v_mfma_f32_16x16x32_bf16 v[72:75], a[112:115], a[164:167], v[72:75]
    v_mul_f32 v204, v204, v220
    v_mul_f32 v205, v205, v221
    v_mfma_f32_16x16x32_bf16 v[104:107], a[112:115], a[168:171], v[104:107]
    ds_read_b64_tr_b16 a[100:101], v19 offset:24576
    ds_read_b64_tr_b16 a[102:103], v19 offset:28672
    v_mfma_f32_16x16x32_bf16 v[104:107], a[116:119], a[184:187], v[104:107]
    v_mul_f32 v206, v206, v222
    v_mul_f32 v207, v207, v223
    v_mfma_f32_16x16x32_bf16 v[136:139], a[116:119], a[188:191], v[136:139]
    v_cvt_pk_bf16_f32 v212, v200, v201
    v_cvt_pk_bf16_f32 v213, v202, v203
    v_mfma_f32_16x16x32_bf16 v[136:139], a[112:115], a[172:175], v[136:139]
    s_waitcnt lgkmcnt(4)
    v_cvt_pk_bf16_f32 v214, v204, v205
    v_cvt_pk_bf16_f32 v215, v206, v207
    v_mfma_f32_16x16x32_bf16 v[140:143], a[120:123], a[172:175], v[140:143]
    v_mul_f32 v160, 0xbfb8aa3b, v160
    v_mul_f32 v161, 0xbfb8aa3b, v161
    v_mfma_f32_16x16x32_bf16 v[140:143], a[124:127], a[188:191], v[140:143]
    ds_read_b64_tr_b16 a[104:105], v19 offset:16392
    ds_read_b64_tr_b16 a[106:107], v19 offset:20488
    v_mfma_f32_16x16x32_bf16 v[108:111], a[124:127], a[184:187], v[108:111]
    v_mul_f32 v162, 0xbfb8aa3b, v162
    v_mul_f32 v163, 0xbfb8aa3b, v163
    v_mfma_f32_16x16x32_bf16 v[108:111], a[120:123], a[168:171], v[108:111]
    v_mul_f32 v164, 0xbfb8aa3b, v164
    v_mul_f32 v165, 0xbfb8aa3b, v165
    v_mfma_f32_16x16x32_bf16 v[76:79], a[120:123], a[164:167], v[76:79]
    ds_read_b64_tr_b16 a[108:109], v19 offset:24584
    ds_read_b64_tr_b16 a[110:111], v19 offset:28680
    v_mfma_f32_16x16x32_bf16 v[76:79], a[124:127], a[180:183], v[76:79]
    v_mul_f32 v166, 0xbfb8aa3b, v166
    v_mul_f32 v167, 0xbfb8aa3b, v167
    v_mfma_f32_16x16x32_bf16 v[44:47], a[124:127], a[176:179], v[44:47]
    v_exp_f32 v160, v160
    v_mfma_f32_16x16x32_bf16 v[44:47], a[120:123], a[160:163], v[44:47]
    s_waitcnt lgkmcnt(4)
    v_exp_f32 v161, v161
    v_mfma_f32_16x16x32_bf16 v[48:51], a[96:99], a[160:163], v[48:51]
    v_exp_f32 v162, v162
    v_mfma_f32_16x16x32_bf16 v[48:51], a[100:103], a[176:179], v[48:51]
    ds_read_b64_tr_b16 a[112:113], v20 offset:16384
    ds_read_b64_tr_b16 a[114:115], v20 offset:20480
    v_mfma_f32_16x16x32_bf16 v[80:83], a[100:103], a[180:183], v[80:83]
    v_exp_f32 v163, v163
    v_mfma_f32_16x16x32_bf16 v[80:83], a[96:99], a[164:167], v[80:83]
    v_exp_f32 v164, v164
    v_mfma_f32_16x16x32_bf16 v[112:115], a[96:99], a[168:171], v[112:115]
    ds_read_b64_tr_b16 a[116:117], v20 offset:24576
    ds_read_b64_tr_b16 a[118:119], v20 offset:28672
    v_mfma_f32_16x16x32_bf16 v[112:115], a[100:103], a[184:187], v[112:115]
    v_exp_f32 v165, v165
    v_mfma_f32_16x16x32_bf16 v[144:147], a[100:103], a[188:191], v[144:147]
    v_exp_f32 v166, v166
    v_mfma_f32_16x16x32_bf16 v[144:147], a[96:99], a[172:175], v[144:147]
    s_waitcnt lgkmcnt(4)
    v_exp_f32 v167, v167
    v_mfma_f32_16x16x32_bf16 v[148:151], a[104:107], a[172:175], v[148:151]
    v_add_f32 v160, 1.0, v160
    v_add_f32 v161, 1.0, v161
    v_mfma_f32_16x16x32_bf16 v[148:151], a[108:111], a[188:191], v[148:151]
    ds_read_b64_tr_b16 a[120:121], v20 offset:16392
    ds_read_b64_tr_b16 a[122:123], v20 offset:20488
    v_mfma_f32_16x16x32_bf16 v[116:119], a[108:111], a[184:187], v[116:119]
    v_add_f32 v162, 1.0, v162
    v_add_f32 v163, 1.0, v163
    v_mfma_f32_16x16x32_bf16 v[116:119], a[104:107], a[168:171], v[116:119]
    v_add_f32 v164, 1.0, v164
    v_add_f32 v165, 1.0, v165
    v_mfma_f32_16x16x32_bf16 v[84:87], a[104:107], a[164:167], v[84:87]
    ds_read_b64_tr_b16 a[124:125], v20 offset:24584
    ds_read_b64_tr_b16 a[126:127], v20 offset:28680
    v_mfma_f32_16x16x32_bf16 v[84:87], a[108:111], a[180:183], v[84:87]
    v_add_f32 v166, 1.0, v166
    v_add_f32 v167, 1.0, v167
    v_mfma_f32_16x16x32_bf16 v[52:55], a[108:111], a[176:179], v[52:55]
    v_rcp_f32 v160, v160
    v_mfma_f32_16x16x32_bf16 v[52:55], a[104:107], a[160:163], v[52:55]
    s_waitcnt lgkmcnt(4)
    v_rcp_f32 v161, v161
    v_mfma_f32_16x16x32_bf16 v[56:59], a[112:115], a[160:163], v[56:59]
    s_waitcnt vmcnt(7)
    v_rcp_f32 v162, v162
    v_mfma_f32_16x16x32_bf16 v[56:59], a[116:119], a[176:179], v[56:59]
    s_barrier
    ds_read_b64_tr_b16 a[96:97], v17 offset:32768
    ds_read_b64_tr_b16 a[98:99], v17 offset:36864
    v_mfma_f32_16x16x32_bf16 v[88:91], a[116:119], a[180:183], v[88:91]
    v_rcp_f32 v163, v163
    v_mfma_f32_16x16x32_bf16 v[88:91], a[112:115], a[164:167], v[88:91]
    v_rcp_f32 v164, v164
    v_mfma_f32_16x16x32_bf16 v[120:123], a[112:115], a[168:171], v[120:123]
    ds_read_b64_tr_b16 a[100:101], v17 offset:40960
    ds_read_b64_tr_b16 a[102:103], v17 offset:45056
    v_mfma_f32_16x16x32_bf16 v[120:123], a[116:119], a[184:187], v[120:123]
    v_rcp_f32 v165, v165
    v_mfma_f32_16x16x32_bf16 v[152:155], a[116:119], a[188:191], v[152:155]
    v_rcp_f32 v166, v166
    v_mfma_f32_16x16x32_bf16 v[152:155], a[112:115], a[172:175], v[152:155]
    s_waitcnt lgkmcnt(4)
    v_rcp_f32 v167, v167
    v_mfma_f32_16x16x32_bf16 v[156:159], a[120:123], a[172:175], v[156:159]
    v_mul_f32 v160, v160, v176
    v_mul_f32 v161, v161, v177
    v_mfma_f32_16x16x32_bf16 v[156:159], a[124:127], a[188:191], v[156:159]
    ds_read_b64_tr_b16 a[104:105], v17 offset:32776
    ds_read_b64_tr_b16 a[106:107], v17 offset:36872
    v_mfma_f32_16x16x32_bf16 v[124:127], a[124:127], a[184:187], v[124:127]
    v_mul_f32 v162, v162, v178
    v_mul_f32 v163, v163, v179
    v_mfma_f32_16x16x32_bf16 v[124:127], a[120:123], a[168:171], v[124:127]
    v_mul_f32 v164, v164, v180
    v_mul_f32 v165, v165, v181
    v_mfma_f32_16x16x32_bf16 v[92:95], a[120:123], a[164:167], v[92:95]
    ds_read_b64_tr_b16 a[108:109], v17 offset:40968
    ds_read_b64_tr_b16 a[110:111], v17 offset:45064
    v_mfma_f32_16x16x32_bf16 v[92:95], a[124:127], a[180:183], v[92:95]
    v_mul_f32 v166, v166, v182
    v_mul_f32 v167, v167, v183
    v_mfma_f32_16x16x32_bf16 v[60:63], a[124:127], a[176:179], v[60:63]
    v_cvt_pk_bf16_f32 v216, v160, v161
    v_cvt_pk_bf16_f32 v217, v162, v163
    v_mfma_f32_16x16x32_bf16 v[60:63], a[120:123], a[160:163], v[60:63]
    s_waitcnt lgkmcnt(4)
    v_cvt_pk_bf16_f32 v218, v164, v165
    v_cvt_pk_bf16_f32 v219, v166, v167
    v_mfma_f32_16x16x32_bf16 v[32:35], a[96:99], a[192:195], v[32:35]
    v_mul_f32 v168, 0xbfb8aa3b, v168
    v_mul_f32 v169, 0xbfb8aa3b, v169
    v_mfma_f32_16x16x32_bf16 v[32:35], a[100:103], a[208:211], v[32:35]
    ds_read_b64_tr_b16 a[112:113], v18 offset:32768
    ds_read_b64_tr_b16 a[114:115], v18 offset:36864
    v_mfma_f32_16x16x32_bf16 v[64:67], a[100:103], a[212:215], v[64:67]
    v_mul_f32 v170, 0xbfb8aa3b, v170
    v_mul_f32 v171, 0xbfb8aa3b, v171
    v_mfma_f32_16x16x32_bf16 v[64:67], a[96:99], a[196:199], v[64:67]
    v_mul_f32 v172, 0xbfb8aa3b, v172
    v_mul_f32 v173, 0xbfb8aa3b, v173
    v_mfma_f32_16x16x32_bf16 v[96:99], a[96:99], a[200:203], v[96:99]
    ds_read_b64_tr_b16 a[116:117], v18 offset:40960
    ds_read_b64_tr_b16 a[118:119], v18 offset:45056
    v_mfma_f32_16x16x32_bf16 v[96:99], a[100:103], a[216:219], v[96:99]
    v_mul_f32 v174, 0xbfb8aa3b, v174
    v_mul_f32 v175, 0xbfb8aa3b, v175
    v_mfma_f32_16x16x32_bf16 v[128:131], a[100:103], a[220:223], v[128:131]
    v_exp_f32 v168, v168
    v_mfma_f32_16x16x32_bf16 v[128:131], a[96:99], a[204:207], v[128:131]
    s_waitcnt lgkmcnt(4)
    v_exp_f32 v169, v169
    v_mfma_f32_16x16x32_bf16 v[132:135], a[104:107], a[204:207], v[132:135]
    v_exp_f32 v170, v170
    v_mfma_f32_16x16x32_bf16 v[132:135], a[108:111], a[220:223], v[132:135]
    ds_read_b64_tr_b16 a[120:121], v18 offset:32776
    ds_read_b64_tr_b16 a[122:123], v18 offset:36872
    v_mfma_f32_16x16x32_bf16 v[100:103], a[108:111], a[216:219], v[100:103]
    v_exp_f32 v171, v171
    v_mfma_f32_16x16x32_bf16 v[100:103], a[104:107], a[200:203], v[100:103]
    v_exp_f32 v172, v172
    v_mfma_f32_16x16x32_bf16 v[68:71], a[104:107], a[196:199], v[68:71]
    ds_read_b64_tr_b16 a[124:125], v18 offset:40968
    ds_read_b64_tr_b16 a[126:127], v18 offset:45064
    v_mfma_f32_16x16x32_bf16 v[68:71], a[108:111], a[212:215], v[68:71]
    v_exp_f32 v173, v173
    v_mfma_f32_16x16x32_bf16 v[36:39], a[108:111], a[208:211], v[36:39]
    v_exp_f32 v174, v174
    v_mfma_f32_16x16x32_bf16 v[36:39], a[104:107], a[192:195], v[36:39]
    s_waitcnt lgkmcnt(4)
    v_exp_f32 v175, v175
    v_mfma_f32_16x16x32_bf16 v[40:43], a[112:115], a[192:195], v[40:43]
    v_add_f32 v168, 1.0, v168
    v_add_f32 v169, 1.0, v169
    v_mfma_f32_16x16x32_bf16 v[40:43], a[116:119], a[208:211], v[40:43]
    ds_read_b64_tr_b16 a[96:97], v19 offset:32768
    ds_read_b64_tr_b16 a[98:99], v19 offset:36864
    v_mfma_f32_16x16x32_bf16 v[72:75], a[116:119], a[212:215], v[72:75]
    v_add_f32 v170, 1.0, v170
    v_add_f32 v171, 1.0, v171
    v_mfma_f32_16x16x32_bf16 v[72:75], a[112:115], a[196:199], v[72:75]
    v_add_f32 v172, 1.0, v172
    v_add_f32 v173, 1.0, v173
    v_mfma_f32_16x16x32_bf16 v[104:107], a[112:115], a[200:203], v[104:107]
    ds_read_b64_tr_b16 a[100:101], v19 offset:40960
    ds_read_b64_tr_b16 a[102:103], v19 offset:45056
    v_mfma_f32_16x16x32_bf16 v[104:107], a[116:119], a[216:219], v[104:107]
    v_add_f32 v174, 1.0, v174
    v_add_f32 v175, 1.0, v175
    v_mfma_f32_16x16x32_bf16 v[136:139], a[116:119], a[220:223], v[136:139]
    v_rcp_f32 v168, v168
    v_mfma_f32_16x16x32_bf16 v[136:139], a[112:115], a[204:207], v[136:139]
    s_waitcnt lgkmcnt(4)
    v_rcp_f32 v169, v169
    v_mfma_f32_16x16x32_bf16 v[140:143], a[120:123], a[204:207], v[140:143]
    v_rcp_f32 v170, v170
    v_mfma_f32_16x16x32_bf16 v[140:143], a[124:127], a[220:223], v[140:143]
    ds_read_b64_tr_b16 a[104:105], v19 offset:32776
    ds_read_b64_tr_b16 a[106:107], v19 offset:36872
    v_mfma_f32_16x16x32_bf16 v[108:111], a[124:127], a[216:219], v[108:111]
    v_rcp_f32 v171, v171
    v_mfma_f32_16x16x32_bf16 v[108:111], a[120:123], a[200:203], v[108:111]
    v_rcp_f32 v172, v172
    v_mfma_f32_16x16x32_bf16 v[76:79], a[120:123], a[196:199], v[76:79]
    ds_read_b64_tr_b16 a[108:109], v19 offset:40968
    ds_read_b64_tr_b16 a[110:111], v19 offset:45064
    v_mfma_f32_16x16x32_bf16 v[76:79], a[124:127], a[212:215], v[76:79]
    v_rcp_f32 v173, v173
    v_mfma_f32_16x16x32_bf16 v[44:47], a[124:127], a[208:211], v[44:47]
    v_rcp_f32 v174, v174
    v_mfma_f32_16x16x32_bf16 v[44:47], a[120:123], a[192:195], v[44:47]
    s_waitcnt lgkmcnt(4)
    v_rcp_f32 v175, v175
    v_mfma_f32_16x16x32_bf16 v[48:51], a[96:99], a[192:195], v[48:51]
    s_add_u32 m0, s39, 0
    v_mul_f32 v168, v168, v184
    v_mul_f32 v169, v169, v185
    v_mfma_f32_16x16x32_bf16 v[48:51], a[100:103], a[208:211], v[48:51]
    ds_read_b64_tr_b16 a[112:113], v20 offset:32768
    ds_read_b64_tr_b16 a[114:115], v20 offset:36864
    v_mfma_f32_16x16x32_bf16 v[80:83], a[100:103], a[212:215], v[80:83]
    buffer_load_dwordx4 v1, s[8:11], s45 offen offset:0 lds
    v_mul_f32 v170, v170, v186
    v_mfma_f32_16x16x32_bf16 v[80:83], a[96:99], a[196:199], v[80:83]
    v_mul_f32 v171, v171, v187
    v_mul_f32 v172, v172, v188
    v_mfma_f32_16x16x32_bf16 v[112:115], a[96:99], a[200:203], v[112:115]
    ds_read_b64_tr_b16 a[116:117], v20 offset:40960
    ds_read_b64_tr_b16 a[118:119], v20 offset:45056
    v_mfma_f32_16x16x32_bf16 v[112:115], a[100:103], a[216:219], v[112:115]
    v_mul_f32 v173, v173, v189
    v_mul_f32 v174, v174, v190
    v_mfma_f32_16x16x32_bf16 v[144:147], a[100:103], a[220:223], v[144:147]
    v_mul_f32 v175, v175, v191
    v_cvt_pk_bf16_f32 v220, v168, v169
    v_mfma_f32_16x16x32_bf16 v[144:147], a[96:99], a[204:207], v[144:147]
    s_waitcnt lgkmcnt(4)
    v_cvt_pk_bf16_f32 v221, v170, v171
    v_cvt_pk_bf16_f32 v222, v172, v173
    v_mfma_f32_16x16x32_bf16 v[148:151], a[104:107], a[204:207], v[148:151]
    buffer_load_dwordx4 v2, s[8:11], s45 offen offset:1024 lds
    v_cvt_pk_bf16_f32 v223, v174, v175
    v_mfma_f32_16x16x32_bf16 v[148:151], a[108:111], a[220:223], v[148:151]
    ds_read_b64_tr_b16 a[120:121], v20 offset:32776
    ds_read_b64_tr_b16 a[122:123], v20 offset:36872
    v_mfma_f32_16x16x32_bf16 v[116:119], a[108:111], a[216:219], v[116:119]
    v_mul_f32 v224, 0xbfb8aa3b, v224
    v_mul_f32 v225, 0xbfb8aa3b, v225
    v_mfma_f32_16x16x32_bf16 v[116:119], a[104:107], a[200:203], v[116:119]
    v_mul_f32 v226, 0xbfb8aa3b, v226
    v_mul_f32 v227, 0xbfb8aa3b, v227
    v_mfma_f32_16x16x32_bf16 v[84:87], a[104:107], a[196:199], v[84:87]
    ds_read_b64_tr_b16 a[124:125], v20 offset:40968
    ds_read_b64_tr_b16 a[126:127], v20 offset:45064
    v_mfma_f32_16x16x32_bf16 v[84:87], a[108:111], a[212:215], v[84:87]
    v_mul_f32 v228, 0xbfb8aa3b, v228
    v_mul_f32 v229, 0xbfb8aa3b, v229
    v_mfma_f32_16x16x32_bf16 v[52:55], a[108:111], a[208:211], v[52:55]
    buffer_load_dwordx4 v3, s[8:11], s45 offen offset:2048 lds
    v_mul_f32 v230, 0xbfb8aa3b, v230
    v_mfma_f32_16x16x32_bf16 v[52:55], a[104:107], a[192:195], v[52:55]
    s_waitcnt lgkmcnt(4)
    v_mul_f32 v231, 0xbfb8aa3b, v231
    v_mfma_f32_16x16x32_bf16 v[56:59], a[112:115], a[192:195], v[56:59]
    s_waitcnt vmcnt(6)
    v_exp_f32 v224, v224
    v_mfma_f32_16x16x32_bf16 v[56:59], a[116:119], a[208:211], v[56:59]
    s_barrier
    ds_read_b64_tr_b16 a[96:97], v17 offset:49152
    ds_read_b64_tr_b16 a[98:99], v17 offset:53248
    v_mfma_f32_16x16x32_bf16 v[88:91], a[116:119], a[212:215], v[88:91]
    v_exp_f32 v225, v225
    v_mfma_f32_16x16x32_bf16 v[88:91], a[112:115], a[196:199], v[88:91]
    v_exp_f32 v226, v226
    v_mfma_f32_16x16x32_bf16 v[120:123], a[112:115], a[200:203], v[120:123]
    ds_read_b64_tr_b16 a[100:101], v17 offset:57344
    ds_read_b64_tr_b16 a[102:103], v17 offset:61440
    v_mfma_f32_16x16x32_bf16 v[120:123], a[116:119], a[216:219], v[120:123]
    buffer_load_dwordx4 v4, s[8:11], s45 offen offset:3072 lds
    v_mfma_f32_16x16x32_bf16 v[152:155], a[116:119], a[220:223], v[152:155]
    s_add_u32 s45, s45, 16384
    v_exp_f32 v227, v227
    v_mfma_f32_16x16x32_bf16 v[152:155], a[112:115], a[204:207], v[152:155]
    s_waitcnt lgkmcnt(4)
    v_exp_f32 v228, v228
    v_mfma_f32_16x16x32_bf16 v[156:159], a[120:123], a[204:207], v[156:159]
    s_add_u32 m0, s39, 81920
    v_exp_f32 v229, v229
    v_mfma_f32_16x16x32_bf16 v[156:159], a[124:127], a[220:223], v[156:159]
    ds_read_b64_tr_b16 a[104:105], v17 offset:49160
    ds_read_b64_tr_b16 a[106:107], v17 offset:53256
    v_mfma_f32_16x16x32_bf16 v[124:127], a[124:127], a[216:219], v[124:127]
    v_exp_f32 v230, v230
    v_mfma_f32_16x16x32_bf16 v[124:127], a[120:123], a[200:203], v[124:127]
    buffer_load_dwordx4 v5, s[12:15], s46 offen offset:0 lds
    v_mfma_f32_16x16x32_bf16 v[92:95], a[120:123], a[196:199], v[92:95]
    ds_read_b64_tr_b16 a[108:109], v17 offset:57352
    ds_read_b64_tr_b16 a[110:111], v17 offset:61448
    v_mfma_f32_16x16x32_bf16 v[92:95], a[124:127], a[212:215], v[92:95]
    v_exp_f32 v231, v231
    v_mfma_f32_16x16x32_bf16 v[60:63], a[124:127], a[208:211], v[60:63]
    v_add_f32 v224, 1.0, v224
    v_add_f32 v225, 1.0, v225
    v_mfma_f32_16x16x32_bf16 v[60:63], a[120:123], a[192:195], v[60:63]
    s_waitcnt lgkmcnt(4)
    v_add_f32 v226, 1.0, v226
    v_add_f32 v227, 1.0, v227
    v_mfma_f32_16x16x32_bf16 v[32:35], a[96:99], a[224:227], v[32:35]
    v_add_f32 v228, 1.0, v228
    v_add_f32 v229, 1.0, v229
    v_mfma_f32_16x16x32_bf16 v[32:35], a[100:103], a[240:243], v[32:35]
    ds_read_b64_tr_b16 a[112:113], v18 offset:49152
    ds_read_b64_tr_b16 a[114:115], v18 offset:53248
    v_mfma_f32_16x16x32_bf16 v[64:67], a[100:103], a[244:247], v[64:67]
    buffer_load_dwordx4 v6, s[12:15], s46 offen offset:1024 lds
    v_add_f32 v230, 1.0, v230
    v_mfma_f32_16x16x32_bf16 v[64:67], a[96:99], a[228:231], v[64:67]
    v_add_f32 v231, 1.0, v231
    v_mfma_f32_16x16x32_bf16 v[96:99], a[96:99], a[232:235], v[96:99]
    ds_read_b64_tr_b16 a[116:117], v18 offset:57344
    ds_read_b64_tr_b16 a[118:119], v18 offset:61440
    v_mfma_f32_16x16x32_bf16 v[96:99], a[100:103], a[248:251], v[96:99]
    v_rcp_f32 v224, v224
    v_mfma_f32_16x16x32_bf16 v[128:131], a[100:103], a[252:255], v[128:131]
    v_rcp_f32 v225, v225
    v_mfma_f32_16x16x32_bf16 v[128:131], a[96:99], a[236:239], v[128:131]
    s_waitcnt lgkmcnt(4)
    v_rcp_f32 v226, v226
    v_mfma_f32_16x16x32_bf16 v[132:135], a[104:107], a[236:239], v[132:135]
    buffer_load_dwordx4 v5, s[12:15], s46 offen offset:2048 lds
    v_mfma_f32_16x16x32_bf16 v[132:135], a[108:111], a[252:255], v[132:135]
    ds_read_b64_tr_b16 a[120:121], v18 offset:49160
    ds_read_b64_tr_b16 a[122:123], v18 offset:53256
    v_mfma_f32_16x16x32_bf16 v[100:103], a[108:111], a[248:251], v[100:103]
    v_rcp_f32 v227, v227
    v_mfma_f32_16x16x32_bf16 v[100:103], a[104:107], a[232:235], v[100:103]
    v_rcp_f32 v228, v228
    v_mfma_f32_16x16x32_bf16 v[68:71], a[104:107], a[228:231], v[68:71]
    ds_read_b64_tr_b16 a[124:125], v18 offset:57352
    ds_read_b64_tr_b16 a[126:127], v18 offset:61448
    v_mfma_f32_16x16x32_bf16 v[68:71], a[108:111], a[244:247], v[68:71]
    v_rcp_f32 v229, v229
    v_mfma_f32_16x16x32_bf16 v[36:39], a[108:111], a[240:243], v[36:39]
    buffer_load_dwordx4 v6, s[12:15], s46 offen offset:3072 lds
    v_mfma_f32_16x16x32_bf16 v[36:39], a[104:107], a[224:227], v[36:39]
    s_waitcnt lgkmcnt(4)
    v_rcp_f32 v230, v230
    v_mfma_f32_16x16x32_bf16 v[40:43], a[112:115], a[224:227], v[40:43]
    s_add_u32 s46, s46, 16384
    v_mul_f32 v32, s6, v32
    v_mul_f32 v33, s6, v33
    v_mfma_f32_16x16x32_bf16 v[40:43], a[116:119], a[240:243], v[40:43]
    s_add_u32 m0, s39, 16384
    ds_read_b64_tr_b16 a[96:97], v19 offset:49152
    ds_read_b64_tr_b16 a[98:99], v19 offset:53248
    v_mfma_f32_16x16x32_bf16 v[72:75], a[116:119], a[244:247], v[72:75]
    v_mul_f32 v34, s6, v34
    v_mul_f32 v35, s6, v35
    v_mfma_f32_16x16x32_bf16 v[72:75], a[112:115], a[228:231], v[72:75]
    v_mul_f32 v64, s6, v64
    v_mul_f32 v65, s6, v65
    v_mfma_f32_16x16x32_bf16 v[104:107], a[112:115], a[232:235], v[104:107]
    ds_read_b64_tr_b16 a[100:101], v19 offset:57344
    ds_read_b64_tr_b16 a[102:103], v19 offset:61440
    v_mfma_f32_16x16x32_bf16 v[104:107], a[116:119], a[248:251], v[104:107]
    buffer_load_dwordx4 v1, s[8:11], s45 offen offset:0 lds
    v_mul_f32 v66, s6, v66
    v_mfma_f32_16x16x32_bf16 v[136:139], a[116:119], a[252:255], v[136:139]
    v_mul_f32 v67, s6, v67
    v_mul_f32 v96, s6, v96
    v_mfma_f32_16x16x32_bf16 v[136:139], a[112:115], a[236:239], v[136:139]
    s_waitcnt lgkmcnt(4)
    v_mul_f32 v97, s6, v97
    v_mul_f32 v98, s6, v98
    v_mfma_f32_16x16x32_bf16 v[140:143], a[120:123], a[236:239], v[140:143]
    v_mul_f32 v99, s6, v99
    v_mul_f32 v128, s6, v128
    v_mfma_f32_16x16x32_bf16 v[140:143], a[124:127], a[252:255], v[140:143]
    ds_read_b64_tr_b16 a[104:105], v19 offset:49160
    ds_read_b64_tr_b16 a[106:107], v19 offset:53256
    v_mfma_f32_16x16x32_bf16 v[108:111], a[124:127], a[248:251], v[108:111]
    v_mul_f32 v129, s6, v129
    v_mul_f32 v130, s6, v130
    v_mfma_f32_16x16x32_bf16 v[108:111], a[120:123], a[232:235], v[108:111]
    buffer_load_dwordx4 v2, s[8:11], s45 offen offset:1024 lds
    v_mul_f32 v131, s6, v131
    v_mfma_f32_16x16x32_bf16 v[76:79], a[120:123], a[228:231], v[76:79]
    ds_read_b64_tr_b16 a[108:109], v19 offset:57352
    ds_read_b64_tr_b16 a[110:111], v19 offset:61448
    v_mfma_f32_16x16x32_bf16 v[76:79], a[124:127], a[244:247], v[76:79]
    v_mul_f32 v36, s6, v36
    v_mul_f32 v37, s6, v37
    v_mfma_f32_16x16x32_bf16 v[44:47], a[124:127], a[240:243], v[44:47]
    v_mul_f32 v38, s6, v38
    v_mul_f32 v39, s6, v39
    v_mfma_f32_16x16x32_bf16 v[44:47], a[120:123], a[224:227], v[44:47]
    s_waitcnt lgkmcnt(4)
    v_mul_f32 v68, s6, v68
    v_mul_f32 v69, s6, v69
    v_mfma_f32_16x16x32_bf16 v[48:51], a[96:99], a[224:227], v[48:51]
    v_mul_f32 v70, s6, v70
    v_mul_f32 v71, s6, v71
    v_mfma_f32_16x16x32_bf16 v[48:51], a[100:103], a[240:243], v[48:51]
    ds_read_b64_tr_b16 a[112:113], v20 offset:49152
    ds_read_b64_tr_b16 a[114:115], v20 offset:53248
    v_mfma_f32_16x16x32_bf16 v[80:83], a[100:103], a[244:247], v[80:83]
    buffer_load_dwordx4 v3, s[8:11], s45 offen offset:2048 lds
    v_mul_f32 v100, s6, v100
    v_mfma_f32_16x16x32_bf16 v[80:83], a[96:99], a[228:231], v[80:83]
    v_mul_f32 v101, s6, v101
    v_mul_f32 v102, s6, v102
    v_mfma_f32_16x16x32_bf16 v[112:115], a[96:99], a[232:235], v[112:115]
    ds_read_b64_tr_b16 a[116:117], v20 offset:57344
    ds_read_b64_tr_b16 a[118:119], v20 offset:61440
    v_mfma_f32_16x16x32_bf16 v[112:115], a[100:103], a[248:251], v[112:115]
    v_mul_f32 v103, s6, v103
    v_mul_f32 v132, s6, v132
    v_mfma_f32_16x16x32_bf16 v[144:147], a[100:103], a[252:255], v[144:147]
    v_mul_f32 v133, s6, v133
    v_mul_f32 v134, s6, v134
    v_mfma_f32_16x16x32_bf16 v[144:147], a[96:99], a[236:239], v[144:147]
    s_waitcnt lgkmcnt(4)
    v_mul_f32 v135, s6, v135
    v_mul_f32 v40, s6, v40
    v_mfma_f32_16x16x32_bf16 v[148:151], a[104:107], a[236:239], v[148:151]
    buffer_load_dwordx4 v4, s[8:11], s45 offen offset:3072 lds
    v_mul_f32 v41, s6, v41
    v_mfma_f32_16x16x32_bf16 v[148:151], a[108:111], a[252:255], v[148:151]
    s_add_u32 s45, s45, 16384
    ds_read_b64_tr_b16 a[120:121], v20 offset:49160
    ds_read_b64_tr_b16 a[122:123], v20 offset:53256
    v_mfma_f32_16x16x32_bf16 v[116:119], a[108:111], a[248:251], v[116:119]
    s_add_u32 m0, s39, 98304
    v_mul_f32 v42, s6, v42
    v_mul_f32 v43, s6, v43
    v_mfma_f32_16x16x32_bf16 v[116:119], a[104:107], a[232:235], v[116:119]
    v_mul_f32 v72, s6, v72
    v_mul_f32 v73, s6, v73
    v_mfma_f32_16x16x32_bf16 v[84:87], a[104:107], a[228:231], v[84:87]
    ds_read_b64_tr_b16 a[124:125], v20 offset:57352
    ds_read_b64_tr_b16 a[126:127], v20 offset:61448
    v_mfma_f32_16x16x32_bf16 v[84:87], a[108:111], a[244:247], v[84:87]
    v_mul_f32 v74, s6, v74
    v_mul_f32 v75, s6, v75
    v_mfma_f32_16x16x32_bf16 v[52:55], a[108:111], a[240:243], v[52:55]
    buffer_load_dwordx4 v5, s[12:15], s46 offen offset:0 lds
    v_mul_f32 v104, s6, v104
    v_mfma_f32_16x16x32_bf16 v[52:55], a[104:107], a[224:227], v[52:55]
    s_waitcnt lgkmcnt(4)
    v_mul_f32 v105, s6, v105
    v_mul_f32 v106, s6, v106
    v_mfma_f32_16x16x32_bf16 v[56:59], a[112:115], a[224:227], v[56:59]
    v_mul_f32 v107, s6, v107
    v_mul_f32 v136, s6, v136
    v_mfma_f32_16x16x32_bf16 v[56:59], a[116:119], a[240:243], v[56:59]
    v_mul_f32 v137, s6, v137
    v_mul_f32 v138, s6, v138
    v_mfma_f32_16x16x32_bf16 v[88:91], a[116:119], a[244:247], v[88:91]
    v_mul_f32 v139, s6, v139
    v_mul_f32 v44, s6, v44
    v_mfma_f32_16x16x32_bf16 v[88:91], a[112:115], a[228:231], v[88:91]
    v_mul_f32 v45, s6, v45
    v_mul_f32 v46, s6, v46
    v_mfma_f32_16x16x32_bf16 v[120:123], a[112:115], a[232:235], v[120:123]
    buffer_load_dwordx4 v6, s[12:15], s46 offen offset:1024 lds
    v_mul_f32 v47, s6, v47
    v_mfma_f32_16x16x32_bf16 v[120:123], a[116:119], a[248:251], v[120:123]
    v_mul_f32 v76, s6, v76
    v_mul_f32 v77, s6, v77
    v_mfma_f32_16x16x32_bf16 v[152:155], a[116:119], a[252:255], v[152:155]
    v_mul_f32 v78, s6, v78
    v_mul_f32 v79, s6, v79
    v_mfma_f32_16x16x32_bf16 v[152:155], a[112:115], a[236:239], v[152:155]
    s_waitcnt lgkmcnt(0)
    v_mul_f32 v108, s6, v108
    v_mul_f32 v109, s6, v109
    v_mfma_f32_16x16x32_bf16 v[156:159], a[120:123], a[236:239], v[156:159]
    v_mul_f32 v110, s6, v110
    v_mul_f32 v111, s6, v111
    v_mfma_f32_16x16x32_bf16 v[156:159], a[124:127], a[252:255], v[156:159]
    v_mul_f32 v140, s6, v140
    v_mul_f32 v141, s6, v141
    v_mfma_f32_16x16x32_bf16 v[124:127], a[124:127], a[248:251], v[124:127]
    buffer_load_dwordx4 v5, s[12:15], s46 offen offset:2048 lds
    v_mul_f32 v142, s6, v142
    v_mfma_f32_16x16x32_bf16 v[124:127], a[120:123], a[232:235], v[124:127]
    v_mul_f32 v143, s6, v143
    v_mul_f32 v48, s6, v48
    v_mfma_f32_16x16x32_bf16 v[92:95], a[120:123], a[228:231], v[92:95]
    v_mul_f32 v49, s6, v49
    v_mul_f32 v50, s6, v50
    v_mfma_f32_16x16x32_bf16 v[92:95], a[124:127], a[244:247], v[92:95]
    v_mul_f32 v51, s6, v51
    v_mul_f32 v80, s6, v80
    v_mfma_f32_16x16x32_bf16 v[60:63], a[124:127], a[240:243], v[60:63]
    v_mul_f32 v81, s6, v81
    v_mul_f32 v82, s6, v82
    v_mfma_f32_16x16x32_bf16 v[60:63], a[120:123], a[224:227], v[60:63]
    s_waitcnt vmcnt(11)
    v_mul_f32 v83, s6, v83
    v_mul_f32 v112, s6, v112
L_mid:
    s_barrier
    ds_read_b128 a[192:195], v10 offset:0
    ds_read_b128 a[196:199], v11 offset:0
    ds_read_b128 a[200:203], v12 offset:0
    ds_read_b128 a[204:207], v13 offset:0
    ds_read_b128 a[208:211], v10 offset:4096
    ds_read_b128 a[212:215], v11 offset:4096
    ds_read_b128 a[216:219], v12 offset:4096
    ds_read_b128 a[220:223], v13 offset:4096
    buffer_load_dwordx4 v6, s[12:15], s46 offen offset:3072 lds
    s_add_u32 s46, s46, 16384
    s_add_u32 m0, s39, 32768
    s_nop 0
    buffer_load_dwordx4 v1, s[8:11], s45 offen offset:0 lds
    buffer_load_dwordx4 v2, s[8:11], s45 offen offset:1024 lds
    buffer_load_dwordx4 v3, s[8:11], s45 offen offset:2048 lds
    buffer_load_dwordx4 v4, s[8:11], s45 offen offset:3072 lds
    s_add_u32 s45, s45, 16384
    v_mul_f32 v113, s6, v113
    v_cvt_pk_bf16_f32 v32, v32, v33
    v_cvt_pk_bf16_f32 v33, v34, v35
    v_cvt_pk_bf16_f32 v34, v36, v37
    v_cvt_pk_bf16_f32 v35, v38, v39
    v_cvt_pk_bf16_f32 v36, v40, v41
    v_cvt_pk_bf16_f32 v37, v42, v43
    v_cvt_pk_bf16_f32 v38, v44, v45
    v_cvt_pk_bf16_f32 v39, v46, v47
    v_pk_mul_f32 v[52:53], v[52:53], s[6:7]
    v_pk_mul_f32 v[54:55], v[54:55], s[6:7]
    v_cvt_pk_bf16_f32 v40, v48, v49
    v_cvt_pk_bf16_f32 v41, v50, v51
    v_cvt_pk_bf16_f32 v42, v52, v53
    v_cvt_pk_bf16_f32 v43, v54, v55
    v_pk_mul_f32 v[56:57], v[56:57], s[6:7]
    v_pk_mul_f32 v[58:59], v[58:59], s[6:7]
    v_pk_mul_f32 v[60:61], v[60:61], s[6:7]
    v_pk_mul_f32 v[62:63], v[62:63], s[6:7]
    v_cvt_pk_bf16_f32 v44, v56, v57
    v_cvt_pk_bf16_f32 v45, v58, v59
    v_cvt_pk_bf16_f32 v46, v60, v61
    v_cvt_pk_bf16_f32 v47, v62, v63
    v_cvt_pk_bf16_f32 v48, v64, v65
    v_cvt_pk_bf16_f32 v49, v66, v67
    v_cvt_pk_bf16_f32 v50, v68, v69
    v_cvt_pk_bf16_f32 v51, v70, v71
    v_cvt_pk_bf16_f32 v52, v72, v73
    v_cvt_pk_bf16_f32 v53, v74, v75
    v_cvt_pk_bf16_f32 v54, v76, v77
    v_cvt_pk_bf16_f32 v55, v78, v79
    v_pk_mul_f32 v[84:85], v[84:85], s[6:7]
    v_pk_mul_f32 v[86:87], v[86:87], s[6:7]
    v_cvt_pk_bf16_f32 v56, v80, v81
    v_cvt_pk_bf16_f32 v57, v82, v83
    v_cvt_pk_bf16_f32 v58, v84, v85
    v_cvt_pk_bf16_f32 v59, v86, v87
    v_pk_mul_f32 v[88:89], v[88:89], s[6:7]
    v_pk_mul_f32 v[90:91], v[90:91], s[6:7]
    v_pk_mul_f32 v[92:93], v[92:93], s[6:7]
    v_pk_mul_f32 v[94:95], v[94:95], s[6:7]
    v_cvt_pk_bf16_f32 v60, v88, v89
    v_cvt_pk_bf16_f32 v61, v90, v91
    v_cvt_pk_bf16_f32 v62, v92, v93
    v_cvt_pk_bf16_f32 v63, v94, v95
    v_cvt_pk_bf16_f32 v64, v96, v97
    v_cvt_pk_bf16_f32 v65, v98, v99
    v_cvt_pk_bf16_f32 v66, v100, v101
    v_cvt_pk_bf16_f32 v67, v102, v103
    v_cvt_pk_bf16_f32 v68, v104, v105
    v_cvt_pk_bf16_f32 v69, v106, v107
    v_cvt_pk_bf16_f32 v70, v108, v109
    v_cvt_pk_bf16_f32 v71, v110, v111
    v_pk_mul_f32 v[114:115], v[114:115], s[6:7]
    v_pk_mul_f32 v[116:117], v[116:117], s[6:7]
    v_pk_mul_f32 v[118:119], v[118:119], s[6:7]
    v_cvt_pk_bf16_f32 v72, v112, v113
    v_cvt_pk_bf16_f32 v73, v114, v115
    v_cvt_pk_bf16_f32 v74, v116, v117
    v_cvt_pk_bf16_f32 v75, v118, v119
    v_pk_mul_f32 v[120:121], v[120:121], s[6:7]
    v_pk_mul_f32 v[122:123], v[122:123], s[6:7]
    v_pk_mul_f32 v[124:125], v[124:125], s[6:7]
    v_pk_mul_f32 v[126:127], v[126:127], s[6:7]
    v_cvt_pk_bf16_f32 v76, v120, v121
    v_cvt_pk_bf16_f32 v77, v122, v123
    v_cvt_pk_bf16_f32 v78, v124, v125
    v_cvt_pk_bf16_f32 v79, v126, v127
    v_cvt_pk_bf16_f32 v80, v128, v129
    v_cvt_pk_bf16_f32 v81, v130, v131
    v_cvt_pk_bf16_f32 v82, v132, v133
    v_cvt_pk_bf16_f32 v83, v134, v135
    v_cvt_pk_bf16_f32 v84, v136, v137
    v_cvt_pk_bf16_f32 v85, v138, v139
    v_cvt_pk_bf16_f32 v86, v140, v141
    v_cvt_pk_bf16_f32 v87, v142, v143
    v_pk_mul_f32 v[144:145], v[144:145], s[6:7]
    v_pk_mul_f32 v[146:147], v[146:147], s[6:7]
    v_pk_mul_f32 v[148:149], v[148:149], s[6:7]
    v_pk_mul_f32 v[150:151], v[150:151], s[6:7]
    v_cvt_pk_bf16_f32 v88, v144, v145
    v_cvt_pk_bf16_f32 v89, v146, v147
    v_cvt_pk_bf16_f32 v90, v148, v149
    v_cvt_pk_bf16_f32 v91, v150, v151
    v_pk_mul_f32 v[152:153], v[152:153], s[6:7]
    v_pk_mul_f32 v[154:155], v[154:155], s[6:7]
    v_pk_mul_f32 v[156:157], v[156:157], s[6:7]
    v_pk_mul_f32 v[158:159], v[158:159], s[6:7]
    v_cvt_pk_bf16_f32 v92, v152, v153
    v_cvt_pk_bf16_f32 v93, v154, v155
    v_cvt_pk_bf16_f32 v94, v156, v157
    v_cvt_pk_bf16_f32 v95, v158, v159
    s_waitcnt lgkmcnt(0)
    v_mfma_f32_16x16x32_bf16 v[96:99], a[192:195], v[32:35], 0
    v_rcp_f32 v231, v231
    v_mfma_f32_16x16x32_bf16 v[96:99], a[196:199], v[36:39], v[96:99]
    v_mul_f32 v224, v224, v240
    v_mul_f32 v225, v225, v241
    v_mfma_f32_16x16x32_bf16 v[96:99], a[200:203], v[40:43], v[96:99]
    v_mul_f32 v226, v226, v242
    v_mul_f32 v227, v227, v243
    v_mfma_f32_16x16x32_bf16 v[96:99], a[204:207], v[44:47], v[96:99]
    v_mul_f32 v228, v228, v244
    v_mul_f32 v229, v229, v245
    v_mfma_f32_16x16x32_bf16 v[104:107], a[204:207], v[60:63], 0
    v_mul_f32 v230, v230, v246
    v_mul_f32 v231, v231, v247
    v_mfma_f32_16x16x32_bf16 v[104:107], a[200:203], v[56:59], v[104:107]
    v_cvt_pk_bf16_f32 v224, v224, v225
    v_cvt_pk_bf16_f32 v225, v226, v227
    v_mfma_f32_16x16x32_bf16 v[104:107], a[196:199], v[52:55], v[104:107]
    v_cvt_pk_bf16_f32 v226, v228, v229
    v_cvt_pk_bf16_f32 v227, v230, v231
    v_mfma_f32_16x16x32_bf16 v[104:107], a[192:195], v[48:51], v[104:107]
    v_mul_f32 v232, 0xbfb8aa3b, v232
    v_mul_f32 v233, 0xbfb8aa3b, v233
    v_mfma_f32_16x16x32_bf16 v[112:115], a[192:195], v[64:67], 0
    v_mul_f32 v234, 0xbfb8aa3b, v234
    v_mul_f32 v235, 0xbfb8aa3b, v235
    v_mfma_f32_16x16x32_bf16 v[112:115], a[196:199], v[68:71], v[112:115]
    v_mul_f32 v236, 0xbfb8aa3b, v236
    v_mul_f32 v237, 0xbfb8aa3b, v237
    v_mfma_f32_16x16x32_bf16 v[112:115], a[200:203], v[72:75], v[112:115]
    v_mul_f32 v238, 0xbfb8aa3b, v238
    v_mul_f32 v239, 0xbfb8aa3b, v239
    v_mfma_f32_16x16x32_bf16 v[112:115], a[204:207], v[76:79], v[112:115]
    v_exp_f32 v232, v232
    v_mfma_f32_16x16x32_bf16 v[120:123], a[204:207], v[92:95], 0
    v_exp_f32 v233, v233
    v_mfma_f32_16x16x32_bf16 v[120:123], a[200:203], v[88:91], v[120:123]
    v_exp_f32 v234, v234
    v_mfma_f32_16x16x32_bf16 v[120:123], a[196:199], v[84:87], v[120:123]
    v_exp_f32 v235, v235
    v_mfma_f32_16x16x32_bf16 v[120:123], a[192:195], v[80:83], v[120:123]
    v_exp_f32 v236, v236
    v_mfma_f32_16x16x32_bf16 v[124:127], a[208:211], v[80:83], 0
    v_exp_f32 v237, v237
    v_mfma_f32_16x16x32_bf16 v[124:127], a[212:215], v[84:87], v[124:127]
    v_exp_f32 v238, v238
    v_mfma_f32_16x16x32_bf16 v[124:127], a[216:219], v[88:91], v[124:127]
    v_exp_f32 v239, v239
    v_mfma_f32_16x16x32_bf16 v[124:127], a[220:223], v[92:95], v[124:127]
    v_add_f32 v232, 1.0, v232
    v_add_f32 v233, 1.0, v233
    v_mfma_f32_16x16x32_bf16 v[116:119], a[220:223], v[76:79], 0
    v_add_f32 v234, 1.0, v234
    v_add_f32 v235, 1.0, v235
    v_mfma_f32_16x16x32_bf16 v[116:119], a[216:219], v[72:75], v[116:119]
    v_add_f32 v236, 1.0, v236
    v_add_f32 v237, 1.0, v237
    v_mfma_f32_16x16x32_bf16 v[116:119], a[212:215], v[68:71], v[116:119]
    v_add_f32 v238, 1.0, v238
    v_add_f32 v239, 1.0, v239
    v_mfma_f32_16x16x32_bf16 v[116:119], a[208:211], v[64:67], v[116:119]
    v_rcp_f32 v232, v232
    v_mfma_f32_16x16x32_bf16 v[108:111], a[208:211], v[48:51], 0
    v_rcp_f32 v233, v233
    v_mfma_f32_16x16x32_bf16 v[108:111], a[212:215], v[52:55], v[108:111]
    v_rcp_f32 v234, v234
    v_mfma_f32_16x16x32_bf16 v[108:111], a[216:219], v[56:59], v[108:111]
    v_rcp_f32 v235, v235
    v_mfma_f32_16x16x32_bf16 v[108:111], a[220:223], v[60:63], v[108:111]
    v_rcp_f32 v236, v236
    v_mfma_f32_16x16x32_bf16 v[100:103], a[220:223], v[44:47], 0
    v_rcp_f32 v237, v237
    v_mfma_f32_16x16x32_bf16 v[100:103], a[216:219], v[40:43], v[100:103]
    v_rcp_f32 v238, v238
    v_mfma_f32_16x16x32_bf16 v[100:103], a[212:215], v[36:39], v[100:103]
    v_rcp_f32 v239, v239
    v_mfma_f32_16x16x32_bf16 v[100:103], a[208:211], v[32:35], v[100:103]
    v_mul_f32 v232, v232, v248
    v_mul_f32 v233, v233, v249
    ds_read_b128 a[192:195], v10 offset:8192
    ds_read_b128 a[196:199], v11 offset:8192
    ds_read_b128 a[200:203], v12 offset:8192
    ds_read_b128 a[204:207], v13 offset:8192
    ds_read_b128 a[208:211], v10 offset:12288
    ds_read_b128 a[212:215], v11 offset:12288
    ds_read_b128 a[216:219], v12 offset:12288
    ds_read_b128 a[220:223], v13 offset:12288
    s_cmp_lg_u32 s48, 0
    s_cbranch_scc1 L_maxpass
    v_max3_f32 v182, v120, v121, v122
    v_max3_f32 v183, v123, v124, v125
    v_max3_f32 v182, v182, v126, v127
    v_max_f32 v182, v182, v183
    v_max3_f32 v180, v112, v113, v114
    v_max3_f32 v181, v115, v116, v117
    v_max3_f32 v180, v180, v118, v119
    v_max_f32 v180, v180, v181
    v_max3_f32 v178, v104, v105, v106
    v_max3_f32 v179, v107, v108, v109
    v_max3_f32 v178, v178, v110, v111
    v_max_f32 v178, v178, v179
    v_max3_f32 v176, v96, v97, v98
    v_max3_f32 v177, v99, v100, v101
    v_max3_f32 v176, v176, v102, v103
    v_max_f32 v176, v176, v177
L_redm:
    v_mov_b32 v23, 0x3f803f80
    v_mov_b32 v177, v176
    v_mov_b32 v179, v178
    v_mov_b32 v181, v180
    v_mov_b32 v183, v182
    v_accvgpr_write_b32 a144, v23
    v_accvgpr_write_b32 a145, v23
    v_permlane16_swap_b32 v176, v177
    v_permlane16_swap_b32 v178, v179
    v_permlane16_swap_b32 v180, v181
    v_permlane16_swap_b32 v182, v183
    s_nop 1
    v_max_f32 v176, v176, v177
    v_max_f32 v178, v178, v179
    v_max_f32 v180, v180, v181
    v_max_f32 v182, v182, v183
    v_mov_b32 v177, v176
    v_mov_b32 v179, v178
    v_mov_b32 v181, v180
    v_mov_b32 v183, v182
    v_accvgpr_write_b32 a146, v23
    v_accvgpr_write_b32 a147, v23
    v_permlane32_swap_b32 v176, v177
    v_permlane32_swap_b32 v178, v179
    v_permlane32_swap_b32 v180, v181
    v_permlane32_swap_b32 v182, v183
    s_nop 1
    v_max_f32 v176, v176, v177
    v_max_f32 v178, v178, v179
    v_max_f32 v180, v180, v181
    v_max_f32 v182, v182, v183
    v_sub_f32 v192, 0, v176
    v_sub_f32 v193, 0, v176
    v_sub_f32 v194, 0, v176
    v_sub_f32 v195, 0, v176
    v_sub_f32 v196, 0, v178
    v_sub_f32 v197, 0, v178
    v_sub_f32 v198, 0, v178
    v_sub_f32 v199, 0, v178
    v_sub_f32 v200, 0, v180
    v_sub_f32 v201, 0, v180
    v_sub_f32 v202, 0, v180
    v_sub_f32 v203, 0, v180
    v_sub_f32 v204, 0, v182
    v_sub_f32 v205, 0, v182
    v_sub_f32 v206, 0, v182
    v_sub_f32 v207, 0, v182
    v_pk_add_f32 v[96:97], v[96:97], v[192:193]
    v_pk_add_f32 v[98:99], v[98:99], v[192:193]
    v_pk_add_f32 v[100:101], v[100:101], v[192:193]
    v_pk_add_f32 v[102:103], v[102:103], v[192:193]
    v_pk_add_f32 v[104:105], v[104:105], v[196:197]
    v_pk_add_f32 v[106:107], v[106:107], v[196:197]
    v_pk_add_f32 v[108:109], v[108:109], v[196:197]
    v_pk_add_f32 v[110:111], v[110:111], v[196:197]
    v_pk_add_f32 v[112:113], v[112:113], v[200:201]
    v_pk_add_f32 v[114:115], v[114:115], v[200:201]
    v_pk_add_f32 v[116:117], v[116:117], v[200:201]
    v_pk_add_f32 v[118:119], v[118:119], v[200:201]
    v_pk_add_f32 v[120:121], v[120:121], v[204:205]
    v_pk_add_f32 v[122:123], v[122:123], v[204:205]
    v_pk_add_f32 v[124:125], v[124:125], v[204:205]
    v_pk_add_f32 v[126:127], v[126:127], v[204:205]
    v_accvgpr_write_b32 a128, 0
    v_accvgpr_write_b32 a129, 0
    v_accvgpr_write_b32 a132, 0
    v_accvgpr_write_b32 a133, 0
    v_accvgpr_write_b32 a136, 0
    v_accvgpr_write_b32 a137, 0
    v_accvgpr_write_b32 a140, 0
    v_accvgpr_write_b32 a141, 0
    s_waitcnt lgkmcnt(0)
    v_mfma_f32_16x16x32_bf16 v[128:131], a[192:195], v[32:35], v[192:195]
    v_exp_f32 v96, v96
    v_mfma_f32_16x16x32_bf16 v[128:131], a[196:199], v[36:39], v[128:131]
    v_exp_f32 v97, v97
    v_mfma_f32_16x16x32_bf16 v[128:131], a[200:203], v[40:43], v[128:131]
    v_exp_f32 v98, v98
    v_mfma_f32_16x16x32_bf16 v[128:131], a[204:207], v[44:47], v[128:131]
    v_exp_f32 v99, v99
    v_mfma_f32_16x16x32_bf16 v[136:139], a[204:207], v[60:63], v[196:199]
    v_exp_f32 v104, v104
    v_mfma_f32_16x16x32_bf16 v[136:139], a[200:203], v[56:59], v[136:139]
    v_exp_f32 v105, v105
    v_mfma_f32_16x16x32_bf16 v[136:139], a[196:199], v[52:55], v[136:139]
    v_exp_f32 v106, v106
    v_mfma_f32_16x16x32_bf16 v[136:139], a[192:195], v[48:51], v[136:139]
    v_exp_f32 v107, v107
    v_mfma_f32_16x16x32_bf16 v[144:147], a[192:195], v[64:67], v[200:203]
    v_exp_f32 v112, v112
    v_mfma_f32_16x16x32_bf16 v[144:147], a[196:199], v[68:71], v[144:147]
    v_exp_f32 v113, v113
    v_mfma_f32_16x16x32_bf16 v[144:147], a[200:203], v[72:75], v[144:147]
    v_exp_f32 v114, v114
    v_mfma_f32_16x16x32_bf16 v[144:147], a[204:207], v[76:79], v[144:147]
    v_exp_f32 v115, v115
    v_mfma_f32_16x16x32_bf16 v[152:155], a[204:207], v[92:95], v[204:207]
    v_exp_f32 v120, v120
    v_mfma_f32_16x16x32_bf16 v[152:155], a[200:203], v[88:91], v[152:155]
    v_exp_f32 v121, v121
    v_mfma_f32_16x16x32_bf16 v[152:155], a[196:199], v[84:87], v[152:155]
    v_exp_f32 v122, v122
    v_mfma_f32_16x16x32_bf16 v[152:155], a[192:195], v[80:83], v[152:155]
    v_exp_f32 v123, v123
    v_mfma_f32_16x16x32_bf16 v[156:159], a[208:211], v[80:83], v[204:207]
    s_waitcnt vmcnt(8)
    v_exp_f32 v124, v124
    v_mfma_f32_16x16x32_bf16 v[156:159], a[212:215], v[84:87], v[156:159]
    s_barrier
    v_exp_f32 v125, v125
    v_mfma_f32_16x16x32_bf16 v[156:159], a[216:219], v[88:91], v[156:159]
    ds_read_b128 a[192:195], v10 offset:16384
    ds_read_b128 a[196:199], v11 offset:16384
    v_mfma_f32_16x16x32_bf16 v[156:159], a[220:223], v[92:95], v[156:159]
    ds_read_b128 a[200:203], v12 offset:16384
    ds_read_b128 a[204:207], v13 offset:16384
    v_mfma_f32_16x16x32_bf16 v[148:151], a[220:223], v[76:79], v[200:203]
    v_exp_f32 v126, v126
    v_mfma_f32_16x16x32_bf16 v[148:151], a[216:219], v[72:75], v[148:151]
    v_exp_f32 v127, v127
    v_mfma_f32_16x16x32_bf16 v[148:151], a[212:215], v[68:71], v[148:151]
    v_exp_f32 v116, v116
    v_mfma_f32_16x16x32_bf16 v[148:151], a[208:211], v[64:67], v[148:151]
    v_exp_f32 v117, v117
    v_mfma_f32_16x16x32_bf16 v[140:143], a[208:211], v[48:51], v[196:199]
    v_exp_f32 v118, v118
    v_mfma_f32_16x16x32_bf16 v[140:143], a[212:215], v[52:55], v[140:143]
    v_exp_f32 v119, v119
    v_mfma_f32_16x16x32_bf16 v[140:143], a[216:219], v[56:59], v[140:143]
    v_exp_f32 v108, v108
    v_mfma_f32_16x16x32_bf16 v[140:143], a[220:223], v[60:63], v[140:143]
    v_exp_f32 v109, v109
    v_mfma_f32_16x16x32_bf16 v[132:135], a[220:223], v[44:47], v[192:195]
    v_exp_f32 v110, v110
    v_mfma_f32_16x16x32_bf16 v[132:135], a[216:219], v[40:43], v[132:135]
    v_exp_f32 v111, v111
    v_mfma_f32_16x16x32_bf16 v[132:135], a[212:215], v[36:39], v[132:135]
    v_exp_f32 v100, v100
    v_mfma_f32_16x16x32_bf16 v[132:135], a[208:211], v[32:35], v[132:135]
    v_exp_f32 v101, v101
    v_cvt_pk_bf16_f32 v160, v96, v97
    v_cvt_pk_bf16_f32 v161, v98, v99
    v_cvt_pk_bf16_f32 v168, v104, v105
    v_cvt_pk_bf16_f32 v169, v106, v107
    v_cvt_pk_bf16_f32 v176, v112, v113
    v_cvt_pk_bf16_f32 v177, v114, v115
    v_exp_f32 v102, v102
    v_exp_f32 v103, v103
    v_exp_f32 v128, v128
    v_exp_f32 v129, v129
    v_exp_f32 v130, v130
    v_exp_f32 v131, v131
    v_exp_f32 v136, v136
    v_exp_f32 v137, v137
    v_exp_f32 v138, v138
    v_exp_f32 v139, v139
    v_exp_f32 v144, v144
    v_exp_f32 v145, v145
    v_exp_f32 v146, v146
    v_exp_f32 v147, v147
    v_exp_f32 v152, v152
    v_exp_f32 v153, v153
    v_exp_f32 v154, v154
    v_exp_f32 v155, v155
    v_exp_f32 v156, v156
    v_exp_f32 v157, v157
    v_exp_f32 v158, v158
    v_exp_f32 v159, v159
    v_exp_f32 v148, v148
    v_exp_f32 v149, v149
    v_exp_f32 v150, v150
    v_exp_f32 v151, v151
    v_exp_f32 v140, v140
    v_exp_f32 v141, v141
    s_waitcnt lgkmcnt(0)
    v_mfma_f32_16x16x32_bf16 v[96:99], a[192:195], v[32:35], v[192:195]
    s_add_u32 m0, s39, 49152
    v_exp_f32 v142, v142
    v_mfma_f32_16x16x32_bf16 v[96:99], a[196:199], v[36:39], v[96:99]
    s_bfe_u32 s40, s2, 0x20001
    ds_read_b128 a[208:211], v10 offset:20480
    v_cvt_pk_bf16_f32 v184, v120, v121
    v_mfma_f32_16x16x32_bf16 v[96:99], a[200:203], v[40:43], v[96:99]
    s_and_b32 s49, s2, 1
    v_exp_f32 v143, v143
    v_mfma_f32_16x16x32_bf16 v[96:99], a[204:207], v[44:47], v[96:99]
    s_bfe_u32 s42, s2, 0x20003
    ds_read_b128 a[212:215], v11 offset:20480
    v_cvt_pk_bf16_f32 v185, v122, v123
    v_mfma_f32_16x16x32_bf16 v[104:107], a[204:207], v[60:63], v[196:199]
    s_lshl_b32 s50, s38, 1
    v_exp_f32 v132, v132
    v_mfma_f32_16x16x32_bf16 v[104:107], a[200:203], v[56:59], v[104:107]
    s_add_u32 s50, s50, s49
    ds_read_b128 a[216:219], v12 offset:20480
    v_cvt_pk_bf16_f32 v186, v124, v125
    v_mfma_f32_16x16x32_bf16 v[104:107], a[196:199], v[52:55], v[104:107]
    s_lshl_b32 s54, s50, 2
    v_exp_f32 v133, v133
    v_mfma_f32_16x16x32_bf16 v[104:107], a[192:195], v[48:51], v[104:107]
    s_add_u32 s54, s54, s42
    ds_read_b128 a[220:223], v13 offset:20480
    v_cvt_pk_bf16_f32 v187, v126, v127
    v_mfma_f32_16x16x32_bf16 v[112:115], a[192:195], v[64:67], v[200:203]
    s_lshl_b32 s41, s50, 3
    v_exp_f32 v134, v134
    v_mfma_f32_16x16x32_bf16 v[112:115], a[196:199], v[68:71], v[112:115]
    s_lshl_b32 s51, s36, 1
    v_cvt_pk_bf16_f32 v178, v116, v117
    v_cvt_pk_bf16_f32 v179, v118, v119
    v_mfma_f32_16x16x32_bf16 v[112:115], a[200:203], v[72:75], v[112:115]
    s_add_u32 s41, s41, s51
    v_exp_f32 v135, v135
    v_mfma_f32_16x16x32_bf16 v[112:115], a[204:207], v[76:79], v[112:115]
    s_lshl_b32 s55, s49, 1
    v_cvt_pk_bf16_f32 v170, v108, v109
    v_cvt_pk_bf16_f32 v171, v110, v111
    v_mfma_f32_16x16x32_bf16 v[120:123], a[204:207], v[92:95], v[204:207]
    s_lshr_b32 s51, s36, 1
    v_exp_f32 v96, v96
    v_mfma_f32_16x16x32_bf16 v[120:123], a[200:203], v[88:91], v[120:123]
    s_add_u32 s55, s55, s51
    buffer_load_dwordx4 v1, s[8:11], s45 offen offset:0 lds
    v_bfe_i32 v23, v0, 0, 1
    v_mfma_f32_16x16x32_bf16 v[120:123], a[196:199], v[84:87], v[120:123]
    s_lshl_b32 s49, s54, 2
    v_exp_f32 v97, v97
    v_mfma_f32_16x16x32_bf16 v[120:123], a[192:195], v[80:83], v[120:123]
    s_waitcnt lgkmcnt(0)
    v_cvt_pk_bf16_f32 v162, v100, v101
    v_cvt_pk_bf16_f32 v163, v102, v103
    v_mfma_f32_16x16x32_bf16 v[124:127], a[208:211], v[80:83], v[204:207]
    s_add_u32 s49, s49, s40
    v_exp_f32 v98, v98
    v_mfma_f32_16x16x32_bf16 v[124:127], a[212:215], v[84:87], v[124:127]
    s_lshl_b32 s49, s49, 2
    ds_read_b128 a[192:195], v10 offset:24576
    v_and_b32 v23, 0xaaaaaaaa, v23
    v_mfma_f32_16x16x32_bf16 v[124:127], a[216:219], v[88:91], v[124:127]
    s_add_u32 s49, s49, s36
    v_exp_f32 v99, v99
    v_mfma_f32_16x16x32_bf16 v[124:127], a[220:223], v[92:95], v[124:127]
    s_mul_i32 s49, s49, 12288
    ds_read_b128 a[196:199], v11 offset:24576
    v_cvt_pk_bf16_f32 v164, v128, v129
    v_mfma_f32_16x16x32_bf16 v[116:119], a[220:223], v[76:79], v[200:203]
    s_add_u32 s49, s49, 26214400
    v_exp_f32 v104, v104
    v_mfma_f32_16x16x32_bf16 v[116:119], a[216:219], v[72:75], v[116:119]
    s_add_u32 s92, s4, s49
    s_addc_u32 s93, s5, 0
    ds_read_b128 a[200:203], v12 offset:24576
    v_cvt_pk_bf16_f32 v165, v130, v131
    v_mfma_f32_16x16x32_bf16 v[116:119], a[212:215], v[68:71], v[116:119]
    s_movk_i32 s94, 12288
    v_exp_f32 v105, v105
    v_mfma_f32_16x16x32_bf16 v[116:119], a[208:211], v[64:67], v[116:119]
    s_mov_b32 s95, 0x20000
    ds_read_b128 a[204:207], v13 offset:24576
    v_cvt_pk_bf16_f32 v172, v136, v137
    v_mfma_f32_16x16x32_bf16 v[108:111], a[208:211], v[48:51], v[196:199]
    s_mov_b32 s47, 1
    v_exp_f32 v106, v106
    v_mfma_f32_16x16x32_bf16 v[108:111], a[212:215], v[52:55], v[108:111]
    s_lshl_b32 s49, s38, 2
    buffer_load_dwordx4 v2, s[8:11], s45 offen offset:1024 lds
    v_cvt_pk_bf16_f32 v173, v138, v139
    v_mfma_f32_16x16x32_bf16 v[108:111], a[216:219], v[56:59], v[108:111]
    s_add_u32 s91, s49, s55
    v_exp_f32 v107, v107
    v_mfma_f32_16x16x32_bf16 v[108:111], a[220:223], v[60:63], v[108:111]
    s_lshl_b32 s91, s91, 8
    v_cvt_pk_bf16_f32 v180, v144, v145
    v_cvt_pk_bf16_f32 v181, v146, v147
    v_mfma_f32_16x16x32_bf16 v[100:103], a[220:223], v[44:47], v[192:195]
    s_add_u32 s49, s49, s36
    v_exp_f32 v112, v112
    v_mfma_f32_16x16x32_bf16 v[100:103], a[216:219], v[40:43], v[100:103]
    s_lshl_b32 s88, s49, 5
    v_or_b32 v23, 0x44444444, v23
    v_mul_f32 v234, v234, v250
    v_mfma_f32_16x16x32_bf16 v[100:103], a[212:215], v[36:39], v[100:103]
    s_add_u32 s88, s88, s37
    v_exp_f32 v113, v113
    v_mfma_f32_16x16x32_bf16 v[100:103], a[208:211], v[32:35], v[100:103]
    s_waitcnt lgkmcnt(0)
    v_cvt_pk_bf16_f32 v188, v152, v153
    v_cvt_pk_bf16_f32 v189, v154, v155
    v_mfma_f32_16x16x32_bf16 v[128:131], a[192:195], v[32:35], v[192:195]
    s_lshl_b32 s88, s88, 3
    v_exp_f32 v114, v114
    v_mfma_f32_16x16x32_bf16 v[128:131], a[196:199], v[36:39], v[128:131]
    s_lshl_b32 s89, s49, 2
    ds_read_b128 a[208:211], v10 offset:28672
    buffer_load_dwordx4 v3, s[8:11], s45 offen offset:2048 lds
    v_mfma_f32_16x16x32_bf16 v[128:131], a[200:203], v[40:43], v[128:131]
    s_add_u32 s89, s89, s40
    v_exp_f32 v115, v115
    v_mfma_f32_16x16x32_bf16 v[128:131], a[204:207], v[44:47], v[128:131]
    s_lshl_b32 s89, s89, 7
    ds_read_b128 a[212:215], v11 offset:28672
    v_cvt_pk_bf16_f32 v190, v156, v157
    v_mfma_f32_16x16x32_bf16 v[136:139], a[204:207], v[60:63], v[196:199]
    s_add_u32 s89, s89, 8192
    v_exp_f32 v120, v120
    v_mfma_f32_16x16x32_bf16 v[136:139], a[200:203], v[56:59], v[136:139]
    s_lshl_b32 s90, s54, 2
    ds_read_b128 a[216:219], v12 offset:28672
    v_cvt_pk_bf16_f32 v191, v158, v159
    v_mfma_f32_16x16x32_bf16 v[136:139], a[196:199], v[52:55], v[136:139]
    s_add_u32 s90, s90, s36
    v_exp_f32 v121, v121
    v_mfma_f32_16x16x32_bf16 v[136:139], a[192:195], v[48:51], v[136:139]
    s_lshl_b32 s90, s90, 7
    ds_read_b128 a[220:223], v13 offset:28672
    v_cvt_pk_bf16_f32 v182, v148, v149
    v_mfma_f32_16x16x32_bf16 v[144:147], a[192:195], v[64:67], v[200:203]
    s_add_u32 s90, s90, 65536
    v_exp_f32 v122, v122
    v_mfma_f32_16x16x32_bf16 v[144:147], a[196:199], v[68:71], v[144:147]
    s_lshl_b32 s49, s42, 8
    buffer_load_dwordx4 v4, s[8:11], s45 offen offset:3072 lds
    v_cvt_pk_bf16_f32 v183, v150, v151
    v_mfma_f32_16x16x32_bf16 v[144:147], a[200:203], v[72:75], v[144:147]
    s_add_u32 s45, s45, 16384
    v_exp_f32 v123, v123
    v_mfma_f32_16x16x32_bf16 v[144:147], a[204:207], v[76:79], v[144:147]
    s_add_u32 m0, s39, 114688
    v_cvt_pk_bf16_f32 v174, v140, v141
    v_cvt_pk_bf16_f32 v175, v142, v143
    v_mfma_f32_16x16x32_bf16 v[152:155], a[204:207], v[92:95], v[204:207]
    s_add_u32 s16, s60, s49
    s_addc_u32 s17, s61, 0
    v_exp_f32 v124, v124
    v_mfma_f32_16x16x32_bf16 v[152:155], a[200:203], v[88:91], v[152:155]
    s_sub_u32 s18, 1409024, s49
    ds_read_b64_tr_b16 a[228:229], v24 offset:24576
    v_mul_f32 v235, v235, v251
    v_mfma_f32_16x16x32_bf16 v[152:155], a[196:199], v[84:87], v[152:155]
    s_add_u32 s20, s58, s49
    s_addc_u32 s21, s59, 0
    v_exp_f32 v125, v125
    v_mfma_f32_16x16x32_bf16 v[152:155], a[192:195], v[80:83], v[152:155]
    s_waitcnt lgkmcnt(1)
    ds_read_b64_tr_b16 a[230:231], v24 offset:28672
    v_cvt_pk_bf16_f32 v166, v132, v133
    v_mfma_f32_16x16x32_bf16 v[156:159], a[208:211], v[80:83], v[204:207]
    s_sub_u32 s22, 4194304, s49
    v_exp_f32 v126, v126
    v_mfma_f32_16x16x32_bf16 v[156:159], a[212:215], v[84:87], v[156:159]
    s_mul_i32 s43, s40, 360448
    ds_read_b64_tr_b16 a[224:225], v24 offset:16384
    v_cvt_pk_bf16_f32 v167, v134, v135
    v_mfma_f32_16x16x32_bf16 v[156:159], a[216:219], v[88:91], v[156:159]
    s_mul_i32 s44, s40, 1441792
    v_exp_f32 v127, v127
    v_mfma_f32_16x16x32_bf16 v[156:159], a[220:223], v[92:95], v[156:159]
    s_lshr_b32 s50, s2, 3
    ds_read_b64_tr_b16 a[226:227], v24 offset:20480
    buffer_load_dwordx4 v5, s[12:15], s46 offen offset:0 lds
    v_mfma_f32_16x16x32_bf16 v[148:151], a[220:223], v[76:79], v[200:203]
    s_lshl_b32 s7, s36, 5
    v_exp_f32 v116, v116
    v_mfma_f32_16x16x32_bf16 v[148:151], a[216:219], v[72:75], v[148:151]
    s_add_u32 s7, s7, s50
    ds_read_b64_tr_b16 a[236:237], v25 offset:24576
    v_mul_f32 v236, v236, v252
    v_mfma_f32_16x16x32_bf16 v[148:151], a[212:215], v[68:71], v[148:151]
    s_lshl_b32 s7, s7, 13
    v_exp_f32 v117, v117
    v_mfma_f32_16x16x32_bf16 v[148:151], a[208:211], v[64:67], v[148:151]
    s_sub_u32 s7, s7, s49
    ds_read_b64_tr_b16 a[238:239], v25 offset:28672
    v_mul_f32 v237, v237, v253
    v_mfma_f32_16x16x32_bf16 v[140:143], a[208:211], v[48:51], v[196:199]
    s_add_u32 s6, s43, s7
    v_exp_f32 v118, v118
    v_mfma_f32_16x16x32_bf16 v[140:143], a[212:215], v[52:55], v[140:143]
    s_cmp_lt_u32 s7, 392192
    s_cselect_b32 s6, s6, 0x80000000
    ds_read_b64_tr_b16 a[232:233], v25 offset:16384
    buffer_load_dwordx4 v6, s[12:15], s46 offen offset:1024 lds
    v_mfma_f32_16x16x32_bf16 v[140:143], a[216:219], v[56:59], v[140:143]
    s_lshl_b32 s49, s40, 20
    v_exp_f32 v119, v119
    v_mfma_f32_16x16x32_bf16 v[140:143], a[220:223], v[60:63], v[140:143]
    s_add_u32 s7, s7, s49
    ds_read_b64_tr_b16 a[234:235], v25 offset:20480
    v_mul_f32 v238, v238, v254
    v_mfma_f32_16x16x32_bf16 v[132:135], a[220:223], v[44:47], v[192:195]
    s_lshl_b32 s49, s41, 9
    v_exp_f32 v108, v108
    v_mfma_f32_16x16x32_bf16 v[132:135], a[216:219], v[40:43], v[132:135]
    s_sub_u32 s26, 5636096, s49
    ds_read_b64_tr_b16 a[244:245], v26 offset:24576
    v_mul_f32 v239, v239, v255
    v_mfma_f32_16x16x32_bf16 v[132:135], a[212:215], v[36:39], v[132:135]
    s_add_u32 s49, s49, 2097152
    v_exp_f32 v109, v109
    v_mfma_f32_16x16x32_bf16 v[132:135], a[208:211], v[32:35], v[132:135]
    s_add_u32 s24, s4, s49
    s_addc_u32 s25, s5, 0
    ds_read_b64_tr_b16 a[246:247], v26 offset:28672
    buffer_load_dwordx4 v5, s[12:15], s46 offen offset:2048 lds
    v_smfmac_f32_16x16x64_bf16 a[128:131], a[144:147], v[160:167], v23
    s_lshl_b32 s49, s41, 6
    ds_read_b64_tr_b16 a[240:241], v26 offset:16384
    v_smfmac_f32_16x16x64_bf16 a[132:135], a[144:147], v[168:175], v23
    s_add_u32 s49, s49, s42
    v_cvt_pk_bf16_f32 v232, v232, v233
    v_smfmac_f32_16x16x64_bf16 a[136:139], a[144:147], v[176:183], v23
    s_lshl_b32 s49, s49, 2
    ds_read_b64_tr_b16 a[242:243], v26 offset:20480
    v_smfmac_f32_16x16x64_bf16 a[140:143], a[144:147], v[184:191], v23
    s_waitcnt lgkmcnt(8)
    v_cvt_pk_bf16_f32 v233, v234, v235
    v_mfma_f32_16x16x32_bf16 a[12:15], a[228:231], v[188:191], 0
    s_add_u32 s49, s49, s40
    ds_read_b64_tr_b16 a[252:253], v27 offset:24576
    ds_read_b64_tr_b16 a[254:255], v27 offset:28672
    v_mfma_f32_16x16x32_bf16 a[12:15], a[224:227], v[184:187], a[12:15]
    s_lshl_b32 s49, s49, 6
    v_exp_f32 v110, v110
    v_mfma_f32_16x16x32_bf16 a[8:11], a[224:227], v[176:179], 0
    s_brev_b32 s51, 1
    buffer_load_dwordx4 v6, s[12:15], s46 offen offset:3072 lds
    v_cvt_pk_bf16_f32 v234, v236, v237
    v_mfma_f32_16x16x32_bf16 a[8:11], a[228:231], v[180:183], a[8:11]
    s_add_u32 s46, s46, 16384
    v_exp_f32 v111, v111
    v_mfma_f32_16x16x32_bf16 a[4:7], a[228:231], v[172:175], 0
    s_add_u32 m0, s39, 0
    ds_read_b64_tr_b16 a[248:249], v27 offset:16384
    ds_read_b64_tr_b16 a[250:251], v27 offset:20480
    v_mfma_f32_16x16x32_bf16 a[4:7], a[224:227], v[168:171], a[4:7]
    s_brev_b32 s52, 1
    v_exp_f32 v100, v100
    v_mfma_f32_16x16x32_bf16 a[0:3], a[224:227], v[160:163], 0
    s_brev_b32 s53, 1
    v_cvt_pk_bf16_f32 v235, v238, v239
    v_mfma_f32_16x16x32_bf16 a[0:3], a[228:231], v[164:167], a[0:3]
    s_waitcnt lgkmcnt(8)
    v_exp_f32 v101, v101
    v_mfma_f32_16x16x32_bf16 a[16:19], a[236:239], v[164:167], 0
    ds_read_b64_tr_b16 a[228:229], v28 offset:24576
    ds_read_b64_tr_b16 a[230:231], v28 offset:28672
    v_mfma_f32_16x16x32_bf16 a[16:19], a[232:235], v[160:163], a[16:19]
    v_exp_f32 v102, v102
    v_mfma_f32_16x16x32_bf16 a[20:23], a[232:235], v[168:171], 0
    buffer_load_dwordx4 v1, s[8:11], s45 offen offset:0 lds
    v_mfma_f32_16x16x32_bf16 a[20:23], a[236:239], v[172:175], a[20:23]
    v_exp_f32 v103, v103
    v_mfma_f32_16x16x32_bf16 a[24:27], a[236:239], v[180:183], 0
    ds_read_b64_tr_b16 a[224:225], v28 offset:16384
    ds_read_b64_tr_b16 a[226:227], v28 offset:20480
    v_mfma_f32_16x16x32_bf16 a[24:27], a[232:235], v[176:179], a[24:27]
    v_exp_f32 v128, v128
    v_mfma_f32_16x16x32_bf16 a[28:31], a[232:235], v[184:187], 0
    buffer_load_dwordx4 v2, s[8:11], s45 offen offset:1024 lds
    v_mfma_f32_16x16x32_bf16 a[28:31], a[236:239], v[188:191], a[28:31]
    s_waitcnt lgkmcnt(8)
    v_exp_f32 v129, v129
    v_mfma_f32_16x16x32_bf16 a[44:47], a[244:247], v[188:191], 0
    ds_read_b64_tr_b16 a[236:237], v29 offset:24576
    ds_read_b64_tr_b16 a[238:239], v29 offset:28672
    v_mfma_f32_16x16x32_bf16 a[44:47], a[240:243], v[184:187], a[44:47]
    v_exp_f32 v130, v130
    v_mfma_f32_16x16x32_bf16 a[40:43], a[240:243], v[176:179], 0
    v_mfma_f32_16x16x32_bf16 a[40:43], a[244:247], v[180:183], a[40:43]
    v_exp_f32 v131, v131
    v_mfma_f32_16x16x32_bf16 a[36:39], a[244:247], v[172:175], 0
    ds_read_b64_tr_b16 a[232:233], v29 offset:16384
    ds_read_b64_tr_b16 a[234:235], v29 offset:20480
    v_mfma_f32_16x16x32_bf16 a[36:39], a[240:243], v[168:171], a[36:39]
    v_exp_f32 v136, v136
    v_mfma_f32_16x16x32_bf16 a[32:35], a[240:243], v[160:163], 0
    buffer_load_dwordx4 v3, s[8:11], s45 offen offset:2048 lds
    v_mfma_f32_16x16x32_bf16 a[32:35], a[244:247], v[164:167], a[32:35]
    s_waitcnt lgkmcnt(8)
    v_exp_f32 v137, v137
    v_mfma_f32_16x16x32_bf16 a[48:51], a[252:255], v[164:167], 0
    ds_read_b64_tr_b16 a[244:245], v30 offset:24576
    ds_read_b64_tr_b16 a[246:247], v30 offset:28672
    v_mfma_f32_16x16x32_bf16 a[48:51], a[248:251], v[160:163], a[48:51]
    v_exp_f32 v138, v138
    v_mfma_f32_16x16x32_bf16 a[52:55], a[248:251], v[168:171], 0
    v_mfma_f32_16x16x32_bf16 a[52:55], a[252:255], v[172:175], a[52:55]
    v_exp_f32 v139, v139
    v_mfma_f32_16x16x32_bf16 a[56:59], a[252:255], v[180:183], 0
    ds_read_b64_tr_b16 a[240:241], v30 offset:16384
    ds_read_b64_tr_b16 a[242:243], v30 offset:20480
    v_mfma_f32_16x16x32_bf16 a[56:59], a[248:251], v[176:179], a[56:59]
    v_exp_f32 v144, v144
    v_mfma_f32_16x16x32_bf16 a[60:63], a[248:251], v[184:187], 0
    buffer_load_dwordx4 v4, s[8:11], s45 offen offset:3072 lds
    v_mfma_f32_16x16x32_bf16 a[60:63], a[252:255], v[188:191], a[60:63]
    s_waitcnt lgkmcnt(8)
    v_exp_f32 v145, v145
    v_mfma_f32_16x16x32_bf16 a[76:79], a[228:231], v[188:191], 0
    s_add_u32 s45, s45, 16384
    ds_read_b64_tr_b16 a[252:253], v31 offset:24576
    ds_read_b64_tr_b16 a[254:255], v31 offset:28672
    v_mfma_f32_16x16x32_bf16 a[76:79], a[224:227], v[184:187], a[76:79]
    s_add_u32 m0, s39, 65536
    v_exp_f32 v146, v146
    v_mfma_f32_16x16x32_bf16 a[72:75], a[224:227], v[176:179], 0
    v_mfma_f32_16x16x32_bf16 a[72:75], a[228:231], v[180:183], a[72:75]
    v_exp_f32 v147, v147
    v_mfma_f32_16x16x32_bf16 a[68:71], a[228:231], v[172:175], 0
    ds_read_b64_tr_b16 a[248:249], v31 offset:16384
    ds_read_b64_tr_b16 a[250:251], v31 offset:20480
    v_mfma_f32_16x16x32_bf16 a[68:71], a[224:227], v[168:171], a[68:71]
    v_exp_f32 v152, v152
    v_mfma_f32_16x16x32_bf16 a[64:67], a[224:227], v[160:163], 0
    buffer_load_dwordx4 v5, s[12:15], s46 offen offset:0 lds
    v_mfma_f32_16x16x32_bf16 a[64:67], a[228:231], v[164:167], a[64:67]
    s_waitcnt lgkmcnt(8)
    v_exp_f32 v153, v153
    v_mfma_f32_16x16x32_bf16 a[80:83], a[236:239], v[164:167], 0
    v_mfma_f32_16x16x32_bf16 a[80:83], a[232:235], v[160:163], a[80:83]
    v_exp_f32 v154, v154
    v_mfma_f32_16x16x32_bf16 a[84:87], a[232:235], v[168:171], 0
    v_mfma_f32_16x16x32_bf16 a[84:87], a[236:239], v[172:175], a[84:87]
    v_exp_f32 v155, v155
    v_mfma_f32_16x16x32_bf16 a[88:91], a[236:239], v[180:183], 0
    buffer_load_dwordx4 v6, s[12:15], s46 offen offset:1024 lds
    v_mfma_f32_16x16x32_bf16 a[88:91], a[232:235], v[176:179], a[88:91]
    s_waitcnt vmcnt(14) lgkmcnt(0)
    v_exp_f32 v156, v156
    v_mfma_f32_16x16x32_bf16 a[92:95], a[232:235], v[184:187], 0
    s_barrier
    v_mfma_f32_16x16x32_bf16 a[92:95], a[236:239], v[188:191], a[92:95]
    v_exp_f32 v157, v157
    v_mfma_f32_16x16x32_bf16 a[108:111], a[244:247], v[188:191], 0
    ds_read_b128 a[192:195], v10 offset:32768
    buffer_load_dwordx4 v5, s[12:15], s46 offen offset:2048 lds
    v_mfma_f32_16x16x32_bf16 a[108:111], a[240:243], v[184:187], a[108:111]
    v_exp_f32 v158, v158
    v_mfma_f32_16x16x32_bf16 a[104:107], a[240:243], v[176:179], 0
    ds_read_b128 a[196:199], v11 offset:32768
    v_mfma_f32_16x16x32_bf16 a[104:107], a[244:247], v[180:183], a[104:107]
    v_exp_f32 v159, v159
    v_mfma_f32_16x16x32_bf16 a[100:103], a[244:247], v[172:175], 0
    ds_read_b128 a[200:203], v12 offset:32768
    v_mfma_f32_16x16x32_bf16 a[100:103], a[240:243], v[168:171], a[100:103]
    v_exp_f32 v148, v148
    v_mfma_f32_16x16x32_bf16 a[96:99], a[240:243], v[160:163], 0
    ds_read_b128 a[204:207], v13 offset:32768
    buffer_load_dwordx4 v6, s[12:15], s46 offen offset:3072 lds
    v_mfma_f32_16x16x32_bf16 a[96:99], a[244:247], v[164:167], a[96:99]
    s_add_u32 s46, s46, 16384
    v_exp_f32 v149, v149
    v_mfma_f32_16x16x32_bf16 a[112:115], a[252:255], v[164:167], 0
    s_mul_i32 s3, s37, 196608
    v_mfma_f32_16x16x32_bf16 a[112:115], a[248:251], v[160:163], a[112:115]
    s_add_u32 s3, s3, 65536
    v_exp_f32 v150, v150
    v_mfma_f32_16x16x32_bf16 a[116:119], a[248:251], v[168:171], 0
    v_cvt_pk_bf16_f32 v160, v96, v97
    v_cvt_pk_bf16_f32 v161, v98, v99
    v_mfma_f32_16x16x32_bf16 a[116:119], a[252:255], v[172:175], a[116:119]
    v_exp_f32 v151, v151
    v_mfma_f32_16x16x32_bf16 a[120:123], a[252:255], v[180:183], 0
    v_cvt_pk_bf16_f32 v168, v104, v105
    v_cvt_pk_bf16_f32 v169, v106, v107
    v_mfma_f32_16x16x32_bf16 a[120:123], a[248:251], v[176:179], a[120:123]
    v_exp_f32 v140, v140
    v_mfma_f32_16x16x32_bf16 a[124:127], a[248:251], v[184:187], 0
    v_cvt_pk_bf16_f32 v176, v112, v113
    v_cvt_pk_bf16_f32 v177, v114, v115
    v_mfma_f32_16x16x32_bf16 a[124:127], a[252:255], v[188:191], a[124:127]
    s_waitcnt lgkmcnt(0)
    v_exp_f32 v141, v141
    v_mfma_f32_16x16x32_bf16 v[96:99], a[192:195], v[32:35], v[192:195]
    v_exp_f32 v142, v142
    v_mfma_f32_16x16x32_bf16 v[96:99], a[196:199], v[36:39], v[96:99]
    ds_read_b128 a[208:211], v10 offset:36864
    v_cvt_pk_bf16_f32 v184, v120, v121
    v_mfma_f32_16x16x32_bf16 v[96:99], a[200:203], v[40:43], v[96:99]
    v_exp_f32 v143, v143
    v_mfma_f32_16x16x32_bf16 v[96:99], a[204:207], v[44:47], v[96:99]
    ds_read_b128 a[212:215], v11 offset:36864
    v_cvt_pk_bf16_f32 v185, v122, v123
    v_mfma_f32_16x16x32_bf16 v[104:107], a[204:207], v[60:63], v[196:199]
    v_exp_f32 v132, v132
    v_mfma_f32_16x16x32_bf16 v[104:107], a[200:203], v[56:59], v[104:107]
    ds_read_b128 a[216:219], v12 offset:36864
    v_cvt_pk_bf16_f32 v186, v124, v125
    v_mfma_f32_16x16x32_bf16 v[104:107], a[196:199], v[52:55], v[104:107]
    v_exp_f32 v133, v133
    v_mfma_f32_16x16x32_bf16 v[104:107], a[192:195], v[48:51], v[104:107]
    ds_read_b128 a[220:223], v13 offset:36864
    v_cvt_pk_bf16_f32 v187, v126, v127
    v_mfma_f32_16x16x32_bf16 v[112:115], a[192:195], v[64:67], v[200:203]
    v_exp_f32 v134, v134
    v_mfma_f32_16x16x32_bf16 v[112:115], a[196:199], v[68:71], v[112:115]
    v_cvt_pk_bf16_f32 v178, v116, v117
    v_cvt_pk_bf16_f32 v179, v118, v119
    v_mfma_f32_16x16x32_bf16 v[112:115], a[200:203], v[72:75], v[112:115]
    v_exp_f32 v135, v135
    v_mfma_f32_16x16x32_bf16 v[112:115], a[204:207], v[76:79], v[112:115]
    v_cvt_pk_bf16_f32 v170, v108, v109
    v_cvt_pk_bf16_f32 v171, v110, v111
    v_mfma_f32_16x16x32_bf16 v[120:123], a[204:207], v[92:95], v[204:207]
    v_exp_f32 v96, v96
    v_mfma_f32_16x16x32_bf16 v[120:123], a[200:203], v[88:91], v[120:123]
    buffer_store_dwordx4 v[208:211], v9, s[28:31], s3 offen offset:0 sc1
    v_lshlrev_b32 v20, 3, v9
    v_mfma_f32_16x16x32_bf16 v[120:123], a[196:199], v[84:87], v[120:123]
    v_exp_f32 v97, v97
    v_mfma_f32_16x16x32_bf16 v[120:123], a[192:195], v[80:83], v[120:123]
    s_waitcnt lgkmcnt(0)
    v_cvt_pk_bf16_f32 v162, v100, v101
    v_cvt_pk_bf16_f32 v163, v102, v103
    v_mfma_f32_16x16x32_bf16 v[124:127], a[208:211], v[80:83], v[204:207]
    v_exp_f32 v98, v98
    v_mfma_f32_16x16x32_bf16 v[124:127], a[212:215], v[84:87], v[124:127]
    ds_read_b128 a[192:195], v10 offset:40960
    v_and_b32 v22, 0xff, v5
    v_mfma_f32_16x16x32_bf16 v[124:127], a[216:219], v[88:91], v[124:127]
    v_exp_f32 v99, v99
    v_mfma_f32_16x16x32_bf16 v[124:127], a[220:223], v[92:95], v[124:127]
    ds_read_b128 a[196:199], v11 offset:40960
    v_cvt_pk_bf16_f32 v164, v128, v129
    v_mfma_f32_16x16x32_bf16 v[116:119], a[220:223], v[76:79], v[200:203]
    v_exp_f32 v104, v104
    v_mfma_f32_16x16x32_bf16 v[116:119], a[216:219], v[72:75], v[116:119]
    ds_read_b128 a[200:203], v12 offset:40960
    v_cvt_pk_bf16_f32 v165, v130, v131
    v_mfma_f32_16x16x32_bf16 v[116:119], a[212:215], v[68:71], v[116:119]
    v_exp_f32 v105, v105
    v_mfma_f32_16x16x32_bf16 v[116:119], a[208:211], v[64:67], v[116:119]
    ds_read_b128 a[204:207], v13 offset:40960
    v_cvt_pk_bf16_f32 v172, v136, v137
    v_mfma_f32_16x16x32_bf16 v[108:111], a[208:211], v[48:51], v[196:199]
    v_exp_f32 v106, v106
    v_mfma_f32_16x16x32_bf16 v[108:111], a[212:215], v[52:55], v[108:111]
    buffer_store_dwordx4 v[212:215], v9, s[28:31], s3 offen offset:1024 sc1
    v_cvt_pk_bf16_f32 v173, v138, v139
    v_mfma_f32_16x16x32_bf16 v[108:111], a[216:219], v[56:59], v[108:111]
    s_add_u32 m0, s39, 16384
    v_exp_f32 v107, v107
    v_mfma_f32_16x16x32_bf16 v[108:111], a[220:223], v[60:63], v[108:111]
    v_cvt_pk_bf16_f32 v180, v144, v145
    v_cvt_pk_bf16_f32 v181, v146, v147
    v_mfma_f32_16x16x32_bf16 v[100:103], a[220:223], v[44:47], v[192:195]
    v_exp_f32 v112, v112
    v_mfma_f32_16x16x32_bf16 v[100:103], a[216:219], v[40:43], v[100:103]
    v_sub_u32 v14, v5, v22
    v_lshl_add_u32 v14, v14, 2, v22
    v_mfma_f32_16x16x32_bf16 v[100:103], a[212:215], v[36:39], v[100:103]
    v_exp_f32 v113, v113
    v_mfma_f32_16x16x32_bf16 v[100:103], a[208:211], v[32:35], v[100:103]
    s_waitcnt lgkmcnt(0)
    v_cvt_pk_bf16_f32 v188, v152, v153
    v_cvt_pk_bf16_f32 v189, v154, v155
    v_mfma_f32_16x16x32_bf16 v[128:131], a[192:195], v[32:35], v[192:195]
    v_exp_f32 v114, v114
    v_mfma_f32_16x16x32_bf16 v[128:131], a[196:199], v[36:39], v[128:131]
    ds_read_b128 a[208:211], v10 offset:45056
    buffer_load_dwordx4 v1, s[8:11], s45 offen offset:0 lds
    v_mfma_f32_16x16x32_bf16 v[128:131], a[200:203], v[40:43], v[128:131]
    v_exp_f32 v115, v115
    v_mfma_f32_16x16x32_bf16 v[128:131], a[204:207], v[44:47], v[128:131]
    ds_read_b128 a[212:215], v11 offset:45056
    v_cvt_pk_bf16_f32 v190, v156, v157
    v_mfma_f32_16x16x32_bf16 v[136:139], a[204:207], v[60:63], v[196:199]
    v_exp_f32 v120, v120
    v_mfma_f32_16x16x32_bf16 v[136:139], a[200:203], v[56:59], v[136:139]
    ds_read_b128 a[216:219], v12 offset:45056
    v_cvt_pk_bf16_f32 v191, v158, v159
    v_mfma_f32_16x16x32_bf16 v[136:139], a[196:199], v[52:55], v[136:139]
    v_exp_f32 v121, v121
    v_mfma_f32_16x16x32_bf16 v[136:139], a[192:195], v[48:51], v[136:139]
    ds_read_b128 a[220:223], v13 offset:45056
    v_cvt_pk_bf16_f32 v182, v148, v149
    v_mfma_f32_16x16x32_bf16 v[144:147], a[192:195], v[64:67], v[200:203]
    v_exp_f32 v122, v122
    v_mfma_f32_16x16x32_bf16 v[144:147], a[196:199], v[68:71], v[144:147]
    buffer_load_dwordx4 v2, s[8:11], s45 offen offset:1024 lds
    v_cvt_pk_bf16_f32 v183, v150, v151
    v_mfma_f32_16x16x32_bf16 v[144:147], a[200:203], v[72:75], v[144:147]
    v_exp_f32 v123, v123
    v_mfma_f32_16x16x32_bf16 v[144:147], a[204:207], v[76:79], v[144:147]
    v_cvt_pk_bf16_f32 v174, v140, v141
    v_cvt_pk_bf16_f32 v175, v142, v143
    v_mfma_f32_16x16x32_bf16 v[152:155], a[204:207], v[92:95], v[204:207]
    v_exp_f32 v124, v124
    v_mfma_f32_16x16x32_bf16 v[152:155], a[200:203], v[88:91], v[152:155]
    ds_read_b64_tr_b16 a[228:229], v24 offset:40960
    v_and_b32 v22, 0xff, v6
    v_mfma_f32_16x16x32_bf16 v[152:155], a[196:199], v[84:87], v[152:155]
    v_exp_f32 v125, v125
    v_mfma_f32_16x16x32_bf16 v[152:155], a[192:195], v[80:83], v[152:155]
    s_waitcnt lgkmcnt(1)
    ds_read_b64_tr_b16 a[230:231], v24 offset:45056
    v_cvt_pk_bf16_f32 v166, v132, v133
    v_mfma_f32_16x16x32_bf16 v[156:159], a[208:211], v[80:83], v[204:207]
    v_exp_f32 v126, v126
    v_mfma_f32_16x16x32_bf16 v[156:159], a[212:215], v[84:87], v[156:159]
    ds_read_b64_tr_b16 a[224:225], v24 offset:32768
    v_cvt_pk_bf16_f32 v167, v134, v135
    v_mfma_f32_16x16x32_bf16 v[156:159], a[216:219], v[88:91], v[156:159]
    v_exp_f32 v127, v127
    v_mfma_f32_16x16x32_bf16 v[156:159], a[220:223], v[92:95], v[156:159]
    ds_read_b64_tr_b16 a[226:227], v24 offset:36864
    buffer_load_dwordx4 v3, s[8:11], s45 offen offset:2048 lds
    v_mfma_f32_16x16x32_bf16 v[148:151], a[220:223], v[76:79], v[200:203]
    v_exp_f32 v116, v116
    v_mfma_f32_16x16x32_bf16 v[148:151], a[216:219], v[72:75], v[148:151]
    ds_read_b64_tr_b16 a[236:237], v25 offset:40960
    v_sub_u32 v15, v6, v22
    v_mfma_f32_16x16x32_bf16 v[148:151], a[212:215], v[68:71], v[148:151]
    v_exp_f32 v117, v117
    v_mfma_f32_16x16x32_bf16 v[148:151], a[208:211], v[64:67], v[148:151]
    ds_read_b64_tr_b16 a[238:239], v25 offset:45056
    v_lshl_add_u32 v15, v15, 2, v22
    v_mfma_f32_16x16x32_bf16 v[140:143], a[208:211], v[48:51], v[196:199]
    v_exp_f32 v118, v118
    v_mfma_f32_16x16x32_bf16 v[140:143], a[212:215], v[52:55], v[140:143]
    ds_read_b64_tr_b16 a[232:233], v25 offset:32768
    buffer_load_dwordx4 v4, s[8:11], s45 offen offset:3072 lds
    v_mfma_f32_16x16x32_bf16 v[140:143], a[216:219], v[56:59], v[140:143]
    s_add_u32 s45, s45, 16384
    v_exp_f32 v119, v119
    v_mfma_f32_16x16x32_bf16 v[140:143], a[220:223], v[60:63], v[140:143]
    s_add_u32 m0, s39, 81920
    ds_read_b64_tr_b16 a[234:235], v25 offset:36864
    v_add_u32 v15, 3072, v15
    v_mfma_f32_16x16x32_bf16 v[132:135], a[220:223], v[44:47], v[192:195]
    v_exp_f32 v108, v108
    v_mfma_f32_16x16x32_bf16 v[132:135], a[216:219], v[40:43], v[132:135]
    ds_read_b64_tr_b16 a[244:245], v26 offset:40960
    v_add_u32 v16, 6144, v14
    v_mfma_f32_16x16x32_bf16 v[132:135], a[212:215], v[36:39], v[132:135]
    v_exp_f32 v109, v109
    v_mfma_f32_16x16x32_bf16 v[132:135], a[208:211], v[32:35], v[132:135]
    ds_read_b64_tr_b16 a[246:247], v26 offset:45056
    buffer_load_dwordx4 v5, s[12:15], s46 offen offset:0 lds
    v_smfmac_f32_16x16x64_bf16 a[128:131], a[144:147], v[160:167], v23
    ds_read_b64_tr_b16 a[240:241], v26 offset:32768
    v_smfmac_f32_16x16x64_bf16 a[132:135], a[144:147], v[168:175], v23
    v_add_u32 v17, 6144, v15
    v_smfmac_f32_16x16x64_bf16 a[136:139], a[144:147], v[176:183], v23
    ds_read_b64_tr_b16 a[242:243], v26 offset:36864
    v_smfmac_f32_16x16x64_bf16 a[140:143], a[144:147], v[184:191], v23
    s_waitcnt lgkmcnt(8)
    v_and_b32 v22, 15, v0
    v_mfma_f32_16x16x32_bf16 a[12:15], a[228:231], v[188:191], a[12:15]
    ds_read_b64_tr_b16 a[252:253], v27 offset:40960
    ds_read_b64_tr_b16 a[254:255], v27 offset:45056
    v_mfma_f32_16x16x32_bf16 a[12:15], a[224:227], v[184:187], a[12:15]
    v_exp_f32 v110, v110
    v_mfma_f32_16x16x32_bf16 a[8:11], a[224:227], v[176:179], a[8:11]
    buffer_load_dwordx4 v6, s[12:15], s46 offen offset:1024 lds
    v_lshrrev_b32 v18, 4, v0
    v_mfma_f32_16x16x32_bf16 a[8:11], a[228:231], v[180:183], a[8:11]
    v_exp_f32 v111, v111
    v_mfma_f32_16x16x32_bf16 a[4:7], a[228:231], v[172:175], a[4:7]
    ds_read_b64_tr_b16 a[248:249], v27 offset:32768
    ds_read_b64_tr_b16 a[250:251], v27 offset:36864
    v_mfma_f32_16x16x32_bf16 a[4:7], a[224:227], v[168:171], a[4:7]
    v_exp_f32 v100, v100
    v_mfma_f32_16x16x32_bf16 a[0:3], a[224:227], v[160:163], a[0:3]
    v_lshlrev_b32 v22, 10, v22
    v_lshl_add_u32 v22, v18, 3, v22
    v_mfma_f32_16x16x32_bf16 a[0:3], a[228:231], v[164:167], a[0:3]
    s_waitcnt lgkmcnt(8)
    v_exp_f32 v101, v101
    v_mfma_f32_16x16x32_bf16 a[16:19], a[236:239], v[164:167], a[16:19]
    ds_read_b64_tr_b16 a[228:229], v28 offset:40960
    ds_read_b64_tr_b16 a[230:231], v28 offset:45056
    v_mfma_f32_16x16x32_bf16 a[16:19], a[232:235], v[160:163], a[16:19]
    v_exp_f32 v102, v102
    v_mfma_f32_16x16x32_bf16 a[20:23], a[232:235], v[168:171], a[20:23]
    buffer_load_dwordx4 v5, s[12:15], s46 offen offset:2048 lds
    v_add_u32 v18, s49, v22
    v_mfma_f32_16x16x32_bf16 a[20:23], a[236:239], v[172:175], a[20:23]
    v_exp_f32 v103, v103
    v_mfma_f32_16x16x32_bf16 a[24:27], a[236:239], v[180:183], a[24:27]
    ds_read_b64_tr_b16 a[224:225], v28 offset:32768
    ds_read_b64_tr_b16 a[226:227], v28 offset:36864
    v_mfma_f32_16x16x32_bf16 a[24:27], a[232:235], v[176:179], a[24:27]
    v_exp_f32 v128, v128
    v_mfma_f32_16x16x32_bf16 a[28:31], a[232:235], v[184:187], a[28:31]
    buffer_load_dwordx4 v6, s[12:15], s46 offen offset:3072 lds
    v_add_u32 v19, 0x4000, v18
    v_mfma_f32_16x16x32_bf16 a[28:31], a[236:239], v[188:191], a[28:31]
    s_waitcnt lgkmcnt(8)
    v_exp_f32 v129, v129
    v_mfma_f32_16x16x32_bf16 a[44:47], a[244:247], v[188:191], a[44:47]
    s_add_u32 s46, s46, 16384
    ds_read_b64_tr_b16 a[236:237], v29 offset:40960
    ds_read_b64_tr_b16 a[238:239], v29 offset:45056
    v_mfma_f32_16x16x32_bf16 a[44:47], a[240:243], v[184:187], a[44:47]
    s_mul_i32 s3, s37, 196608
    v_exp_f32 v130, v130
    v_mfma_f32_16x16x32_bf16 a[40:43], a[240:243], v[176:179], a[40:43]
    s_add_u32 s3, s3, 0
    v_lshrrev_b32 v21, 3, v0
    v_min_u32 v21, 5, v21
    v_mfma_f32_16x16x32_bf16 a[40:43], a[244:247], v[180:183], a[40:43]
    v_exp_f32 v131, v131
    v_mfma_f32_16x16x32_bf16 a[36:39], a[244:247], v[172:175], a[36:39]
    ds_read_b64_tr_b16 a[232:233], v29 offset:32768
    ds_read_b64_tr_b16 a[234:235], v29 offset:36864
    v_mfma_f32_16x16x32_bf16 a[36:39], a[240:243], v[168:171], a[36:39]
    v_exp_f32 v136, v136
    v_mfma_f32_16x16x32_bf16 a[32:35], a[240:243], v[160:163], a[32:35]
    buffer_store_dwordx4 v[216:219], v9, s[28:31], s3 offen offset:0 sc1
    v_and_b32 v22, 7, v0
    v_mfma_f32_16x16x32_bf16 a[32:35], a[244:247], v[164:167], a[32:35]
    s_waitcnt lgkmcnt(8)
    v_exp_f32 v137, v137
    v_mfma_f32_16x16x32_bf16 a[48:51], a[252:255], v[164:167], a[48:51]
    ds_read_b64_tr_b16 a[244:245], v30 offset:40960
    ds_read_b64_tr_b16 a[246:247], v30 offset:45056
    v_mfma_f32_16x16x32_bf16 a[48:51], a[248:251], v[160:163], a[48:51]
    v_exp_f32 v138, v138
    v_mfma_f32_16x16x32_bf16 a[52:55], a[248:251], v[168:171], a[52:55]
    v_lshlrev_b32 v22, 7, v22
    v_lshl_add_u32 v21, v21, 16, v22
    v_mfma_f32_16x16x32_bf16 a[52:55], a[252:255], v[172:175], a[52:55]
    v_exp_f32 v139, v139
    v_mfma_f32_16x16x32_bf16 a[56:59], a[252:255], v[180:183], a[56:59]
    ds_read_b64_tr_b16 a[240:241], v30 offset:32768
    ds_read_b64_tr_b16 a[242:243], v30 offset:36864
    v_mfma_f32_16x16x32_bf16 a[56:59], a[248:251], v[176:179], a[56:59]
    v_exp_f32 v144, v144
    v_mfma_f32_16x16x32_bf16 a[60:63], a[248:251], v[184:187], a[60:63]
    buffer_store_dwordx4 v[220:223], v9, s[28:31], s3 offen offset:1024 sc1
    v_bfe_i32 v22, v0, 0, 1
    v_mfma_f32_16x16x32_bf16 a[60:63], a[252:255], v[188:191], a[60:63]
    s_waitcnt lgkmcnt(8)
    v_exp_f32 v145, v145
    v_mfma_f32_16x16x32_bf16 a[76:79], a[228:231], v[188:191], a[76:79]
    ds_read_b64_tr_b16 a[252:253], v31 offset:40960
    ds_read_b64_tr_b16 a[254:255], v31 offset:45056
    v_mfma_f32_16x16x32_bf16 a[76:79], a[224:227], v[184:187], a[76:79]
    v_exp_f32 v146, v146
    v_mfma_f32_16x16x32_bf16 a[72:75], a[224:227], v[176:179], a[72:75]
    v_and_b32 v22, s87, v22
    v_xor_b32 v22, s86, v22
    v_mfma_f32_16x16x32_bf16 a[72:75], a[228:231], v[180:183], a[72:75]
    v_exp_f32 v147, v147
    v_mfma_f32_16x16x32_bf16 a[68:71], a[228:231], v[172:175], a[68:71]
    ds_read_b64_tr_b16 a[248:249], v31 offset:32768
    ds_read_b64_tr_b16 a[250:251], v31 offset:36864
    v_mfma_f32_16x16x32_bf16 a[68:71], a[224:227], v[168:171], a[68:71]
    v_exp_f32 v152, v152
    v_mfma_f32_16x16x32_bf16 a[64:67], a[224:227], v[160:163], a[64:67]
    v_mfma_f32_16x16x32_bf16 a[64:67], a[228:231], v[164:167], a[64:67]
    s_waitcnt lgkmcnt(8)
    v_exp_f32 v153, v153
    v_mfma_f32_16x16x32_bf16 a[80:83], a[236:239], v[164:167], a[80:83]
    v_mfma_f32_16x16x32_bf16 a[80:83], a[232:235], v[160:163], a[80:83]
    v_exp_f32 v154, v154
    v_mfma_f32_16x16x32_bf16 a[84:87], a[232:235], v[168:171], a[84:87]
    v_mfma_f32_16x16x32_bf16 a[84:87], a[236:239], v[172:175], a[84:87]
    v_exp_f32 v155, v155
    v_mfma_f32_16x16x32_bf16 a[88:91], a[236:239], v[180:183], a[88:91]
    v_mfma_f32_16x16x32_bf16 a[88:91], a[232:235], v[176:179], a[88:91]
    s_waitcnt vmcnt(20) lgkmcnt(0)
    v_exp_f32 v156, v156
    v_mfma_f32_16x16x32_bf16 a[92:95], a[232:235], v[184:187], a[92:95]
    s_barrier
    v_mfma_f32_16x16x32_bf16 a[92:95], a[236:239], v[188:191], a[92:95]
    s_mul_i32 s3, s37, 196608
    v_exp_f32 v157, v157
    v_mfma_f32_16x16x32_bf16 a[108:111], a[244:247], v[188:191], a[108:111]
    s_add_u32 s3, s3, 131072
    ds_read_b128 a[192:195], v10 offset:49152
    buffer_store_dwordx4 v[224:227], v9, s[28:31], s3 offen offset:0 sc1
    v_mfma_f32_16x16x32_bf16 a[108:111], a[240:243], v[184:187], a[108:111]
    v_exp_f32 v158, v158
    v_mfma_f32_16x16x32_bf16 a[104:107], a[240:243], v[176:179], a[104:107]
    ds_read_b128 a[196:199], v11 offset:49152
    v_mfma_f32_16x16x32_bf16 a[104:107], a[244:247], v[180:183], a[104:107]
    v_exp_f32 v159, v159
    v_mfma_f32_16x16x32_bf16 a[100:103], a[244:247], v[172:175], a[100:103]
    ds_read_b128 a[200:203], v12 offset:49152
    v_mfma_f32_16x16x32_bf16 a[100:103], a[240:243], v[168:171], a[100:103]
    v_exp_f32 v148, v148
    v_mfma_f32_16x16x32_bf16 a[96:99], a[240:243], v[160:163], a[96:99]
    ds_read_b128 a[204:207], v13 offset:49152
    buffer_store_dwordx4 v[232:235], v9, s[28:31], s3 offen offset:1024 sc1
    v_mfma_f32_16x16x32_bf16 a[96:99], a[244:247], v[164:167], a[96:99]
    s_add_u32 s28, s4, 25165824
    s_addc_u32 s29, s5, 0
    v_exp_f32 v149, v149
    v_mfma_f32_16x16x32_bf16 a[112:115], a[252:255], v[164:167], a[112:115]
    s_mov_b32 s30, 327680
    v_mfma_f32_16x16x32_bf16 a[112:115], a[248:251], v[160:163], a[112:115]
    v_exp_f32 v150, v150
    v_mfma_f32_16x16x32_bf16 a[116:119], a[248:251], v[168:171], a[116:119]
    v_cvt_pk_bf16_f32 v160, v96, v97
    v_cvt_pk_bf16_f32 v161, v98, v99
    v_mfma_f32_16x16x32_bf16 a[116:119], a[252:255], v[172:175], a[116:119]
    v_exp_f32 v151, v151
    v_mfma_f32_16x16x32_bf16 a[120:123], a[252:255], v[180:183], a[120:123]
    v_cvt_pk_bf16_f32 v168, v104, v105
    v_cvt_pk_bf16_f32 v169, v106, v107
    v_mfma_f32_16x16x32_bf16 a[120:123], a[248:251], v[176:179], a[120:123]
    v_exp_f32 v140, v140
    v_mfma_f32_16x16x32_bf16 a[124:127], a[248:251], v[184:187], a[124:127]
    v_cvt_pk_bf16_f32 v176, v112, v113
    v_cvt_pk_bf16_f32 v177, v114, v115
    v_mfma_f32_16x16x32_bf16 a[124:127], a[252:255], v[188:191], a[124:127]
    s_waitcnt lgkmcnt(0)
    v_exp_f32 v141, v141
    s_branch L_e2
    .p2align 6
L_loop:
    v_mfma_f32_16x16x32_bf16 v[96:99], a[192:195], v[32:35], v[192:195]
    v_exp_f32 v142, v142
    v_mfma_f32_16x16x32_bf16 v[96:99], a[196:199], v[36:39], v[96:99]
    ds_read_b128 a[208:211], v10 offset:20480
    v_cvt_pk_bf16_f32 v184, v120, v121
    v_mfma_f32_16x16x32_bf16 v[96:99], a[200:203], v[40:43], v[96:99]
    v_exp_f32 v143, v143
    v_mfma_f32_16x16x32_bf16 v[96:99], a[204:207], v[44:47], v[96:99]
    ds_read_b128 a[212:215], v11 offset:20480
    v_cvt_pk_bf16_f32 v185, v122, v123
    v_mfma_f32_16x16x32_bf16 v[104:107], a[204:207], v[60:63], v[196:199]
    v_exp_f32 v132, v132
    v_mfma_f32_16x16x32_bf16 v[104:107], a[200:203], v[56:59], v[104:107]
    ds_read_b128 a[216:219], v12 offset:20480
    v_cvt_pk_bf16_f32 v186, v124, v125
    v_mfma_f32_16x16x32_bf16 v[104:107], a[196:199], v[52:55], v[104:107]
    v_exp_f32 v133, v133
    v_mfma_f32_16x16x32_bf16 v[104:107], a[192:195], v[48:51], v[104:107]
    ds_read_b128 a[220:223], v13 offset:20480
    v_cvt_pk_bf16_f32 v187, v126, v127
    v_mfma_f32_16x16x32_bf16 v[112:115], a[192:195], v[64:67], v[200:203]
    v_exp_f32 v134, v134
    v_mfma_f32_16x16x32_bf16 v[112:115], a[196:199], v[68:71], v[112:115]
    v_cvt_pk_bf16_f32 v178, v116, v117
    v_cvt_pk_bf16_f32 v179, v118, v119
    v_mfma_f32_16x16x32_bf16 v[112:115], a[200:203], v[72:75], v[112:115]
    v_exp_f32 v135, v135
    v_mfma_f32_16x16x32_bf16 v[112:115], a[204:207], v[76:79], v[112:115]
    s_add_u32 m0, s39, 0
    v_cvt_pk_bf16_f32 v170, v108, v109
    v_cvt_pk_bf16_f32 v171, v110, v111
    v_mfma_f32_16x16x32_bf16 v[120:123], a[204:207], v[92:95], v[204:207]
    v_exp_f32 v96, v96
    v_mfma_f32_16x16x32_bf16 v[120:123], a[200:203], v[88:91], v[120:123]
    buffer_load_dwordx4 v1, s[8:11], s45 offen offset:0 lds
    v_mfma_f32_16x16x32_bf16 v[120:123], a[196:199], v[84:87], v[120:123]
    v_exp_f32 v97, v97
    v_mfma_f32_16x16x32_bf16 v[120:123], a[192:195], v[80:83], v[120:123]
    s_waitcnt lgkmcnt(0)
    v_cvt_pk_bf16_f32 v162, v100, v101
    v_cvt_pk_bf16_f32 v163, v102, v103
    v_mfma_f32_16x16x32_bf16 v[124:127], a[208:211], v[80:83], v[204:207]
    v_exp_f32 v98, v98
    v_mfma_f32_16x16x32_bf16 v[124:127], a[212:215], v[84:87], v[124:127]
    ds_read_b128 a[192:195], v10 offset:24576
    v_mfma_f32_16x16x32_bf16 v[124:127], a[216:219], v[88:91], v[124:127]
    v_exp_f32 v99, v99
    v_mfma_f32_16x16x32_bf16 v[124:127], a[220:223], v[92:95], v[124:127]
    ds_read_b128 a[196:199], v11 offset:24576
    v_cvt_pk_bf16_f32 v164, v128, v129
    v_mfma_f32_16x16x32_bf16 v[116:119], a[220:223], v[76:79], v[200:203]
    v_exp_f32 v104, v104
    v_mfma_f32_16x16x32_bf16 v[116:119], a[216:219], v[72:75], v[116:119]
    ds_read_b128 a[200:203], v12 offset:24576
    v_cvt_pk_bf16_f32 v165, v130, v131
    v_mfma_f32_16x16x32_bf16 v[116:119], a[212:215], v[68:71], v[116:119]
    v_exp_f32 v105, v105
    v_mfma_f32_16x16x32_bf16 v[116:119], a[208:211], v[64:67], v[116:119]
    ds_read_b128 a[204:207], v13 offset:24576
    v_cvt_pk_bf16_f32 v172, v136, v137
    v_mfma_f32_16x16x32_bf16 v[108:111], a[208:211], v[48:51], v[196:199]
    v_exp_f32 v106, v106
    v_mfma_f32_16x16x32_bf16 v[108:111], a[212:215], v[52:55], v[108:111]
    v_cvt_pk_bf16_f32 v173, v138, v139
    v_mfma_f32_16x16x32_bf16 v[108:111], a[216:219], v[56:59], v[108:111]
    v_exp_f32 v107, v107
    v_mfma_f32_16x16x32_bf16 v[108:111], a[220:223], v[60:63], v[108:111]
    v_cvt_pk_bf16_f32 v180, v144, v145
    v_cvt_pk_bf16_f32 v181, v146, v147
    v_mfma_f32_16x16x32_bf16 v[100:103], a[220:223], v[44:47], v[192:195]
    v_exp_f32 v112, v112
    v_mfma_f32_16x16x32_bf16 v[100:103], a[216:219], v[40:43], v[100:103]
    buffer_load_dwordx4 v2, s[8:11], s45 offen offset:1024 lds
    v_mfma_f32_16x16x32_bf16 v[100:103], a[212:215], v[36:39], v[100:103]
    v_exp_f32 v113, v113
    v_mfma_f32_16x16x32_bf16 v[100:103], a[208:211], v[32:35], v[100:103]
    s_waitcnt lgkmcnt(0)
    v_cvt_pk_bf16_f32 v188, v152, v153
    v_cvt_pk_bf16_f32 v189, v154, v155
    v_mfma_f32_16x16x32_bf16 v[128:131], a[192:195], v[32:35], v[192:195]
    v_exp_f32 v114, v114
    v_mfma_f32_16x16x32_bf16 v[128:131], a[196:199], v[36:39], v[128:131]
    ds_read_b128 a[208:211], v10 offset:28672
    v_mfma_f32_16x16x32_bf16 v[128:131], a[200:203], v[40:43], v[128:131]
    v_exp_f32 v115, v115
    v_mfma_f32_16x16x32_bf16 v[128:131], a[204:207], v[44:47], v[128:131]
    ds_read_b128 a[212:215], v11 offset:28672
    v_cvt_pk_bf16_f32 v190, v156, v157
    v_mfma_f32_16x16x32_bf16 v[136:139], a[204:207], v[60:63], v[196:199]
    v_exp_f32 v120, v120
    v_mfma_f32_16x16x32_bf16 v[136:139], a[200:203], v[56:59], v[136:139]
    ds_read_b128 a[216:219], v12 offset:28672
    v_cvt_pk_bf16_f32 v191, v158, v159
    v_mfma_f32_16x16x32_bf16 v[136:139], a[196:199], v[52:55], v[136:139]
    v_exp_f32 v121, v121
    v_mfma_f32_16x16x32_bf16 v[136:139], a[192:195], v[48:51], v[136:139]
    ds_read_b128 a[220:223], v13 offset:28672
    v_cvt_pk_bf16_f32 v182, v148, v149
    v_mfma_f32_16x16x32_bf16 v[144:147], a[192:195], v[64:67], v[200:203]
    v_exp_f32 v122, v122
    v_mfma_f32_16x16x32_bf16 v[144:147], a[196:199], v[68:71], v[144:147]
    v_cvt_pk_bf16_f32 v183, v150, v151
    v_mfma_f32_16x16x32_bf16 v[144:147], a[200:203], v[72:75], v[144:147]
    v_exp_f32 v123, v123
    v_mfma_f32_16x16x32_bf16 v[144:147], a[204:207], v[76:79], v[144:147]
    v_cvt_pk_bf16_f32 v174, v140, v141
    v_cvt_pk_bf16_f32 v175, v142, v143
    v_mfma_f32_16x16x32_bf16 v[152:155], a[204:207], v[92:95], v[204:207]
    v_exp_f32 v124, v124
    v_mfma_f32_16x16x32_bf16 v[152:155], a[200:203], v[88:91], v[152:155]
    ds_read_b64_tr_b16 a[228:229], v24 offset:24576
    v_mfma_f32_16x16x32_bf16 v[152:155], a[196:199], v[84:87], v[152:155]
    v_exp_f32 v125, v125
    v_mfma_f32_16x16x32_bf16 v[152:155], a[192:195], v[80:83], v[152:155]
    s_waitcnt lgkmcnt(1)
    ds_read_b64_tr_b16 a[230:231], v24 offset:28672
    v_cvt_pk_bf16_f32 v166, v132, v133
    v_mfma_f32_16x16x32_bf16 v[156:159], a[208:211], v[80:83], v[204:207]
    v_exp_f32 v126, v126
    v_mfma_f32_16x16x32_bf16 v[156:159], a[212:215], v[84:87], v[156:159]
    ds_read_b64_tr_b16 a[224:225], v24 offset:16384
    v_cvt_pk_bf16_f32 v167, v134, v135
    v_mfma_f32_16x16x32_bf16 v[156:159], a[216:219], v[88:91], v[156:159]
    v_exp_f32 v127, v127
    v_mfma_f32_16x16x32_bf16 v[156:159], a[220:223], v[92:95], v[156:159]
    ds_read_b64_tr_b16 a[226:227], v24 offset:20480
    v_mfma_f32_16x16x32_bf16 v[148:151], a[220:223], v[76:79], v[200:203]
    v_exp_f32 v116, v116
    v_mfma_f32_16x16x32_bf16 v[148:151], a[216:219], v[72:75], v[148:151]
    ds_read_b64_tr_b16 a[236:237], v25 offset:24576
    v_mfma_f32_16x16x32_bf16 v[148:151], a[212:215], v[68:71], v[148:151]
    v_exp_f32 v117, v117
    v_mfma_f32_16x16x32_bf16 v[148:151], a[208:211], v[64:67], v[148:151]
    ds_read_b64_tr_b16 a[238:239], v25 offset:28672
    v_mfma_f32_16x16x32_bf16 v[140:143], a[208:211], v[48:51], v[196:199]
    v_exp_f32 v118, v118
    v_mfma_f32_16x16x32_bf16 v[140:143], a[212:215], v[52:55], v[140:143]
    ds_read_b64_tr_b16 a[232:233], v25 offset:16384
    v_mfma_f32_16x16x32_bf16 v[140:143], a[216:219], v[56:59], v[140:143]
    v_exp_f32 v119, v119
    v_mfma_f32_16x16x32_bf16 v[140:143], a[220:223], v[60:63], v[140:143]
    ds_read_b64_tr_b16 a[234:235], v25 offset:20480
    v_mfma_f32_16x16x32_bf16 v[132:135], a[220:223], v[44:47], v[192:195]
    v_exp_f32 v108, v108
    v_mfma_f32_16x16x32_bf16 v[132:135], a[216:219], v[40:43], v[132:135]
    ds_read_b64_tr_b16 a[244:245], v26 offset:24576
    v_mfma_f32_16x16x32_bf16 v[132:135], a[212:215], v[36:39], v[132:135]
    v_exp_f32 v109, v109
    v_mfma_f32_16x16x32_bf16 v[132:135], a[208:211], v[32:35], v[132:135]
    ds_read_b64_tr_b16 a[246:247], v26 offset:28672
    v_smfmac_f32_16x16x64_bf16 a[128:131], a[144:147], v[160:167], v23
    ds_read_b64_tr_b16 a[240:241], v26 offset:16384
    v_smfmac_f32_16x16x64_bf16 a[132:135], a[144:147], v[168:175], v23
    buffer_load_dwordx4 v3, s[8:11], s45 offen offset:2048 lds
    v_smfmac_f32_16x16x64_bf16 a[136:139], a[144:147], v[176:183], v23
    ds_read_b64_tr_b16 a[242:243], v26 offset:20480
    v_smfmac_f32_16x16x64_bf16 a[140:143], a[144:147], v[184:191], v23
    s_waitcnt lgkmcnt(8)
    v_mfma_f32_16x16x32_bf16 a[12:15], a[228:231], v[188:191], a[12:15]
    ds_read_b64_tr_b16 a[252:253], v27 offset:24576
    ds_read_b64_tr_b16 a[254:255], v27 offset:28672
    v_mfma_f32_16x16x32_bf16 a[12:15], a[224:227], v[184:187], a[12:15]
    v_exp_f32 v110, v110
    v_mfma_f32_16x16x32_bf16 a[8:11], a[224:227], v[176:179], a[8:11]
    buffer_load_dwordx4 v4, s[8:11], s45 offen offset:3072 lds
    v_mfma_f32_16x16x32_bf16 a[8:11], a[228:231], v[180:183], a[8:11]
    s_add_u32 s45, s45, 16384
    v_exp_f32 v111, v111
    v_mfma_f32_16x16x32_bf16 a[4:7], a[228:231], v[172:175], a[4:7]
    ds_read_b64_tr_b16 a[248:249], v27 offset:16384
    ds_read_b64_tr_b16 a[250:251], v27 offset:20480
    v_mfma_f32_16x16x32_bf16 a[4:7], a[224:227], v[168:171], a[4:7]
    v_exp_f32 v100, v100
    v_mfma_f32_16x16x32_bf16 a[0:3], a[224:227], v[160:163], a[0:3]
    v_mfma_f32_16x16x32_bf16 a[0:3], a[228:231], v[164:167], a[0:3]
    s_waitcnt lgkmcnt(8)
    v_exp_f32 v101, v101
    v_mfma_f32_16x16x32_bf16 a[16:19], a[236:239], v[164:167], a[16:19]
    ds_read_b64_tr_b16 a[228:229], v28 offset:24576
    ds_read_b64_tr_b16 a[230:231], v28 offset:28672
    v_mfma_f32_16x16x32_bf16 a[16:19], a[232:235], v[160:163], a[16:19]
    s_add_u32 m0, s39, 65536
    v_exp_f32 v102, v102
    v_mfma_f32_16x16x32_bf16 a[20:23], a[232:235], v[168:171], a[20:23]
    buffer_load_dwordx4 v5, s[12:15], s46 offen offset:0 lds
    v_mfma_f32_16x16x32_bf16 a[20:23], a[236:239], v[172:175], a[20:23]
    v_exp_f32 v103, v103
    v_mfma_f32_16x16x32_bf16 a[24:27], a[236:239], v[180:183], a[24:27]
    ds_read_b64_tr_b16 a[224:225], v28 offset:16384
    ds_read_b64_tr_b16 a[226:227], v28 offset:20480
    v_mfma_f32_16x16x32_bf16 a[24:27], a[232:235], v[176:179], a[24:27]
    v_exp_f32 v128, v128
    v_mfma_f32_16x16x32_bf16 a[28:31], a[232:235], v[184:187], a[28:31]
    v_mfma_f32_16x16x32_bf16 a[28:31], a[236:239], v[188:191], a[28:31]
    s_waitcnt lgkmcnt(8)
    v_exp_f32 v129, v129
    v_mfma_f32_16x16x32_bf16 a[44:47], a[244:247], v[188:191], a[44:47]
    ds_read_b64_tr_b16 a[236:237], v29 offset:24576
    ds_read_b64_tr_b16 a[238:239], v29 offset:28672
    v_mfma_f32_16x16x32_bf16 a[44:47], a[240:243], v[184:187], a[44:47]
    v_exp_f32 v130, v130
    v_mfma_f32_16x16x32_bf16 a[40:43], a[240:243], v[176:179], a[40:43]
    v_mfma_f32_16x16x32_bf16 a[40:43], a[244:247], v[180:183], a[40:43]
    v_exp_f32 v131, v131
    v_mfma_f32_16x16x32_bf16 a[36:39], a[244:247], v[172:175], a[36:39]
    ds_read_b64_tr_b16 a[232:233], v29 offset:16384
    ds_read_b64_tr_b16 a[234:235], v29 offset:20480
    v_mfma_f32_16x16x32_bf16 a[36:39], a[240:243], v[168:171], a[36:39]
    v_exp_f32 v136, v136
    v_mfma_f32_16x16x32_bf16 a[32:35], a[240:243], v[160:163], a[32:35]
    buffer_load_dwordx4 v6, s[12:15], s46 offen offset:1024 lds
    v_mfma_f32_16x16x32_bf16 a[32:35], a[244:247], v[164:167], a[32:35]
    s_waitcnt lgkmcnt(8)
    v_exp_f32 v137, v137
    v_mfma_f32_16x16x32_bf16 a[48:51], a[252:255], v[164:167], a[48:51]
    ds_read_b64_tr_b16 a[244:245], v30 offset:24576
    ds_read_b64_tr_b16 a[246:247], v30 offset:28672
    v_mfma_f32_16x16x32_bf16 a[48:51], a[248:251], v[160:163], a[48:51]
    v_exp_f32 v138, v138
    v_mfma_f32_16x16x32_bf16 a[52:55], a[248:251], v[168:171], a[52:55]
    v_mfma_f32_16x16x32_bf16 a[52:55], a[252:255], v[172:175], a[52:55]
    v_exp_f32 v139, v139
    v_mfma_f32_16x16x32_bf16 a[56:59], a[252:255], v[180:183], a[56:59]
    ds_read_b64_tr_b16 a[240:241], v30 offset:16384
    ds_read_b64_tr_b16 a[242:243], v30 offset:20480
    v_mfma_f32_16x16x32_bf16 a[56:59], a[248:251], v[176:179], a[56:59]
    v_exp_f32 v144, v144
    v_mfma_f32_16x16x32_bf16 a[60:63], a[248:251], v[184:187], a[60:63]
    v_mfma_f32_16x16x32_bf16 a[60:63], a[252:255], v[188:191], a[60:63]
    s_waitcnt lgkmcnt(8)
    v_exp_f32 v145, v145
    v_mfma_f32_16x16x32_bf16 a[76:79], a[228:231], v[188:191], a[76:79]
    ds_read_b64_tr_b16 a[252:253], v31 offset:24576
    ds_read_b64_tr_b16 a[254:255], v31 offset:28672
    v_mfma_f32_16x16x32_bf16 a[76:79], a[224:227], v[184:187], a[76:79]
    v_exp_f32 v146, v146
    v_mfma_f32_16x16x32_bf16 a[72:75], a[224:227], v[176:179], a[72:75]
    buffer_load_dwordx4 v5, s[12:15], s46 offen offset:2048 lds
    v_mfma_f32_16x16x32_bf16 a[72:75], a[228:231], v[180:183], a[72:75]
    v_exp_f32 v147, v147
    v_mfma_f32_16x16x32_bf16 a[68:71], a[228:231], v[172:175], a[68:71]
    ds_read_b64_tr_b16 a[248:249], v31 offset:16384
    ds_read_b64_tr_b16 a[250:251], v31 offset:20480
    v_mfma_f32_16x16x32_bf16 a[68:71], a[224:227], v[168:171], a[68:71]
    v_exp_f32 v152, v152
    v_mfma_f32_16x16x32_bf16 a[64:67], a[224:227], v[160:163], a[64:67]
    v_mfma_f32_16x16x32_bf16 a[64:67], a[228:231], v[164:167], a[64:67]
    s_waitcnt lgkmcnt(8)
    v_exp_f32 v153, v153
    v_mfma_f32_16x16x32_bf16 a[80:83], a[236:239], v[164:167], a[80:83]
    v_mfma_f32_16x16x32_bf16 a[80:83], a[232:235], v[160:163], a[80:83]
    v_exp_f32 v154, v154
    v_mfma_f32_16x16x32_bf16 a[84:87], a[232:235], v[168:171], a[84:87]
    buffer_load_dwordx4 v6, s[12:15], s46 offen offset:3072 lds
    v_mfma_f32_16x16x32_bf16 a[84:87], a[236:239], v[172:175], a[84:87]
    s_add_u32 s46, s46, 16384
    v_exp_f32 v155, v155
    v_mfma_f32_16x16x32_bf16 a[88:91], a[236:239], v[180:183], a[88:91]
    v_mfma_f32_16x16x32_bf16 a[88:91], a[232:235], v[176:179], a[88:91]
    s_waitcnt vmcnt(16) lgkmcnt(0)
    v_exp_f32 v156, v156
    v_mfma_f32_16x16x32_bf16 a[92:95], a[232:235], v[184:187], a[92:95]
    s_barrier
    v_mfma_f32_16x16x32_bf16 a[92:95], a[236:239], v[188:191], a[92:95]
    v_exp_f32 v157, v157
    v_mfma_f32_16x16x32_bf16 a[108:111], a[244:247], v[188:191], a[108:111]
    ds_read_b128 a[192:195], v10 offset:32768
    v_mfma_f32_16x16x32_bf16 a[108:111], a[240:243], v[184:187], a[108:111]
    v_exp_f32 v158, v158
    v_mfma_f32_16x16x32_bf16 a[104:107], a[240:243], v[176:179], a[104:107]
    ds_read_b128 a[196:199], v11 offset:32768
    v_mfma_f32_16x16x32_bf16 a[104:107], a[244:247], v[180:183], a[104:107]
    v_exp_f32 v159, v159
    v_mfma_f32_16x16x32_bf16 a[100:103], a[244:247], v[172:175], a[100:103]
    ds_read_b128 a[200:203], v12 offset:32768
    v_mfma_f32_16x16x32_bf16 a[100:103], a[240:243], v[168:171], a[100:103]
    v_exp_f32 v148, v148
    v_mfma_f32_16x16x32_bf16 a[96:99], a[240:243], v[160:163], a[96:99]
    ds_read_b128 a[204:207], v13 offset:32768
    v_mfma_f32_16x16x32_bf16 a[96:99], a[244:247], v[164:167], a[96:99]
    v_exp_f32 v149, v149
    v_mfma_f32_16x16x32_bf16 a[112:115], a[252:255], v[164:167], a[112:115]
    v_mfma_f32_16x16x32_bf16 a[112:115], a[248:251], v[160:163], a[112:115]
    v_exp_f32 v150, v150
    v_mfma_f32_16x16x32_bf16 a[116:119], a[248:251], v[168:171], a[116:119]
    s_add_u32 s47, s47, 1
    v_cvt_pk_bf16_f32 v160, v96, v97
    v_cvt_pk_bf16_f32 v161, v98, v99
    v_mfma_f32_16x16x32_bf16 a[116:119], a[252:255], v[172:175], a[116:119]
    v_exp_f32 v151, v151
    v_mfma_f32_16x16x32_bf16 a[120:123], a[252:255], v[180:183], a[120:123]
    s_cmp_eq_u32 s47, 8
    v_cvt_pk_bf16_f32 v168, v104, v105
    v_cvt_pk_bf16_f32 v169, v106, v107
    v_mfma_f32_16x16x32_bf16 a[120:123], a[248:251], v[176:179], a[120:123]
    v_exp_f32 v140, v140
    v_mfma_f32_16x16x32_bf16 a[124:127], a[248:251], v[184:187], a[124:127]
    v_cvt_pk_bf16_f32 v176, v112, v113
    v_cvt_pk_bf16_f32 v177, v114, v115
    v_mfma_f32_16x16x32_bf16 a[124:127], a[252:255], v[188:191], a[124:127]
    s_waitcnt lgkmcnt(0)
    v_exp_f32 v141, v141
    s_cbranch_scc1 L_last
    v_mfma_f32_16x16x32_bf16 v[96:99], a[192:195], v[32:35], v[192:195]
    v_exp_f32 v142, v142
    v_mfma_f32_16x16x32_bf16 v[96:99], a[196:199], v[36:39], v[96:99]
    ds_read_b128 a[208:211], v10 offset:36864
    v_cvt_pk_bf16_f32 v184, v120, v121
    v_mfma_f32_16x16x32_bf16 v[96:99], a[200:203], v[40:43], v[96:99]
    v_exp_f32 v143, v143
    v_mfma_f32_16x16x32_bf16 v[96:99], a[204:207], v[44:47], v[96:99]
    ds_read_b128 a[212:215], v11 offset:36864
    v_cvt_pk_bf16_f32 v185, v122, v123
    v_mfma_f32_16x16x32_bf16 v[104:107], a[204:207], v[60:63], v[196:199]
    v_exp_f32 v132, v132
    v_mfma_f32_16x16x32_bf16 v[104:107], a[200:203], v[56:59], v[104:107]
    ds_read_b128 a[216:219], v12 offset:36864
    v_cvt_pk_bf16_f32 v186, v124, v125
    v_mfma_f32_16x16x32_bf16 v[104:107], a[196:199], v[52:55], v[104:107]
    v_exp_f32 v133, v133
    v_mfma_f32_16x16x32_bf16 v[104:107], a[192:195], v[48:51], v[104:107]
    ds_read_b128 a[220:223], v13 offset:36864
    v_cvt_pk_bf16_f32 v187, v126, v127
    v_mfma_f32_16x16x32_bf16 v[112:115], a[192:195], v[64:67], v[200:203]
    v_exp_f32 v134, v134
    v_mfma_f32_16x16x32_bf16 v[112:115], a[196:199], v[68:71], v[112:115]
    v_cvt_pk_bf16_f32 v178, v116, v117
    v_cvt_pk_bf16_f32 v179, v118, v119
    v_mfma_f32_16x16x32_bf16 v[112:115], a[200:203], v[72:75], v[112:115]
    v_exp_f32 v135, v135
    v_mfma_f32_16x16x32_bf16 v[112:115], a[204:207], v[76:79], v[112:115]
    s_add_u32 m0, s39, 16384
    v_cvt_pk_bf16_f32 v170, v108, v109
    v_cvt_pk_bf16_f32 v171, v110, v111
    v_mfma_f32_16x16x32_bf16 v[120:123], a[204:207], v[92:95], v[204:207]
    v_exp_f32 v96, v96
    v_mfma_f32_16x16x32_bf16 v[120:123], a[200:203], v[88:91], v[120:123]
    buffer_load_dwordx4 v1, s[8:11], s45 offen offset:0 lds
    v_mfma_f32_16x16x32_bf16 v[120:123], a[196:199], v[84:87], v[120:123]
    v_exp_f32 v97, v97
    v_mfma_f32_16x16x32_bf16 v[120:123], a[192:195], v[80:83], v[120:123]
    s_waitcnt lgkmcnt(0)
    v_cvt_pk_bf16_f32 v162, v100, v101
    v_cvt_pk_bf16_f32 v163, v102, v103
    v_mfma_f32_16x16x32_bf16 v[124:127], a[208:211], v[80:83], v[204:207]
    v_exp_f32 v98, v98
    v_mfma_f32_16x16x32_bf16 v[124:127], a[212:215], v[84:87], v[124:127]
    ds_read_b128 a[192:195], v10 offset:40960
    v_mfma_f32_16x16x32_bf16 v[124:127], a[216:219], v[88:91], v[124:127]
    v_exp_f32 v99, v99
    v_mfma_f32_16x16x32_bf16 v[124:127], a[220:223], v[92:95], v[124:127]
    ds_read_b128 a[196:199], v11 offset:40960
    v_cvt_pk_bf16_f32 v164, v128, v129
    v_mfma_f32_16x16x32_bf16 v[116:119], a[220:223], v[76:79], v[200:203]
    v_exp_f32 v104, v104
    v_mfma_f32_16x16x32_bf16 v[116:119], a[216:219], v[72:75], v[116:119]
    ds_read_b128 a[200:203], v12 offset:40960
    v_cvt_pk_bf16_f32 v165, v130, v131
    v_mfma_f32_16x16x32_bf16 v[116:119], a[212:215], v[68:71], v[116:119]
    v_exp_f32 v105, v105
    v_mfma_f32_16x16x32_bf16 v[116:119], a[208:211], v[64:67], v[116:119]
    ds_read_b128 a[204:207], v13 offset:40960
    v_cvt_pk_bf16_f32 v172, v136, v137
    v_mfma_f32_16x16x32_bf16 v[108:111], a[208:211], v[48:51], v[196:199]
    v_exp_f32 v106, v106
    v_mfma_f32_16x16x32_bf16 v[108:111], a[212:215], v[52:55], v[108:111]
    v_cvt_pk_bf16_f32 v173, v138, v139
    v_mfma_f32_16x16x32_bf16 v[108:111], a[216:219], v[56:59], v[108:111]
    v_exp_f32 v107, v107
    v_mfma_f32_16x16x32_bf16 v[108:111], a[220:223], v[60:63], v[108:111]
    v_cvt_pk_bf16_f32 v180, v144, v145
    v_cvt_pk_bf16_f32 v181, v146, v147
    v_mfma_f32_16x16x32_bf16 v[100:103], a[220:223], v[44:47], v[192:195]
    v_exp_f32 v112, v112
    v_mfma_f32_16x16x32_bf16 v[100:103], a[216:219], v[40:43], v[100:103]
    buffer_load_dwordx4 v2, s[8:11], s45 offen offset:1024 lds
    v_mfma_f32_16x16x32_bf16 v[100:103], a[212:215], v[36:39], v[100:103]
    v_exp_f32 v113, v113
    v_mfma_f32_16x16x32_bf16 v[100:103], a[208:211], v[32:35], v[100:103]
    s_waitcnt lgkmcnt(0)
    v_cvt_pk_bf16_f32 v188, v152, v153
    v_cvt_pk_bf16_f32 v189, v154, v155
    v_mfma_f32_16x16x32_bf16 v[128:131], a[192:195], v[32:35], v[192:195]
    v_exp_f32 v114, v114
    v_mfma_f32_16x16x32_bf16 v[128:131], a[196:199], v[36:39], v[128:131]
    ds_read_b128 a[208:211], v10 offset:45056
    v_mfma_f32_16x16x32_bf16 v[128:131], a[200:203], v[40:43], v[128:131]
    v_exp_f32 v115, v115
    v_mfma_f32_16x16x32_bf16 v[128:131], a[204:207], v[44:47], v[128:131]
    ds_read_b128 a[212:215], v11 offset:45056
    v_cvt_pk_bf16_f32 v190, v156, v157
    v_mfma_f32_16x16x32_bf16 v[136:139], a[204:207], v[60:63], v[196:199]
    v_exp_f32 v120, v120
    v_mfma_f32_16x16x32_bf16 v[136:139], a[200:203], v[56:59], v[136:139]
    ds_read_b128 a[216:219], v12 offset:45056
    v_cvt_pk_bf16_f32 v191, v158, v159
    v_mfma_f32_16x16x32_bf16 v[136:139], a[196:199], v[52:55], v[136:139]
    v_exp_f32 v121, v121
    v_mfma_f32_16x16x32_bf16 v[136:139], a[192:195], v[48:51], v[136:139]
    ds_read_b128 a[220:223], v13 offset:45056
    v_cvt_pk_bf16_f32 v182, v148, v149
    v_mfma_f32_16x16x32_bf16 v[144:147], a[192:195], v[64:67], v[200:203]
    v_exp_f32 v122, v122
    v_mfma_f32_16x16x32_bf16 v[144:147], a[196:199], v[68:71], v[144:147]
    v_cvt_pk_bf16_f32 v183, v150, v151
    v_mfma_f32_16x16x32_bf16 v[144:147], a[200:203], v[72:75], v[144:147]
    v_exp_f32 v123, v123
    v_mfma_f32_16x16x32_bf16 v[144:147], a[204:207], v[76:79], v[144:147]
    v_cvt_pk_bf16_f32 v174, v140, v141
    v_cvt_pk_bf16_f32 v175, v142, v143
    v_mfma_f32_16x16x32_bf16 v[152:155], a[204:207], v[92:95], v[204:207]
    v_exp_f32 v124, v124
    v_mfma_f32_16x16x32_bf16 v[152:155], a[200:203], v[88:91], v[152:155]
    ds_read_b64_tr_b16 a[228:229], v24 offset:40960
    v_mfma_f32_16x16x32_bf16 v[152:155], a[196:199], v[84:87], v[152:155]
    v_exp_f32 v125, v125
    v_mfma_f32_16x16x32_bf16 v[152:155], a[192:195], v[80:83], v[152:155]
    s_waitcnt lgkmcnt(1)
    ds_read_b64_tr_b16 a[230:231], v24 offset:45056
    v_cvt_pk_bf16_f32 v166, v132, v133
    v_mfma_f32_16x16x32_bf16 v[156:159], a[208:211], v[80:83], v[204:207]
    v_exp_f32 v126, v126
    v_mfma_f32_16x16x32_bf16 v[156:159], a[212:215], v[84:87], v[156:159]
    ds_read_b64_tr_b16 a[224:225], v24 offset:32768
    v_cvt_pk_bf16_f32 v167, v134, v135
    v_mfma_f32_16x16x32_bf16 v[156:159], a[216:219], v[88:91], v[156:159]
    v_exp_f32 v127, v127
    v_mfma_f32_16x16x32_bf16 v[156:159], a[220:223], v[92:95], v[156:159]
    ds_read_b64_tr_b16 a[226:227], v24 offset:36864
    v_mfma_f32_16x16x32_bf16 v[148:151], a[220:223], v[76:79], v[200:203]
    v_exp_f32 v116, v116
    v_mfma_f32_16x16x32_bf16 v[148:151], a[216:219], v[72:75], v[148:151]
    ds_read_b64_tr_b16 a[236:237], v25 offset:40960
    v_mfma_f32_16x16x32_bf16 v[148:151], a[212:215], v[68:71], v[148:151]
    v_exp_f32 v117, v117
    v_mfma_f32_16x16x32_bf16 v[148:151], a[208:211], v[64:67], v[148:151]
    ds_read_b64_tr_b16 a[238:239], v25 offset:45056
    v_mfma_f32_16x16x32_bf16 v[140:143], a[208:211], v[48:51], v[196:199]
    v_exp_f32 v118, v118
    v_mfma_f32_16x16x32_bf16 v[140:143], a[212:215], v[52:55], v[140:143]
    ds_read_b64_tr_b16 a[232:233], v25 offset:32768
    v_mfma_f32_16x16x32_bf16 v[140:143], a[216:219], v[56:59], v[140:143]
    v_exp_f32 v119, v119
    v_mfma_f32_16x16x32_bf16 v[140:143], a[220:223], v[60:63], v[140:143]
    ds_read_b64_tr_b16 a[234:235], v25 offset:36864
    v_mfma_f32_16x16x32_bf16 v[132:135], a[220:223], v[44:47], v[192:195]
    v_exp_f32 v108, v108
    v_mfma_f32_16x16x32_bf16 v[132:135], a[216:219], v[40:43], v[132:135]
    ds_read_b64_tr_b16 a[244:245], v26 offset:40960
    v_mfma_f32_16x16x32_bf16 v[132:135], a[212:215], v[36:39], v[132:135]
    v_exp_f32 v109, v109
    v_mfma_f32_16x16x32_bf16 v[132:135], a[208:211], v[32:35], v[132:135]
    ds_read_b64_tr_b16 a[246:247], v26 offset:45056
    v_smfmac_f32_16x16x64_bf16 a[128:131], a[144:147], v[160:167], v23
    ds_read_b64_tr_b16 a[240:241], v26 offset:32768
    v_smfmac_f32_16x16x64_bf16 a[132:135], a[144:147], v[168:175], v23
    buffer_load_dwordx4 v3, s[8:11], s45 offen offset:2048 lds
    v_smfmac_f32_16x16x64_bf16 a[136:139], a[144:147], v[176:183], v23
    ds_read_b64_tr_b16 a[242:243], v26 offset:36864
    v_smfmac_f32_16x16x64_bf16 a[140:143], a[144:147], v[184:191], v23
    s_waitcnt lgkmcnt(8)
    v_mfma_f32_16x16x32_bf16 a[12:15], a[228:231], v[188:191], a[12:15]
    ds_read_b64_tr_b16 a[252:253], v27 offset:40960
    ds_read_b64_tr_b16 a[254:255], v27 offset:45056
    v_mfma_f32_16x16x32_bf16 a[12:15], a[224:227], v[184:187], a[12:15]
    v_exp_f32 v110, v110
    v_mfma_f32_16x16x32_bf16 a[8:11], a[224:227], v[176:179], a[8:11]
    buffer_load_dwordx4 v4, s[8:11], s45 offen offset:3072 lds
    v_mfma_f32_16x16x32_bf16 a[8:11], a[228:231], v[180:183], a[8:11]
    s_add_u32 s45, s45, 16384
    v_exp_f32 v111, v111
    v_mfma_f32_16x16x32_bf16 a[4:7], a[228:231], v[172:175], a[4:7]
    ds_read_b64_tr_b16 a[248:249], v27 offset:32768
    ds_read_b64_tr_b16 a[250:251], v27 offset:36864
    v_mfma_f32_16x16x32_bf16 a[4:7], a[224:227], v[168:171], a[4:7]
    v_exp_f32 v100, v100
    v_mfma_f32_16x16x32_bf16 a[0:3], a[224:227], v[160:163], a[0:3]
    v_mfma_f32_16x16x32_bf16 a[0:3], a[228:231], v[164:167], a[0:3]
    s_waitcnt lgkmcnt(8)
    v_exp_f32 v101, v101
    v_mfma_f32_16x16x32_bf16 a[16:19], a[236:239], v[164:167], a[16:19]
    ds_read_b64_tr_b16 a[228:229], v28 offset:40960
    ds_read_b64_tr_b16 a[230:231], v28 offset:45056
    v_mfma_f32_16x16x32_bf16 a[16:19], a[232:235], v[160:163], a[16:19]
    s_add_u32 m0, s39, 81920
    v_exp_f32 v102, v102
    v_mfma_f32_16x16x32_bf16 a[20:23], a[232:235], v[168:171], a[20:23]
    buffer_load_dwordx4 v5, s[12:15], s46 offen offset:0 lds
    v_mfma_f32_16x16x32_bf16 a[20:23], a[236:239], v[172:175], a[20:23]
    v_exp_f32 v103, v103
    v_mfma_f32_16x16x32_bf16 a[24:27], a[236:239], v[180:183], a[24:27]
    ds_read_b64_tr_b16 a[224:225], v28 offset:32768
    ds_read_b64_tr_b16 a[226:227], v28 offset:36864
    v_mfma_f32_16x16x32_bf16 a[24:27], a[232:235], v[176:179], a[24:27]
    v_exp_f32 v128, v128
    v_mfma_f32_16x16x32_bf16 a[28:31], a[232:235], v[184:187], a[28:31]
    v_mfma_f32_16x16x32_bf16 a[28:31], a[236:239], v[188:191], a[28:31]
    s_waitcnt lgkmcnt(8)
    v_exp_f32 v129, v129
    v_mfma_f32_16x16x32_bf16 a[44:47], a[244:247], v[188:191], a[44:47]
    ds_read_b64_tr_b16 a[236:237], v29 offset:40960
    ds_read_b64_tr_b16 a[238:239], v29 offset:45056
    v_mfma_f32_16x16x32_bf16 a[44:47], a[240:243], v[184:187], a[44:47]
    v_exp_f32 v130, v130
    v_mfma_f32_16x16x32_bf16 a[40:43], a[240:243], v[176:179], a[40:43]
    v_mfma_f32_16x16x32_bf16 a[40:43], a[244:247], v[180:183], a[40:43]
    v_exp_f32 v131, v131
    v_mfma_f32_16x16x32_bf16 a[36:39], a[244:247], v[172:175], a[36:39]
    ds_read_b64_tr_b16 a[232:233], v29 offset:32768
    ds_read_b64_tr_b16 a[234:235], v29 offset:36864
    v_mfma_f32_16x16x32_bf16 a[36:39], a[240:243], v[168:171], a[36:39]
    v_exp_f32 v136, v136
    v_mfma_f32_16x16x32_bf16 a[32:35], a[240:243], v[160:163], a[32:35]
    buffer_load_dwordx4 v6, s[12:15], s46 offen offset:1024 lds
    v_mfma_f32_16x16x32_bf16 a[32:35], a[244:247], v[164:167], a[32:35]
    s_waitcnt lgkmcnt(8)
    v_exp_f32 v137, v137
    v_mfma_f32_16x16x32_bf16 a[48:51], a[252:255], v[164:167], a[48:51]
    ds_read_b64_tr_b16 a[244:245], v30 offset:40960
    ds_read_b64_tr_b16 a[246:247], v30 offset:45056
    v_mfma_f32_16x16x32_bf16 a[48:51], a[248:251], v[160:163], a[48:51]
    v_exp_f32 v138, v138
    v_mfma_f32_16x16x32_bf16 a[52:55], a[248:251], v[168:171], a[52:55]
    v_mfma_f32_16x16x32_bf16 a[52:55], a[252:255], v[172:175], a[52:55]
    v_exp_f32 v139, v139
    v_mfma_f32_16x16x32_bf16 a[56:59], a[252:255], v[180:183], a[56:59]
    ds_read_b64_tr_b16 a[240:241], v30 offset:32768
    ds_read_b64_tr_b16 a[242:243], v30 offset:36864
    v_mfma_f32_16x16x32_bf16 a[56:59], a[248:251], v[176:179], a[56:59]
    v_exp_f32 v144, v144
    v_mfma_f32_16x16x32_bf16 a[60:63], a[248:251], v[184:187], a[60:63]
    v_mfma_f32_16x16x32_bf16 a[60:63], a[252:255], v[188:191], a[60:63]
    s_waitcnt lgkmcnt(8)
    v_exp_f32 v145, v145
    v_mfma_f32_16x16x32_bf16 a[76:79], a[228:231], v[188:191], a[76:79]
    ds_read_b64_tr_b16 a[252:253], v31 offset:40960
    ds_read_b64_tr_b16 a[254:255], v31 offset:45056
    v_mfma_f32_16x16x32_bf16 a[76:79], a[224:227], v[184:187], a[76:79]
    v_exp_f32 v146, v146
    v_mfma_f32_16x16x32_bf16 a[72:75], a[224:227], v[176:179], a[72:75]
    buffer_load_dwordx4 v5, s[12:15], s46 offen offset:2048 lds
    v_mfma_f32_16x16x32_bf16 a[72:75], a[228:231], v[180:183], a[72:75]
    v_exp_f32 v147, v147
    v_mfma_f32_16x16x32_bf16 a[68:71], a[228:231], v[172:175], a[68:71]
    ds_read_b64_tr_b16 a[248:249], v31 offset:32768
    ds_read_b64_tr_b16 a[250:251], v31 offset:36864
    v_mfma_f32_16x16x32_bf16 a[68:71], a[224:227], v[168:171], a[68:71]
    v_exp_f32 v152, v152
    v_mfma_f32_16x16x32_bf16 a[64:67], a[224:227], v[160:163], a[64:67]
    v_mfma_f32_16x16x32_bf16 a[64:67], a[228:231], v[164:167], a[64:67]
    s_waitcnt lgkmcnt(8)
    v_exp_f32 v153, v153
    v_mfma_f32_16x16x32_bf16 a[80:83], a[236:239], v[164:167], a[80:83]
    v_mfma_f32_16x16x32_bf16 a[80:83], a[232:235], v[160:163], a[80:83]
    v_exp_f32 v154, v154
    v_mfma_f32_16x16x32_bf16 a[84:87], a[232:235], v[168:171], a[84:87]
    buffer_load_dwordx4 v6, s[12:15], s46 offen offset:3072 lds
    v_mfma_f32_16x16x32_bf16 a[84:87], a[236:239], v[172:175], a[84:87]
    s_add_u32 s46, s46, 16384
    v_exp_f32 v155, v155
    v_mfma_f32_16x16x32_bf16 a[88:91], a[236:239], v[180:183], a[88:91]
    v_mfma_f32_16x16x32_bf16 a[88:91], a[232:235], v[176:179], a[88:91]
    s_waitcnt vmcnt(16) lgkmcnt(0)
    v_exp_f32 v156, v156
    v_mfma_f32_16x16x32_bf16 a[92:95], a[232:235], v[184:187], a[92:95]
    s_barrier
    v_mfma_f32_16x16x32_bf16 a[92:95], a[236:239], v[188:191], a[92:95]
    v_exp_f32 v157, v157
    v_mfma_f32_16x16x32_bf16 a[108:111], a[244:247], v[188:191], a[108:111]
    ds_read_b128 a[192:195], v10 offset:49152
    v_mfma_f32_16x16x32_bf16 a[108:111], a[240:243], v[184:187], a[108:111]
    v_exp_f32 v158, v158
    v_mfma_f32_16x16x32_bf16 a[104:107], a[240:243], v[176:179], a[104:107]
    ds_read_b128 a[196:199], v11 offset:49152
    v_mfma_f32_16x16x32_bf16 a[104:107], a[244:247], v[180:183], a[104:107]
    v_exp_f32 v159, v159
    v_mfma_f32_16x16x32_bf16 a[100:103], a[244:247], v[172:175], a[100:103]
    ds_read_b128 a[200:203], v12 offset:49152
    v_mfma_f32_16x16x32_bf16 a[100:103], a[240:243], v[168:171], a[100:103]
    v_exp_f32 v148, v148
    v_mfma_f32_16x16x32_bf16 a[96:99], a[240:243], v[160:163], a[96:99]
    ds_read_b128 a[204:207], v13 offset:49152
    v_mfma_f32_16x16x32_bf16 a[96:99], a[244:247], v[164:167], a[96:99]
    v_exp_f32 v149, v149
    v_mfma_f32_16x16x32_bf16 a[112:115], a[252:255], v[164:167], a[112:115]
    buffer_load_dword a191, v20, s[16:19], s51 offen
    v_mfma_f32_16x16x32_bf16 a[112:115], a[248:251], v[160:163], a[112:115]
    v_exp_f32 v150, v150
    v_mfma_f32_16x16x32_bf16 a[116:119], a[248:251], v[168:171], a[116:119]
    v_cvt_pk_bf16_f32 v160, v96, v97
    v_cvt_pk_bf16_f32 v161, v98, v99
    v_mfma_f32_16x16x32_bf16 a[116:119], a[252:255], v[172:175], a[116:119]
    v_exp_f32 v151, v151
    v_mfma_f32_16x16x32_bf16 a[120:123], a[252:255], v[180:183], a[120:123]
    v_cvt_pk_bf16_f32 v168, v104, v105
    v_cvt_pk_bf16_f32 v169, v106, v107
    v_mfma_f32_16x16x32_bf16 a[120:123], a[248:251], v[176:179], a[120:123]
    v_exp_f32 v140, v140
    v_mfma_f32_16x16x32_bf16 a[124:127], a[248:251], v[184:187], a[124:127]
    v_cvt_pk_bf16_f32 v176, v112, v113
    v_cvt_pk_bf16_f32 v177, v114, v115
    v_mfma_f32_16x16x32_bf16 a[124:127], a[252:255], v[188:191], a[124:127]
    s_waitcnt lgkmcnt(0)
    v_exp_f32 v141, v141
L_e2:
    v_mfma_f32_16x16x32_bf16 v[96:99], a[192:195], v[32:35], v[192:195]
    v_exp_f32 v142, v142
    v_mfma_f32_16x16x32_bf16 v[96:99], a[196:199], v[36:39], v[96:99]
    ds_read_b128 a[208:211], v10 offset:53248
    v_cvt_pk_bf16_f32 v184, v120, v121
    v_mfma_f32_16x16x32_bf16 v[96:99], a[200:203], v[40:43], v[96:99]
    v_exp_f32 v143, v143
    v_mfma_f32_16x16x32_bf16 v[96:99], a[204:207], v[44:47], v[96:99]
    ds_read_b128 a[212:215], v11 offset:53248
    v_cvt_pk_bf16_f32 v185, v122, v123
    v_mfma_f32_16x16x32_bf16 v[104:107], a[204:207], v[60:63], v[196:199]
    v_exp_f32 v132, v132
    v_mfma_f32_16x16x32_bf16 v[104:107], a[200:203], v[56:59], v[104:107]
    ds_read_b128 a[216:219], v12 offset:53248
    v_cvt_pk_bf16_f32 v186, v124, v125
    v_mfma_f32_16x16x32_bf16 v[104:107], a[196:199], v[52:55], v[104:107]
    v_exp_f32 v133, v133
    v_mfma_f32_16x16x32_bf16 v[104:107], a[192:195], v[48:51], v[104:107]
    ds_read_b128 a[220:223], v13 offset:53248
    v_cvt_pk_bf16_f32 v187, v126, v127
    v_mfma_f32_16x16x32_bf16 v[112:115], a[192:195], v[64:67], v[200:203]
    v_exp_f32 v134, v134
    v_mfma_f32_16x16x32_bf16 v[112:115], a[196:199], v[68:71], v[112:115]
    v_cvt_pk_bf16_f32 v178, v116, v117
    v_cvt_pk_bf16_f32 v179, v118, v119
    v_mfma_f32_16x16x32_bf16 v[112:115], a[200:203], v[72:75], v[112:115]
    v_exp_f32 v135, v135
    v_mfma_f32_16x16x32_bf16 v[112:115], a[204:207], v[76:79], v[112:115]
    s_add_u32 m0, s39, 32768
    v_cvt_pk_bf16_f32 v170, v108, v109
    v_cvt_pk_bf16_f32 v171, v110, v111
    v_mfma_f32_16x16x32_bf16 v[120:123], a[204:207], v[92:95], v[204:207]
    v_exp_f32 v96, v96
    v_mfma_f32_16x16x32_bf16 v[120:123], a[200:203], v[88:91], v[120:123]
    buffer_load_dwordx4 v1, s[8:11], s45 offen offset:0 lds
    v_mfma_f32_16x16x32_bf16 v[120:123], a[196:199], v[84:87], v[120:123]
    v_exp_f32 v97, v97
    v_mfma_f32_16x16x32_bf16 v[120:123], a[192:195], v[80:83], v[120:123]
    s_waitcnt lgkmcnt(0)
    v_cvt_pk_bf16_f32 v162, v100, v101
    v_cvt_pk_bf16_f32 v163, v102, v103
    v_mfma_f32_16x16x32_bf16 v[124:127], a[208:211], v[80:83], v[204:207]
    v_exp_f32 v98, v98
    v_mfma_f32_16x16x32_bf16 v[124:127], a[212:215], v[84:87], v[124:127]
    ds_read_b128 a[192:195], v10 offset:57344
    v_mfma_f32_16x16x32_bf16 v[124:127], a[216:219], v[88:91], v[124:127]
    v_exp_f32 v99, v99
    v_mfma_f32_16x16x32_bf16 v[124:127], a[220:223], v[92:95], v[124:127]
    ds_read_b128 a[196:199], v11 offset:57344
    v_cvt_pk_bf16_f32 v164, v128, v129
    v_mfma_f32_16x16x32_bf16 v[116:119], a[220:223], v[76:79], v[200:203]
    v_exp_f32 v104, v104
    v_mfma_f32_16x16x32_bf16 v[116:119], a[216:219], v[72:75], v[116:119]
    ds_read_b128 a[200:203], v12 offset:57344
    v_cvt_pk_bf16_f32 v165, v130, v131
    v_mfma_f32_16x16x32_bf16 v[116:119], a[212:215], v[68:71], v[116:119]
    v_exp_f32 v105, v105
    v_mfma_f32_16x16x32_bf16 v[116:119], a[208:211], v[64:67], v[116:119]
    ds_read_b128 a[204:207], v13 offset:57344
    v_cvt_pk_bf16_f32 v172, v136, v137
    v_mfma_f32_16x16x32_bf16 v[108:111], a[208:211], v[48:51], v[196:199]
    v_exp_f32 v106, v106
    v_mfma_f32_16x16x32_bf16 v[108:111], a[212:215], v[52:55], v[108:111]
    v_cvt_pk_bf16_f32 v173, v138, v139
    v_mfma_f32_16x16x32_bf16 v[108:111], a[216:219], v[56:59], v[108:111]
    v_exp_f32 v107, v107
    v_mfma_f32_16x16x32_bf16 v[108:111], a[220:223], v[60:63], v[108:111]
    v_cvt_pk_bf16_f32 v180, v144, v145
    v_cvt_pk_bf16_f32 v181, v146, v147
    v_mfma_f32_16x16x32_bf16 v[100:103], a[220:223], v[44:47], v[192:195]
    v_exp_f32 v112, v112
    v_mfma_f32_16x16x32_bf16 v[100:103], a[216:219], v[40:43], v[100:103]
    buffer_load_dwordx4 v2, s[8:11], s45 offen offset:1024 lds
    v_mfma_f32_16x16x32_bf16 v[100:103], a[212:215], v[36:39], v[100:103]
    v_exp_f32 v113, v113
    v_mfma_f32_16x16x32_bf16 v[100:103], a[208:211], v[32:35], v[100:103]
    s_waitcnt lgkmcnt(0)
    v_cvt_pk_bf16_f32 v188, v152, v153
    v_cvt_pk_bf16_f32 v189, v154, v155
    v_mfma_f32_16x16x32_bf16 v[128:131], a[192:195], v[32:35], v[192:195]
    v_exp_f32 v114, v114
    v_mfma_f32_16x16x32_bf16 v[128:131], a[196:199], v[36:39], v[128:131]
    ds_read_b128 a[208:211], v10 offset:61440
    v_mfma_f32_16x16x32_bf16 v[128:131], a[200:203], v[40:43], v[128:131]
    v_exp_f32 v115, v115
    v_mfma_f32_16x16x32_bf16 v[128:131], a[204:207], v[44:47], v[128:131]
    ds_read_b128 a[212:215], v11 offset:61440
    v_cvt_pk_bf16_f32 v190, v156, v157
    v_mfma_f32_16x16x32_bf16 v[136:139], a[204:207], v[60:63], v[196:199]
    v_exp_f32 v120, v120
    v_mfma_f32_16x16x32_bf16 v[136:139], a[200:203], v[56:59], v[136:139]
    ds_read_b128 a[216:219], v12 offset:61440
    v_cvt_pk_bf16_f32 v191, v158, v159
    v_mfma_f32_16x16x32_bf16 v[136:139], a[196:199], v[52:55], v[136:139]
    v_exp_f32 v121, v121
    v_mfma_f32_16x16x32_bf16 v[136:139], a[192:195], v[48:51], v[136:139]
    ds_read_b128 a[220:223], v13 offset:61440
    v_cvt_pk_bf16_f32 v182, v148, v149
    v_mfma_f32_16x16x32_bf16 v[144:147], a[192:195], v[64:67], v[200:203]
    v_exp_f32 v122, v122
    v_mfma_f32_16x16x32_bf16 v[144:147], a[196:199], v[68:71], v[144:147]
    v_cvt_pk_bf16_f32 v183, v150, v151
    v_mfma_f32_16x16x32_bf16 v[144:147], a[200:203], v[72:75], v[144:147]
    v_exp_f32 v123, v123
    v_mfma_f32_16x16x32_bf16 v[144:147], a[204:207], v[76:79], v[144:147]
    v_cvt_pk_bf16_f32 v174, v140, v141
    v_cvt_pk_bf16_f32 v175, v142, v143
    v_mfma_f32_16x16x32_bf16 v[152:155], a[204:207], v[92:95], v[204:207]
    v_exp_f32 v124, v124
    v_mfma_f32_16x16x32_bf16 v[152:155], a[200:203], v[88:91], v[152:155]
    ds_read_b64_tr_b16 a[228:229], v24 offset:57344
    v_mfma_f32_16x16x32_bf16 v[152:155], a[196:199], v[84:87], v[152:155]
    v_exp_f32 v125, v125
    v_mfma_f32_16x16x32_bf16 v[152:155], a[192:195], v[80:83], v[152:155]
    s_waitcnt lgkmcnt(1)
    ds_read_b64_tr_b16 a[230:231], v24 offset:61440
    v_cvt_pk_bf16_f32 v166, v132, v133
    v_mfma_f32_16x16x32_bf16 v[156:159], a[208:211], v[80:83], v[204:207]
    v_exp_f32 v126, v126
    v_mfma_f32_16x16x32_bf16 v[156:159], a[212:215], v[84:87], v[156:159]
    ds_read_b64_tr_b16 a[224:225], v24 offset:49152
    v_cvt_pk_bf16_f32 v167, v134, v135
    v_mfma_f32_16x16x32_bf16 v[156:159], a[216:219], v[88:91], v[156:159]
    v_exp_f32 v127, v127
    v_mfma_f32_16x16x32_bf16 v[156:159], a[220:223], v[92:95], v[156:159]
    ds_read_b64_tr_b16 a[226:227], v24 offset:53248
    v_mfma_f32_16x16x32_bf16 v[148:151], a[220:223], v[76:79], v[200:203]
    v_exp_f32 v116, v116
    v_mfma_f32_16x16x32_bf16 v[148:151], a[216:219], v[72:75], v[148:151]
    ds_read_b64_tr_b16 a[236:237], v25 offset:57344
    v_mfma_f32_16x16x32_bf16 v[148:151], a[212:215], v[68:71], v[148:151]
    v_exp_f32 v117, v117
    v_mfma_f32_16x16x32_bf16 v[148:151], a[208:211], v[64:67], v[148:151]
    ds_read_b64_tr_b16 a[238:239], v25 offset:61440
    v_mfma_f32_16x16x32_bf16 v[140:143], a[208:211], v[48:51], v[196:199]
    v_exp_f32 v118, v118
    v_mfma_f32_16x16x32_bf16 v[140:143], a[212:215], v[52:55], v[140:143]
    ds_read_b64_tr_b16 a[232:233], v25 offset:49152
    v_mfma_f32_16x16x32_bf16 v[140:143], a[216:219], v[56:59], v[140:143]
    v_exp_f32 v119, v119
    v_mfma_f32_16x16x32_bf16 v[140:143], a[220:223], v[60:63], v[140:143]
    ds_read_b64_tr_b16 a[234:235], v25 offset:53248
    v_mfma_f32_16x16x32_bf16 v[132:135], a[220:223], v[44:47], v[192:195]
    v_exp_f32 v108, v108
    v_mfma_f32_16x16x32_bf16 v[132:135], a[216:219], v[40:43], v[132:135]
    ds_read_b64_tr_b16 a[244:245], v26 offset:57344
    v_mfma_f32_16x16x32_bf16 v[132:135], a[212:215], v[36:39], v[132:135]
    v_exp_f32 v109, v109
    v_mfma_f32_16x16x32_bf16 v[132:135], a[208:211], v[32:35], v[132:135]
    ds_read_b64_tr_b16 a[246:247], v26 offset:61440
    v_smfmac_f32_16x16x64_bf16 a[128:131], a[144:147], v[160:167], v23
    ds_read_b64_tr_b16 a[240:241], v26 offset:49152
    v_smfmac_f32_16x16x64_bf16 a[132:135], a[144:147], v[168:175], v23
    buffer_load_dwordx4 v3, s[8:11], s45 offen offset:2048 lds
    v_smfmac_f32_16x16x64_bf16 a[136:139], a[144:147], v[176:183], v23
    ds_read_b64_tr_b16 a[242:243], v26 offset:53248
    v_smfmac_f32_16x16x64_bf16 a[140:143], a[144:147], v[184:191], v23
    s_waitcnt lgkmcnt(8)
    v_mfma_f32_16x16x32_bf16 a[12:15], a[228:231], v[188:191], a[12:15]
    ds_read_b64_tr_b16 a[252:253], v27 offset:57344
    ds_read_b64_tr_b16 a[254:255], v27 offset:61440
    v_mfma_f32_16x16x32_bf16 a[12:15], a[224:227], v[184:187], a[12:15]
    v_exp_f32 v110, v110
    v_mfma_f32_16x16x32_bf16 a[8:11], a[224:227], v[176:179], a[8:11]
    buffer_load_dwordx4 v4, s[8:11], s45 offen offset:3072 lds
    v_mfma_f32_16x16x32_bf16 a[8:11], a[228:231], v[180:183], a[8:11]
    s_add_u32 s45, s45, 16384
    v_exp_f32 v111, v111
    v_mfma_f32_16x16x32_bf16 a[4:7], a[228:231], v[172:175], a[4:7]
    ds_read_b64_tr_b16 a[248:249], v27 offset:49152
    ds_read_b64_tr_b16 a[250:251], v27 offset:53248
    v_mfma_f32_16x16x32_bf16 a[4:7], a[224:227], v[168:171], a[4:7]
    v_exp_f32 v100, v100
    v_mfma_f32_16x16x32_bf16 a[0:3], a[224:227], v[160:163], a[0:3]
    v_mfma_f32_16x16x32_bf16 a[0:3], a[228:231], v[164:167], a[0:3]
    s_waitcnt lgkmcnt(8)
    v_exp_f32 v101, v101
    v_mfma_f32_16x16x32_bf16 a[16:19], a[236:239], v[164:167], a[16:19]
    ds_read_b64_tr_b16 a[228:229], v28 offset:57344
    ds_read_b64_tr_b16 a[230:231], v28 offset:61440
    v_mfma_f32_16x16x32_bf16 a[16:19], a[232:235], v[160:163], a[16:19]
    s_add_u32 m0, s39, 98304
    v_exp_f32 v102, v102
    v_mfma_f32_16x16x32_bf16 a[20:23], a[232:235], v[168:171], a[20:23]
    buffer_load_dwordx4 v5, s[12:15], s46 offen offset:0 lds
    v_mfma_f32_16x16x32_bf16 a[20:23], a[236:239], v[172:175], a[20:23]
    v_exp_f32 v103, v103
    v_mfma_f32_16x16x32_bf16 a[24:27], a[236:239], v[180:183], a[24:27]
    ds_read_b64_tr_b16 a[224:225], v28 offset:49152
    ds_read_b64_tr_b16 a[226:227], v28 offset:53248
    v_mfma_f32_16x16x32_bf16 a[24:27], a[232:235], v[176:179], a[24:27]
    v_exp_f32 v128, v128
    v_mfma_f32_16x16x32_bf16 a[28:31], a[232:235], v[184:187], a[28:31]
    v_mfma_f32_16x16x32_bf16 a[28:31], a[236:239], v[188:191], a[28:31]
    s_waitcnt lgkmcnt(8)
    v_exp_f32 v129, v129
    v_mfma_f32_16x16x32_bf16 a[44:47], a[244:247], v[188:191], a[44:47]
    ds_read_b64_tr_b16 a[236:237], v29 offset:57344
    ds_read_b64_tr_b16 a[238:239], v29 offset:61440
    v_mfma_f32_16x16x32_bf16 a[44:47], a[240:243], v[184:187], a[44:47]
    v_exp_f32 v130, v130
    v_mfma_f32_16x16x32_bf16 a[40:43], a[240:243], v[176:179], a[40:43]
    v_mfma_f32_16x16x32_bf16 a[40:43], a[244:247], v[180:183], a[40:43]
    v_exp_f32 v131, v131
    v_mfma_f32_16x16x32_bf16 a[36:39], a[244:247], v[172:175], a[36:39]
    ds_read_b64_tr_b16 a[232:233], v29 offset:49152
    ds_read_b64_tr_b16 a[234:235], v29 offset:53248
    v_mfma_f32_16x16x32_bf16 a[36:39], a[240:243], v[168:171], a[36:39]
    v_exp_f32 v136, v136
    v_mfma_f32_16x16x32_bf16 a[32:35], a[240:243], v[160:163], a[32:35]
    buffer_load_dwordx4 v6, s[12:15], s46 offen offset:1024 lds
    v_mfma_f32_16x16x32_bf16 a[32:35], a[244:247], v[164:167], a[32:35]
    s_waitcnt lgkmcnt(8)
    v_exp_f32 v137, v137
    v_mfma_f32_16x16x32_bf16 a[48:51], a[252:255], v[164:167], a[48:51]
    ds_read_b64_tr_b16 a[244:245], v30 offset:57344
    ds_read_b64_tr_b16 a[246:247], v30 offset:61440
    v_mfma_f32_16x16x32_bf16 a[48:51], a[248:251], v[160:163], a[48:51]
    v_exp_f32 v138, v138
    v_mfma_f32_16x16x32_bf16 a[52:55], a[248:251], v[168:171], a[52:55]
    v_mfma_f32_16x16x32_bf16 a[52:55], a[252:255], v[172:175], a[52:55]
    v_exp_f32 v139, v139
    v_mfma_f32_16x16x32_bf16 a[56:59], a[252:255], v[180:183], a[56:59]
    ds_read_b64_tr_b16 a[240:241], v30 offset:49152
    ds_read_b64_tr_b16 a[242:243], v30 offset:53248
    v_mfma_f32_16x16x32_bf16 a[56:59], a[248:251], v[176:179], a[56:59]
    v_exp_f32 v144, v144
    v_mfma_f32_16x16x32_bf16 a[60:63], a[248:251], v[184:187], a[60:63]
    v_mfma_f32_16x16x32_bf16 a[60:63], a[252:255], v[188:191], a[60:63]
    s_waitcnt lgkmcnt(8)
    v_exp_f32 v145, v145
    v_mfma_f32_16x16x32_bf16 a[76:79], a[228:231], v[188:191], a[76:79]
    ds_read_b64_tr_b16 a[252:253], v31 offset:57344
    ds_read_b64_tr_b16 a[254:255], v31 offset:61440
    v_mfma_f32_16x16x32_bf16 a[76:79], a[224:227], v[184:187], a[76:79]
    v_exp_f32 v146, v146
    v_mfma_f32_16x16x32_bf16 a[72:75], a[224:227], v[176:179], a[72:75]
    buffer_load_dwordx4 v5, s[12:15], s46 offen offset:2048 lds
    v_mfma_f32_16x16x32_bf16 a[72:75], a[228:231], v[180:183], a[72:75]
    v_exp_f32 v147, v147
    v_mfma_f32_16x16x32_bf16 a[68:71], a[228:231], v[172:175], a[68:71]
    ds_read_b64_tr_b16 a[248:249], v31 offset:49152
    ds_read_b64_tr_b16 a[250:251], v31 offset:53248
    v_mfma_f32_16x16x32_bf16 a[68:71], a[224:227], v[168:171], a[68:71]
    v_exp_f32 v152, v152
    v_mfma_f32_16x16x32_bf16 a[64:67], a[224:227], v[160:163], a[64:67]
    v_mfma_f32_16x16x32_bf16 a[64:67], a[228:231], v[164:167], a[64:67]
    s_waitcnt lgkmcnt(8)
    v_exp_f32 v153, v153
    v_mfma_f32_16x16x32_bf16 a[80:83], a[236:239], v[164:167], a[80:83]
    v_mfma_f32_16x16x32_bf16 a[80:83], a[232:235], v[160:163], a[80:83]
    v_exp_f32 v154, v154
    v_mfma_f32_16x16x32_bf16 a[84:87], a[232:235], v[168:171], a[84:87]
    buffer_load_dwordx4 v6, s[12:15], s46 offen offset:3072 lds
    v_mfma_f32_16x16x32_bf16 a[84:87], a[236:239], v[172:175], a[84:87]
    s_add_u32 s46, s46, 16384
    v_exp_f32 v155, v155
    v_mfma_f32_16x16x32_bf16 a[88:91], a[236:239], v[180:183], a[88:91]
    v_mfma_f32_16x16x32_bf16 a[88:91], a[232:235], v[176:179], a[88:91]
    s_waitcnt vmcnt(16) lgkmcnt(0)
    v_exp_f32 v156, v156
    v_mfma_f32_16x16x32_bf16 a[92:95], a[232:235], v[184:187], a[92:95]
    s_barrier
    v_mfma_f32_16x16x32_bf16 a[92:95], a[236:239], v[188:191], a[92:95]
    v_exp_f32 v157, v157
    v_mfma_f32_16x16x32_bf16 a[108:111], a[244:247], v[188:191], a[108:111]
    ds_read_b128 a[192:195], v10 offset:0
    v_mfma_f32_16x16x32_bf16 a[108:111], a[240:243], v[184:187], a[108:111]
    v_exp_f32 v158, v158
    v_mfma_f32_16x16x32_bf16 a[104:107], a[240:243], v[176:179], a[104:107]
    ds_read_b128 a[196:199], v11 offset:0
    v_mfma_f32_16x16x32_bf16 a[104:107], a[244:247], v[180:183], a[104:107]
    v_exp_f32 v159, v159
    v_mfma_f32_16x16x32_bf16 a[100:103], a[244:247], v[172:175], a[100:103]
    ds_read_b128 a[200:203], v12 offset:0
    v_mfma_f32_16x16x32_bf16 a[100:103], a[240:243], v[168:171], a[100:103]
    v_exp_f32 v148, v148
    v_mfma_f32_16x16x32_bf16 a[96:99], a[240:243], v[160:163], a[96:99]
    ds_read_b128 a[204:207], v13 offset:0
    v_mfma_f32_16x16x32_bf16 a[96:99], a[244:247], v[164:167], a[96:99]
    v_exp_f32 v149, v149
    v_mfma_f32_16x16x32_bf16 a[112:115], a[252:255], v[164:167], a[112:115]
    buffer_load_dword a191, v21, s[24:27], s52 offen
    v_mfma_f32_16x16x32_bf16 a[112:115], a[248:251], v[160:163], a[112:115]
    v_exp_f32 v150, v150
    v_mfma_f32_16x16x32_bf16 a[116:119], a[248:251], v[168:171], a[116:119]
    v_cvt_pk_bf16_f32 v160, v96, v97
    v_cvt_pk_bf16_f32 v161, v98, v99
    v_mfma_f32_16x16x32_bf16 a[116:119], a[252:255], v[172:175], a[116:119]
    v_exp_f32 v151, v151
    v_mfma_f32_16x16x32_bf16 a[120:123], a[252:255], v[180:183], a[120:123]
    v_cvt_pk_bf16_f32 v168, v104, v105
    v_cvt_pk_bf16_f32 v169, v106, v107
    v_mfma_f32_16x16x32_bf16 a[120:123], a[248:251], v[176:179], a[120:123]
    v_exp_f32 v140, v140
    v_mfma_f32_16x16x32_bf16 a[124:127], a[248:251], v[184:187], a[124:127]
    v_cvt_pk_bf16_f32 v176, v112, v113
    v_cvt_pk_bf16_f32 v177, v114, v115
    v_mfma_f32_16x16x32_bf16 a[124:127], a[252:255], v[188:191], a[124:127]
    s_waitcnt lgkmcnt(0)
    v_exp_f32 v141, v141
    v_mfma_f32_16x16x32_bf16 v[96:99], a[192:195], v[32:35], v[192:195]
    v_exp_f32 v142, v142
    v_mfma_f32_16x16x32_bf16 v[96:99], a[196:199], v[36:39], v[96:99]
    ds_read_b128 a[208:211], v10 offset:4096
    v_cvt_pk_bf16_f32 v184, v120, v121
    v_mfma_f32_16x16x32_bf16 v[96:99], a[200:203], v[40:43], v[96:99]
    v_exp_f32 v143, v143
    v_mfma_f32_16x16x32_bf16 v[96:99], a[204:207], v[44:47], v[96:99]
    ds_read_b128 a[212:215], v11 offset:4096
    v_cvt_pk_bf16_f32 v185, v122, v123
    v_mfma_f32_16x16x32_bf16 v[104:107], a[204:207], v[60:63], v[196:199]
    v_exp_f32 v132, v132
    v_mfma_f32_16x16x32_bf16 v[104:107], a[200:203], v[56:59], v[104:107]
    ds_read_b128 a[216:219], v12 offset:4096
    v_cvt_pk_bf16_f32 v186, v124, v125
    v_mfma_f32_16x16x32_bf16 v[104:107], a[196:199], v[52:55], v[104:107]
    v_exp_f32 v133, v133
    v_mfma_f32_16x16x32_bf16 v[104:107], a[192:195], v[48:51], v[104:107]
    ds_read_b128 a[220:223], v13 offset:4096
    v_cvt_pk_bf16_f32 v187, v126, v127
    v_mfma_f32_16x16x32_bf16 v[112:115], a[192:195], v[64:67], v[200:203]
    v_exp_f32 v134, v134
    v_mfma_f32_16x16x32_bf16 v[112:115], a[196:199], v[68:71], v[112:115]
    v_cvt_pk_bf16_f32 v178, v116, v117
    v_cvt_pk_bf16_f32 v179, v118, v119
    v_mfma_f32_16x16x32_bf16 v[112:115], a[200:203], v[72:75], v[112:115]
    v_exp_f32 v135, v135
    v_mfma_f32_16x16x32_bf16 v[112:115], a[204:207], v[76:79], v[112:115]
    s_add_u32 m0, s39, 49152
    v_cvt_pk_bf16_f32 v170, v108, v109
    v_cvt_pk_bf16_f32 v171, v110, v111
    v_mfma_f32_16x16x32_bf16 v[120:123], a[204:207], v[92:95], v[204:207]
    v_exp_f32 v96, v96
    v_mfma_f32_16x16x32_bf16 v[120:123], a[200:203], v[88:91], v[120:123]
    buffer_load_dwordx4 v1, s[8:11], s45 offen offset:0 lds
    v_mfma_f32_16x16x32_bf16 v[120:123], a[196:199], v[84:87], v[120:123]
    v_exp_f32 v97, v97
    v_mfma_f32_16x16x32_bf16 v[120:123], a[192:195], v[80:83], v[120:123]
    s_waitcnt lgkmcnt(0)
    v_cvt_pk_bf16_f32 v162, v100, v101
    v_cvt_pk_bf16_f32 v163, v102, v103
    v_mfma_f32_16x16x32_bf16 v[124:127], a[208:211], v[80:83], v[204:207]
    v_exp_f32 v98, v98
    v_mfma_f32_16x16x32_bf16 v[124:127], a[212:215], v[84:87], v[124:127]
    ds_read_b128 a[192:195], v10 offset:8192
    v_mfma_f32_16x16x32_bf16 v[124:127], a[216:219], v[88:91], v[124:127]
    v_exp_f32 v99, v99
    v_mfma_f32_16x16x32_bf16 v[124:127], a[220:223], v[92:95], v[124:127]
    ds_read_b128 a[196:199], v11 offset:8192
    v_cvt_pk_bf16_f32 v164, v128, v129
    v_mfma_f32_16x16x32_bf16 v[116:119], a[220:223], v[76:79], v[200:203]
    v_exp_f32 v104, v104
    v_mfma_f32_16x16x32_bf16 v[116:119], a[216:219], v[72:75], v[116:119]
    ds_read_b128 a[200:203], v12 offset:8192
    v_cvt_pk_bf16_f32 v165, v130, v131
    v_mfma_f32_16x16x32_bf16 v[116:119], a[212:215], v[68:71], v[116:119]
    v_exp_f32 v105, v105
    v_mfma_f32_16x16x32_bf16 v[116:119], a[208:211], v[64:67], v[116:119]
    ds_read_b128 a[204:207], v13 offset:8192
    v_cvt_pk_bf16_f32 v172, v136, v137
    v_mfma_f32_16x16x32_bf16 v[108:111], a[208:211], v[48:51], v[196:199]
    v_exp_f32 v106, v106
    v_mfma_f32_16x16x32_bf16 v[108:111], a[212:215], v[52:55], v[108:111]
    v_cvt_pk_bf16_f32 v173, v138, v139
    v_mfma_f32_16x16x32_bf16 v[108:111], a[216:219], v[56:59], v[108:111]
    v_exp_f32 v107, v107
    v_mfma_f32_16x16x32_bf16 v[108:111], a[220:223], v[60:63], v[108:111]
    v_cvt_pk_bf16_f32 v180, v144, v145
    v_cvt_pk_bf16_f32 v181, v146, v147
    v_mfma_f32_16x16x32_bf16 v[100:103], a[220:223], v[44:47], v[192:195]
    v_exp_f32 v112, v112
    v_mfma_f32_16x16x32_bf16 v[100:103], a[216:219], v[40:43], v[100:103]
    buffer_load_dwordx4 v2, s[8:11], s45 offen offset:1024 lds
    v_mfma_f32_16x16x32_bf16 v[100:103], a[212:215], v[36:39], v[100:103]
    v_exp_f32 v113, v113
    v_mfma_f32_16x16x32_bf16 v[100:103], a[208:211], v[32:35], v[100:103]
    s_waitcnt lgkmcnt(0)
    v_cvt_pk_bf16_f32 v188, v152, v153
    v_cvt_pk_bf16_f32 v189, v154, v155
    v_mfma_f32_16x16x32_bf16 v[128:131], a[192:195], v[32:35], v[192:195]
    v_exp_f32 v114, v114
    v_mfma_f32_16x16x32_bf16 v[128:131], a[196:199], v[36:39], v[128:131]
    ds_read_b128 a[208:211], v10 offset:12288
    v_mfma_f32_16x16x32_bf16 v[128:131], a[200:203], v[40:43], v[128:131]
    v_exp_f32 v115, v115
    v_mfma_f32_16x16x32_bf16 v[128:131], a[204:207], v[44:47], v[128:131]
    ds_read_b128 a[212:215], v11 offset:12288
    v_cvt_pk_bf16_f32 v190, v156, v157
    v_mfma_f32_16x16x32_bf16 v[136:139], a[204:207], v[60:63], v[196:199]
    v_exp_f32 v120, v120
    v_mfma_f32_16x16x32_bf16 v[136:139], a[200:203], v[56:59], v[136:139]
    ds_read_b128 a[216:219], v12 offset:12288
    v_cvt_pk_bf16_f32 v191, v158, v159
    v_mfma_f32_16x16x32_bf16 v[136:139], a[196:199], v[52:55], v[136:139]
    v_exp_f32 v121, v121
    v_mfma_f32_16x16x32_bf16 v[136:139], a[192:195], v[48:51], v[136:139]
    ds_read_b128 a[220:223], v13 offset:12288
    v_cvt_pk_bf16_f32 v182, v148, v149
    v_mfma_f32_16x16x32_bf16 v[144:147], a[192:195], v[64:67], v[200:203]
    v_exp_f32 v122, v122
    v_mfma_f32_16x16x32_bf16 v[144:147], a[196:199], v[68:71], v[144:147]
    v_cvt_pk_bf16_f32 v183, v150, v151
    v_mfma_f32_16x16x32_bf16 v[144:147], a[200:203], v[72:75], v[144:147]
    v_exp_f32 v123, v123
    v_mfma_f32_16x16x32_bf16 v[144:147], a[204:207], v[76:79], v[144:147]
    v_cvt_pk_bf16_f32 v174, v140, v141
    v_cvt_pk_bf16_f32 v175, v142, v143
    v_mfma_f32_16x16x32_bf16 v[152:155], a[204:207], v[92:95], v[204:207]
    v_exp_f32 v124, v124
    v_mfma_f32_16x16x32_bf16 v[152:155], a[200:203], v[88:91], v[152:155]
    ds_read_b64_tr_b16 a[228:229], v24 offset:8192
    v_mfma_f32_16x16x32_bf16 v[152:155], a[196:199], v[84:87], v[152:155]
    v_exp_f32 v125, v125
    v_mfma_f32_16x16x32_bf16 v[152:155], a[192:195], v[80:83], v[152:155]
    s_waitcnt lgkmcnt(1)
    ds_read_b64_tr_b16 a[230:231], v24 offset:12288
    v_cvt_pk_bf16_f32 v166, v132, v133
    v_mfma_f32_16x16x32_bf16 v[156:159], a[208:211], v[80:83], v[204:207]
    v_exp_f32 v126, v126
    v_mfma_f32_16x16x32_bf16 v[156:159], a[212:215], v[84:87], v[156:159]
    ds_read_b64_tr_b16 a[224:225], v24 offset:0
    v_cvt_pk_bf16_f32 v167, v134, v135
    v_mfma_f32_16x16x32_bf16 v[156:159], a[216:219], v[88:91], v[156:159]
    v_exp_f32 v127, v127
    v_mfma_f32_16x16x32_bf16 v[156:159], a[220:223], v[92:95], v[156:159]
    ds_read_b64_tr_b16 a[226:227], v24 offset:4096
    v_mfma_f32_16x16x32_bf16 v[148:151], a[220:223], v[76:79], v[200:203]
    v_exp_f32 v116, v116
    v_mfma_f32_16x16x32_bf16 v[148:151], a[216:219], v[72:75], v[148:151]
    ds_read_b64_tr_b16 a[236:237], v25 offset:8192
    v_mfma_f32_16x16x32_bf16 v[148:151], a[212:215], v[68:71], v[148:151]
    v_exp_f32 v117, v117
    v_mfma_f32_16x16x32_bf16 v[148:151], a[208:211], v[64:67], v[148:151]
    ds_read_b64_tr_b16 a[238:239], v25 offset:12288
    v_mfma_f32_16x16x32_bf16 v[140:143], a[208:211], v[48:51], v[196:199]
    v_exp_f32 v118, v118
    v_mfma_f32_16x16x32_bf16 v[140:143], a[212:215], v[52:55], v[140:143]
    ds_read_b64_tr_b16 a[232:233], v25 offset:0
    v_mfma_f32_16x16x32_bf16 v[140:143], a[216:219], v[56:59], v[140:143]
    v_exp_f32 v119, v119
    v_mfma_f32_16x16x32_bf16 v[140:143], a[220:223], v[60:63], v[140:143]
    ds_read_b64_tr_b16 a[234:235], v25 offset:4096
    v_mfma_f32_16x16x32_bf16 v[132:135], a[220:223], v[44:47], v[192:195]
    v_exp_f32 v108, v108
    v_mfma_f32_16x16x32_bf16 v[132:135], a[216:219], v[40:43], v[132:135]
    ds_read_b64_tr_b16 a[244:245], v26 offset:8192
    v_mfma_f32_16x16x32_bf16 v[132:135], a[212:215], v[36:39], v[132:135]
    v_exp_f32 v109, v109
    v_mfma_f32_16x16x32_bf16 v[132:135], a[208:211], v[32:35], v[132:135]
    ds_read_b64_tr_b16 a[246:247], v26 offset:12288
    v_smfmac_f32_16x16x64_bf16 a[128:131], a[144:147], v[160:167], v23
    ds_read_b64_tr_b16 a[240:241], v26 offset:0
    v_smfmac_f32_16x16x64_bf16 a[132:135], a[144:147], v[168:175], v23
    buffer_load_dwordx4 v3, s[8:11], s45 offen offset:2048 lds
    v_smfmac_f32_16x16x64_bf16 a[136:139], a[144:147], v[176:183], v23
    ds_read_b64_tr_b16 a[242:243], v26 offset:4096
    v_smfmac_f32_16x16x64_bf16 a[140:143], a[144:147], v[184:191], v23
    s_waitcnt lgkmcnt(8)
    v_mfma_f32_16x16x32_bf16 a[12:15], a[228:231], v[188:191], a[12:15]
    ds_read_b64_tr_b16 a[252:253], v27 offset:8192
    ds_read_b64_tr_b16 a[254:255], v27 offset:12288
    v_mfma_f32_16x16x32_bf16 a[12:15], a[224:227], v[184:187], a[12:15]
    v_exp_f32 v110, v110
    v_mfma_f32_16x16x32_bf16 a[8:11], a[224:227], v[176:179], a[8:11]
    buffer_load_dwordx4 v4, s[8:11], s45 offen offset:3072 lds
    v_mfma_f32_16x16x32_bf16 a[8:11], a[228:231], v[180:183], a[8:11]
    s_add_u32 s45, s45, 16384
    v_exp_f32 v111, v111
    v_mfma_f32_16x16x32_bf16 a[4:7], a[228:231], v[172:175], a[4:7]
    ds_read_b64_tr_b16 a[248:249], v27 offset:0
    ds_read_b64_tr_b16 a[250:251], v27 offset:4096
    v_mfma_f32_16x16x32_bf16 a[4:7], a[224:227], v[168:171], a[4:7]
    v_exp_f32 v100, v100
    v_mfma_f32_16x16x32_bf16 a[0:3], a[224:227], v[160:163], a[0:3]
    v_mfma_f32_16x16x32_bf16 a[0:3], a[228:231], v[164:167], a[0:3]
    s_waitcnt lgkmcnt(8)
    v_exp_f32 v101, v101
    v_mfma_f32_16x16x32_bf16 a[16:19], a[236:239], v[164:167], a[16:19]
    ds_read_b64_tr_b16 a[228:229], v28 offset:8192
    ds_read_b64_tr_b16 a[230:231], v28 offset:12288
    v_mfma_f32_16x16x32_bf16 a[16:19], a[232:235], v[160:163], a[16:19]
    s_add_u32 m0, s39, 114688
    v_exp_f32 v102, v102
    v_mfma_f32_16x16x32_bf16 a[20:23], a[232:235], v[168:171], a[20:23]
    buffer_load_dwordx4 v5, s[12:15], s46 offen offset:0 lds
    v_mfma_f32_16x16x32_bf16 a[20:23], a[236:239], v[172:175], a[20:23]
    v_exp_f32 v103, v103
    v_mfma_f32_16x16x32_bf16 a[24:27], a[236:239], v[180:183], a[24:27]
    ds_read_b64_tr_b16 a[224:225], v28 offset:0
    ds_read_b64_tr_b16 a[226:227], v28 offset:4096
    v_mfma_f32_16x16x32_bf16 a[24:27], a[232:235], v[176:179], a[24:27]
    v_exp_f32 v128, v128
    v_mfma_f32_16x16x32_bf16 a[28:31], a[232:235], v[184:187], a[28:31]
    v_mfma_f32_16x16x32_bf16 a[28:31], a[236:239], v[188:191], a[28:31]
    s_waitcnt lgkmcnt(8)
    v_exp_f32 v129, v129
    v_mfma_f32_16x16x32_bf16 a[44:47], a[244:247], v[188:191], a[44:47]
    ds_read_b64_tr_b16 a[236:237], v29 offset:8192
    ds_read_b64_tr_b16 a[238:239], v29 offset:12288
    v_mfma_f32_16x16x32_bf16 a[44:47], a[240:243], v[184:187], a[44:47]
    v_exp_f32 v130, v130
    v_mfma_f32_16x16x32_bf16 a[40:43], a[240:243], v[176:179], a[40:43]
    v_mfma_f32_16x16x32_bf16 a[40:43], a[244:247], v[180:183], a[40:43]
    v_exp_f32 v131, v131
    v_mfma_f32_16x16x32_bf16 a[36:39], a[244:247], v[172:175], a[36:39]
    ds_read_b64_tr_b16 a[232:233], v29 offset:0
    ds_read_b64_tr_b16 a[234:235], v29 offset:4096
    v_mfma_f32_16x16x32_bf16 a[36:39], a[240:243], v[168:171], a[36:39]
    v_exp_f32 v136, v136
    v_mfma_f32_16x16x32_bf16 a[32:35], a[240:243], v[160:163], a[32:35]
    buffer_load_dwordx4 v6, s[12:15], s46 offen offset:1024 lds
    v_mfma_f32_16x16x32_bf16 a[32:35], a[244:247], v[164:167], a[32:35]
    s_waitcnt lgkmcnt(8)
    v_exp_f32 v137, v137
    v_mfma_f32_16x16x32_bf16 a[48:51], a[252:255], v[164:167], a[48:51]
    ds_read_b64_tr_b16 a[244:245], v30 offset:8192
    ds_read_b64_tr_b16 a[246:247], v30 offset:12288
    v_mfma_f32_16x16x32_bf16 a[48:51], a[248:251], v[160:163], a[48:51]
    v_exp_f32 v138, v138
    v_mfma_f32_16x16x32_bf16 a[52:55], a[248:251], v[168:171], a[52:55]
    v_mfma_f32_16x16x32_bf16 a[52:55], a[252:255], v[172:175], a[52:55]
    v_exp_f32 v139, v139
    v_mfma_f32_16x16x32_bf16 a[56:59], a[252:255], v[180:183], a[56:59]
    ds_read_b64_tr_b16 a[240:241], v30 offset:0
    ds_read_b64_tr_b16 a[242:243], v30 offset:4096
    v_mfma_f32_16x16x32_bf16 a[56:59], a[248:251], v[176:179], a[56:59]
    v_exp_f32 v144, v144
    v_mfma_f32_16x16x32_bf16 a[60:63], a[248:251], v[184:187], a[60:63]
    v_mfma_f32_16x16x32_bf16 a[60:63], a[252:255], v[188:191], a[60:63]
    s_waitcnt lgkmcnt(8)
    v_exp_f32 v145, v145
    v_mfma_f32_16x16x32_bf16 a[76:79], a[228:231], v[188:191], a[76:79]
    ds_read_b64_tr_b16 a[252:253], v31 offset:8192
    ds_read_b64_tr_b16 a[254:255], v31 offset:12288
    v_mfma_f32_16x16x32_bf16 a[76:79], a[224:227], v[184:187], a[76:79]
    v_exp_f32 v146, v146
    v_mfma_f32_16x16x32_bf16 a[72:75], a[224:227], v[176:179], a[72:75]
    buffer_load_dwordx4 v5, s[12:15], s46 offen offset:2048 lds
    v_mfma_f32_16x16x32_bf16 a[72:75], a[228:231], v[180:183], a[72:75]
    v_exp_f32 v147, v147
    v_mfma_f32_16x16x32_bf16 a[68:71], a[228:231], v[172:175], a[68:71]
    ds_read_b64_tr_b16 a[248:249], v31 offset:0
    ds_read_b64_tr_b16 a[250:251], v31 offset:4096
    v_mfma_f32_16x16x32_bf16 a[68:71], a[224:227], v[168:171], a[68:71]
    v_exp_f32 v152, v152
    v_mfma_f32_16x16x32_bf16 a[64:67], a[224:227], v[160:163], a[64:67]
    v_mfma_f32_16x16x32_bf16 a[64:67], a[228:231], v[164:167], a[64:67]
    s_waitcnt lgkmcnt(8)
    v_exp_f32 v153, v153
    v_mfma_f32_16x16x32_bf16 a[80:83], a[236:239], v[164:167], a[80:83]
    v_mfma_f32_16x16x32_bf16 a[80:83], a[232:235], v[160:163], a[80:83]
    v_exp_f32 v154, v154
    v_mfma_f32_16x16x32_bf16 a[84:87], a[232:235], v[168:171], a[84:87]
    buffer_load_dwordx4 v6, s[12:15], s46 offen offset:3072 lds
    v_mfma_f32_16x16x32_bf16 a[84:87], a[236:239], v[172:175], a[84:87]
    s_add_u32 s46, s46, 16384
    v_exp_f32 v155, v155
    v_mfma_f32_16x16x32_bf16 a[88:91], a[236:239], v[180:183], a[88:91]
    v_mfma_f32_16x16x32_bf16 a[88:91], a[232:235], v[176:179], a[88:91]
    s_waitcnt vmcnt(16) lgkmcnt(0)
    v_exp_f32 v156, v156
    v_mfma_f32_16x16x32_bf16 a[92:95], a[232:235], v[184:187], a[92:95]
    s_barrier
    v_mfma_f32_16x16x32_bf16 a[92:95], a[236:239], v[188:191], a[92:95]
    v_exp_f32 v157, v157
    v_mfma_f32_16x16x32_bf16 a[108:111], a[244:247], v[188:191], a[108:111]
    ds_read_b128 a[192:195], v10 offset:16384
    v_mfma_f32_16x16x32_bf16 a[108:111], a[240:243], v[184:187], a[108:111]
    v_exp_f32 v158, v158
    v_mfma_f32_16x16x32_bf16 a[104:107], a[240:243], v[176:179], a[104:107]
    ds_read_b128 a[196:199], v11 offset:16384
    v_mfma_f32_16x16x32_bf16 a[104:107], a[244:247], v[180:183], a[104:107]
    v_exp_f32 v159, v159
    v_mfma_f32_16x16x32_bf16 a[100:103], a[244:247], v[172:175], a[100:103]
    ds_read_b128 a[200:203], v12 offset:16384
    v_mfma_f32_16x16x32_bf16 a[100:103], a[240:243], v[168:171], a[100:103]
    v_exp_f32 v148, v148
    v_mfma_f32_16x16x32_bf16 a[96:99], a[240:243], v[160:163], a[96:99]
    ds_read_b128 a[204:207], v13 offset:16384
    v_mfma_f32_16x16x32_bf16 a[96:99], a[244:247], v[164:167], a[96:99]
    v_exp_f32 v149, v149
    v_mfma_f32_16x16x32_bf16 a[112:115], a[252:255], v[164:167], a[112:115]
    buffer_load_dword a191, v20, s[20:23], s53 offen
    v_mfma_f32_16x16x32_bf16 a[112:115], a[248:251], v[160:163], a[112:115]
    v_exp_f32 v150, v150
    v_mfma_f32_16x16x32_bf16 a[116:119], a[248:251], v[168:171], a[116:119]
    v_cvt_pk_bf16_f32 v160, v96, v97
    v_cvt_pk_bf16_f32 v161, v98, v99
    v_mfma_f32_16x16x32_bf16 a[116:119], a[252:255], v[172:175], a[116:119]
    v_exp_f32 v151, v151
    v_mfma_f32_16x16x32_bf16 a[120:123], a[252:255], v[180:183], a[120:123]
    s_bitcmp1_b32 112, s47
    v_cvt_pk_bf16_f32 v168, v104, v105
    v_cvt_pk_bf16_f32 v169, v106, v107
    v_mfma_f32_16x16x32_bf16 a[120:123], a[248:251], v[176:179], a[120:123]
    v_exp_f32 v140, v140
    v_mfma_f32_16x16x32_bf16 a[124:127], a[248:251], v[184:187], a[124:127]
    v_cvt_pk_bf16_f32 v176, v112, v113
    v_cvt_pk_bf16_f32 v177, v114, v115
    v_mfma_f32_16x16x32_bf16 a[124:127], a[252:255], v[188:191], a[124:127]
    s_waitcnt lgkmcnt(0)
    v_exp_f32 v141, v141
    s_cbranch_scc0 L_loop
    s_cmp_eq_u32 s47, 5
    s_cbranch_scc1 L_lb3
    s_cmp_eq_u32 s47, 6
    s_cbranch_scc1 L_lb4
    v_lshlrev_b32 v7, 2, v0
    s_mov_b64 exec, 3
    buffer_store_dword v22, v7, s[28:31], s88 offen sc1
    s_mov_b64 exec, -1
    s_mov_b64 exec, 1
    buffer_load_dword a191, v7, s[28:31], s89 offen sc1
    buffer_load_dword a191, v7, s[28:31], s90 offen sc1
    s_mov_b64 exec, -1
    s_branch L_loop
L_lb3:
    buffer_load_dword v8, v7, s[28:31], s91 offen sc1
    s_mov_b32 s51, s6
    s_cmp_lt_u32 s36, 2
    s_cselect_b32 s53, s7, s53
    s_branch L_loop
L_lb4:
    v_cmp_ne_u32 vcc, v22, v8
    s_brev_b32 s51, 1
    s_cmp_lt_u32 s36, 2
    s_cselect_b32 s53, s51, s7
    s_cbranch_vccz L_hok
    s_mov_b32 s49, 262144
L_ph:
    buffer_load_dword v8, v7, s[28:31], s91 offen sc1
    s_sub_u32 s49, s49, 1
    s_cbranch_scc1 L_ph_x
    s_waitcnt vmcnt(0)
    v_cmp_ne_u32 vcc, v22, v8
    s_nop 1
    s_cbranch_vccnz L_ph
L_ph_x:
L_hok:
    s_mul_i32 s52, s42, 393216
    s_add_u32 s52, s52, s44
    s_cmp_lg_u32 s42, s36
    s_cbranch_scc1 L_loop
    s_getpc_b64 s[84:85]
L_pc:
    s_lshl_b32 s49, s36, 13
    v_add_u32 v208, s49, v20
    v_min_u32 v208, L_end-L_pc, v208
    v_add_co_u32 v208, vcc, s84, v208
    v_mov_b32 v209, s85
    s_nop 0
    v_addc_co_u32 v209, vcc, 0, v209, vcc
    global_load_dword a191, v[208:209], off
    s_branch L_loop
L_last:
    s_getpc_b64 s[84:85]
L_pc3:
    s_lshr_b32 s49, s2, 3
    s_lshl_b32 s49, s49, 2
    s_add_u32 s49, s49, s36
    s_lshl_b32 s49, s49, 8
    v_and_b32 v208, 1, v0
    v_lshl_add_u32 v208, v208, 7, s49
    v_min_u32 v208, L_end-L_pc3, v208
    v_add_co_u32 v208, vcc, s84, v208
    v_mov_b32 v209, s85
    s_nop 0
    v_addc_co_u32 v209, vcc, 0, v209, vcc
    global_load_dword a191, v[208:209], off
    v_mfma_f32_16x16x32_bf16 v[96:99], a[192:195], v[32:35], v[192:195]
    s_mov_b32 s12, s56
    v_exp_f32 v142, v142
    v_mfma_f32_16x16x32_bf16 v[96:99], a[196:199], v[36:39], v[96:99]
    s_mov_b32 s13, s57
    ds_read_b128 a[208:211], v10 offset:36864
    v_cvt_pk_bf16_f32 v184, v120, v121
    v_mfma_f32_16x16x32_bf16 v[96:99], a[200:203], v[40:43], v[96:99]
    s_mov_b32 s14, 2097152
    v_exp_f32 v143, v143
    v_mfma_f32_16x16x32_bf16 v[96:99], a[204:207], v[44:47], v[96:99]
    s_lshl_b32 s45, s40, 20
    ds_read_b128 a[212:215], v11 offset:36864
    v_cvt_pk_bf16_f32 v185, v122, v123
    v_mfma_f32_16x16x32_bf16 v[104:107], a[204:207], v[60:63], v[196:199]
    s_lshl_b32 s46, s40, 20
    v_exp_f32 v132, v132
    v_mfma_f32_16x16x32_bf16 v[104:107], a[200:203], v[56:59], v[104:107]
    ds_read_b128 a[216:219], v12 offset:36864
    v_cvt_pk_bf16_f32 v186, v124, v125
    v_mfma_f32_16x16x32_bf16 v[104:107], a[196:199], v[52:55], v[104:107]
    v_exp_f32 v133, v133
    v_mfma_f32_16x16x32_bf16 v[104:107], a[192:195], v[48:51], v[104:107]
    ds_read_b128 a[220:223], v13 offset:36864
    v_cvt_pk_bf16_f32 v187, v126, v127
    v_mfma_f32_16x16x32_bf16 v[112:115], a[192:195], v[64:67], v[200:203]
    v_exp_f32 v134, v134
    v_mfma_f32_16x16x32_bf16 v[112:115], a[196:199], v[68:71], v[112:115]
    v_cvt_pk_bf16_f32 v178, v116, v117
    v_cvt_pk_bf16_f32 v179, v118, v119
    v_mfma_f32_16x16x32_bf16 v[112:115], a[200:203], v[72:75], v[112:115]
    v_exp_f32 v135, v135
    v_mfma_f32_16x16x32_bf16 v[112:115], a[204:207], v[76:79], v[112:115]
    v_cvt_pk_bf16_f32 v170, v108, v109
    v_cvt_pk_bf16_f32 v171, v110, v111
    v_mfma_f32_16x16x32_bf16 v[120:123], a[204:207], v[92:95], v[204:207]
    v_exp_f32 v96, v96
    v_mfma_f32_16x16x32_bf16 v[120:123], a[200:203], v[88:91], v[120:123]
    buffer_load_dwordx4 v[208:211], v9, s[24:27], s44 offen sc1
    v_mfma_f32_16x16x32_bf16 v[120:123], a[196:199], v[84:87], v[120:123]
    s_add_u32 s44, s44, 65536
    v_exp_f32 v97, v97
    v_mfma_f32_16x16x32_bf16 v[120:123], a[192:195], v[80:83], v[120:123]
    s_waitcnt lgkmcnt(0)
    v_cvt_pk_bf16_f32 v162, v100, v101
    v_cvt_pk_bf16_f32 v163, v102, v103
    v_mfma_f32_16x16x32_bf16 v[124:127], a[208:211], v[80:83], v[204:207]
    v_exp_f32 v98, v98
    v_mfma_f32_16x16x32_bf16 v[124:127], a[212:215], v[84:87], v[124:127]
    ds_read_b128 a[192:195], v10 offset:40960
    buffer_load_dwordx4 v[212:215], v9, s[24:27], s44 offen sc1
    v_mfma_f32_16x16x32_bf16 v[124:127], a[216:219], v[88:91], v[124:127]
    s_add_u32 s44, s44, 65536
    v_exp_f32 v99, v99
    v_mfma_f32_16x16x32_bf16 v[124:127], a[220:223], v[92:95], v[124:127]
    ds_read_b128 a[196:199], v11 offset:40960
    v_cvt_pk_bf16_f32 v164, v128, v129
    v_mfma_f32_16x16x32_bf16 v[116:119], a[220:223], v[76:79], v[200:203]
    v_exp_f32 v104, v104
    v_mfma_f32_16x16x32_bf16 v[116:119], a[216:219], v[72:75], v[116:119]
    ds_read_b128 a[200:203], v12 offset:40960
    v_cvt_pk_bf16_f32 v165, v130, v131
    v_mfma_f32_16x16x32_bf16 v[116:119], a[212:215], v[68:71], v[116:119]
    v_exp_f32 v105, v105
    v_mfma_f32_16x16x32_bf16 v[116:119], a[208:211], v[64:67], v[116:119]
    ds_read_b128 a[204:207], v13 offset:40960
    v_cvt_pk_bf16_f32 v172, v136, v137
    v_mfma_f32_16x16x32_bf16 v[108:111], a[208:211], v[48:51], v[196:199]
    v_exp_f32 v106, v106
    v_mfma_f32_16x16x32_bf16 v[108:111], a[212:215], v[52:55], v[108:111]
    buffer_load_dwordx4 v[216:219], v9, s[24:27], s44 offen sc1
    v_cvt_pk_bf16_f32 v173, v138, v139
    v_mfma_f32_16x16x32_bf16 v[108:111], a[216:219], v[56:59], v[108:111]
    s_add_u32 s44, s44, 65536
    v_exp_f32 v107, v107
    v_mfma_f32_16x16x32_bf16 v[108:111], a[220:223], v[60:63], v[108:111]
    v_cvt_pk_bf16_f32 v180, v144, v145
    v_cvt_pk_bf16_f32 v181, v146, v147
    v_mfma_f32_16x16x32_bf16 v[100:103], a[220:223], v[44:47], v[192:195]
    v_exp_f32 v112, v112
    v_mfma_f32_16x16x32_bf16 v[100:103], a[216:219], v[40:43], v[100:103]
    buffer_load_dwordx4 v[220:223], v9, s[24:27], s44 offen sc1
    v_mfma_f32_16x16x32_bf16 v[100:103], a[212:215], v[36:39], v[100:103]
    s_add_u32 s44, s44, 65536
    v_exp_f32 v113, v113
    v_mfma_f32_16x16x32_bf16 v[100:103], a[208:211], v[32:35], v[100:103]
    s_waitcnt lgkmcnt(0)
    v_cvt_pk_bf16_f32 v188, v152, v153
    v_cvt_pk_bf16_f32 v189, v154, v155
    v_mfma_f32_16x16x32_bf16 v[128:131], a[192:195], v[32:35], v[192:195]
    v_exp_f32 v114, v114
    v_mfma_f32_16x16x32_bf16 v[128:131], a[196:199], v[36:39], v[128:131]
    ds_read_b128 a[208:211], v10 offset:45056
    buffer_load_dwordx4 v[224:227], v9, s[24:27], s44 offen sc1
    v_mfma_f32_16x16x32_bf16 v[128:131], a[200:203], v[40:43], v[128:131]
    s_add_u32 s44, s44, 65536
    v_exp_f32 v115, v115
    v_mfma_f32_16x16x32_bf16 v[128:131], a[204:207], v[44:47], v[128:131]
    ds_read_b128 a[212:215], v11 offset:45056
    v_cvt_pk_bf16_f32 v190, v156, v157
    v_mfma_f32_16x16x32_bf16 v[136:139], a[204:207], v[60:63], v[196:199]
    v_exp_f32 v120, v120
    v_mfma_f32_16x16x32_bf16 v[136:139], a[200:203], v[56:59], v[136:139]
    ds_read_b128 a[216:219], v12 offset:45056
    v_cvt_pk_bf16_f32 v191, v158, v159
    v_mfma_f32_16x16x32_bf16 v[136:139], a[196:199], v[52:55], v[136:139]
    v_exp_f32 v121, v121
    v_mfma_f32_16x16x32_bf16 v[136:139], a[192:195], v[48:51], v[136:139]
    ds_read_b128 a[220:223], v13 offset:45056
    v_cvt_pk_bf16_f32 v182, v148, v149
    v_mfma_f32_16x16x32_bf16 v[144:147], a[192:195], v[64:67], v[200:203]
    v_exp_f32 v122, v122
    v_mfma_f32_16x16x32_bf16 v[144:147], a[196:199], v[68:71], v[144:147]
    buffer_load_dwordx4 v[228:231], v9, s[24:27], s44 offen sc1
    v_cvt_pk_bf16_f32 v183, v150, v151
    v_mfma_f32_16x16x32_bf16 v[144:147], a[200:203], v[72:75], v[144:147]
    s_add_u32 s44, s44, 65536
    v_exp_f32 v123, v123
    v_mfma_f32_16x16x32_bf16 v[144:147], a[204:207], v[76:79], v[144:147]
    v_cvt_pk_bf16_f32 v174, v140, v141
    v_cvt_pk_bf16_f32 v175, v142, v143
    v_mfma_f32_16x16x32_bf16 v[152:155], a[204:207], v[92:95], v[204:207]
    v_exp_f32 v124, v124
    v_mfma_f32_16x16x32_bf16 v[152:155], a[200:203], v[88:91], v[152:155]
    ds_read_b64_tr_b16 a[228:229], v24 offset:40960
    buffer_load_dwordx4 v[232:235], v9, s[24:27], s44 offen sc1
    v_mfma_f32_16x16x32_bf16 v[152:155], a[196:199], v[84:87], v[152:155]
    s_add_u32 s44, s44, 65536
    v_exp_f32 v125, v125
    v_mfma_f32_16x16x32_bf16 v[152:155], a[192:195], v[80:83], v[152:155]
    s_waitcnt lgkmcnt(1)
    ds_read_b64_tr_b16 a[230:231], v24 offset:45056
    v_cvt_pk_bf16_f32 v166, v132, v133
    v_mfma_f32_16x16x32_bf16 v[156:159], a[208:211], v[80:83], v[204:207]
    v_exp_f32 v126, v126
    v_mfma_f32_16x16x32_bf16 v[156:159], a[212:215], v[84:87], v[156:159]
    ds_read_b64_tr_b16 a[224:225], v24 offset:32768
    v_cvt_pk_bf16_f32 v167, v134, v135
    v_mfma_f32_16x16x32_bf16 v[156:159], a[216:219], v[88:91], v[156:159]
    v_exp_f32 v127, v127
    v_mfma_f32_16x16x32_bf16 v[156:159], a[220:223], v[92:95], v[156:159]
    ds_read_b64_tr_b16 a[226:227], v24 offset:36864
    buffer_load_dwordx4 v[236:239], v9, s[24:27], s44 offen sc1
    v_mfma_f32_16x16x32_bf16 v[148:151], a[220:223], v[76:79], v[200:203]
    s_add_u32 s44, s44, 65536
    v_exp_f32 v116, v116
    v_mfma_f32_16x16x32_bf16 v[148:151], a[216:219], v[72:75], v[148:151]
    ds_read_b64_tr_b16 a[236:237], v25 offset:40960
    v_mfma_f32_16x16x32_bf16 v[148:151], a[212:215], v[68:71], v[148:151]
    v_exp_f32 v117, v117
    v_mfma_f32_16x16x32_bf16 v[148:151], a[208:211], v[64:67], v[148:151]
    ds_read_b64_tr_b16 a[238:239], v25 offset:45056
    buffer_load_dwordx4 v[240:243], v9, s[24:27], s44 offen sc1
    v_mfma_f32_16x16x32_bf16 v[140:143], a[208:211], v[48:51], v[196:199]
    s_add_u32 s44, s44, 65536
    v_exp_f32 v118, v118
    v_mfma_f32_16x16x32_bf16 v[140:143], a[212:215], v[52:55], v[140:143]
    ds_read_b64_tr_b16 a[232:233], v25 offset:32768
    v_mfma_f32_16x16x32_bf16 v[140:143], a[216:219], v[56:59], v[140:143]
    v_exp_f32 v119, v119
    v_mfma_f32_16x16x32_bf16 v[140:143], a[220:223], v[60:63], v[140:143]
    ds_read_b64_tr_b16 a[234:235], v25 offset:36864
    buffer_load_dwordx4 v[244:247], v9, s[24:27], s44 offen sc1
    v_mfma_f32_16x16x32_bf16 v[132:135], a[220:223], v[44:47], v[192:195]
    s_add_u32 s44, s44, 65536
    v_exp_f32 v108, v108
    v_mfma_f32_16x16x32_bf16 v[132:135], a[216:219], v[40:43], v[132:135]
    ds_read_b64_tr_b16 a[244:245], v26 offset:40960
    v_mfma_f32_16x16x32_bf16 v[132:135], a[212:215], v[36:39], v[132:135]
    v_exp_f32 v109, v109
    v_mfma_f32_16x16x32_bf16 v[132:135], a[208:211], v[32:35], v[132:135]
    ds_read_b64_tr_b16 a[246:247], v26 offset:45056
    buffer_load_dwordx4 v[248:251], v9, s[24:27], s44 offen sc1
    v_smfmac_f32_16x16x64_bf16 a[128:131], a[144:147], v[160:167], v23
    s_add_u32 s44, s44, 65536
    ds_read_b64_tr_b16 a[240:241], v26 offset:32768
    v_smfmac_f32_16x16x64_bf16 a[132:135], a[144:147], v[168:175], v23
    v_smfmac_f32_16x16x64_bf16 a[136:139], a[144:147], v[176:183], v23
    ds_read_b64_tr_b16 a[242:243], v26 offset:36864
    v_smfmac_f32_16x16x64_bf16 a[140:143], a[144:147], v[184:191], v23
    s_waitcnt lgkmcnt(8)
    buffer_load_dwordx4 v[252:255], v9, s[24:27], s44 offen sc1
    v_mfma_f32_16x16x32_bf16 a[12:15], a[228:231], v[188:191], a[12:15]
    s_add_u32 s44, s44, 65536
    ds_read_b64_tr_b16 a[252:253], v27 offset:40960
    ds_read_b64_tr_b16 a[254:255], v27 offset:45056
    v_mfma_f32_16x16x32_bf16 a[12:15], a[224:227], v[184:187], a[12:15]
    s_add_u32 m0, s39, 16384
    v_exp_f32 v110, v110
    v_mfma_f32_16x16x32_bf16 a[8:11], a[224:227], v[176:179], a[8:11]
    buffer_load_dwordx4 v14, s[16:19], s43 offen offset:0 lds
    v_mfma_f32_16x16x32_bf16 a[8:11], a[228:231], v[180:183], a[8:11]
    v_exp_f32 v111, v111
    v_mfma_f32_16x16x32_bf16 a[4:7], a[228:231], v[172:175], a[4:7]
    ds_read_b64_tr_b16 a[248:249], v27 offset:32768
    ds_read_b64_tr_b16 a[250:251], v27 offset:36864
    v_mfma_f32_16x16x32_bf16 a[4:7], a[224:227], v[168:171], a[4:7]
    v_exp_f32 v100, v100
    v_mfma_f32_16x16x32_bf16 a[0:3], a[224:227], v[160:163], a[0:3]
    buffer_load_dwordx4 v15, s[16:19], s43 offen offset:1024 lds
    v_mfma_f32_16x16x32_bf16 a[0:3], a[228:231], v[164:167], a[0:3]
    s_waitcnt lgkmcnt(8)
    v_exp_f32 v101, v101
    v_mfma_f32_16x16x32_bf16 a[16:19], a[236:239], v[164:167], a[16:19]
    ds_read_b64_tr_b16 a[228:229], v28 offset:40960
    ds_read_b64_tr_b16 a[230:231], v28 offset:45056
    v_mfma_f32_16x16x32_bf16 a[16:19], a[232:235], v[160:163], a[16:19]
    v_exp_f32 v102, v102
    v_mfma_f32_16x16x32_bf16 a[20:23], a[232:235], v[168:171], a[20:23]
    buffer_load_dwordx4 v16, s[16:19], s43 offen offset:2048 lds
    v_mfma_f32_16x16x32_bf16 a[20:23], a[236:239], v[172:175], a[20:23]
    v_exp_f32 v103, v103
    v_mfma_f32_16x16x32_bf16 a[24:27], a[236:239], v[180:183], a[24:27]
    ds_read_b64_tr_b16 a[224:225], v28 offset:32768
    ds_read_b64_tr_b16 a[226:227], v28 offset:36864
    v_mfma_f32_16x16x32_bf16 a[24:27], a[232:235], v[176:179], a[24:27]
    v_exp_f32 v128, v128
    v_mfma_f32_16x16x32_bf16 a[28:31], a[232:235], v[184:187], a[28:31]
    buffer_load_dwordx4 v17, s[16:19], s43 offen offset:3072 lds
    v_mfma_f32_16x16x32_bf16 a[28:31], a[236:239], v[188:191], a[28:31]
    s_waitcnt lgkmcnt(8)
    v_exp_f32 v129, v129
    v_mfma_f32_16x16x32_bf16 a[44:47], a[244:247], v[188:191], a[44:47]
    s_add_u32 s43, s43, 65536
    ds_read_b64_tr_b16 a[236:237], v29 offset:40960
    ds_read_b64_tr_b16 a[238:239], v29 offset:45056
    v_mfma_f32_16x16x32_bf16 a[44:47], a[240:243], v[184:187], a[44:47]
    s_add_u32 m0, s39, 81920
    v_exp_f32 v130, v130
    v_mfma_f32_16x16x32_bf16 a[40:43], a[240:243], v[176:179], a[40:43]
    buffer_load_dwordx4 v14, s[16:19], s43 offen offset:0 lds
    v_mfma_f32_16x16x32_bf16 a[40:43], a[244:247], v[180:183], a[40:43]
    v_exp_f32 v131, v131
    v_mfma_f32_16x16x32_bf16 a[36:39], a[244:247], v[172:175], a[36:39]
    ds_read_b64_tr_b16 a[232:233], v29 offset:32768
    ds_read_b64_tr_b16 a[234:235], v29 offset:36864
    v_mfma_f32_16x16x32_bf16 a[36:39], a[240:243], v[168:171], a[36:39]
    v_exp_f32 v136, v136
    v_mfma_f32_16x16x32_bf16 a[32:35], a[240:243], v[160:163], a[32:35]
    buffer_load_dwordx4 v15, s[16:19], s43 offen offset:1024 lds
    v_mfma_f32_16x16x32_bf16 a[32:35], a[244:247], v[164:167], a[32:35]
    s_waitcnt lgkmcnt(8)
    v_exp_f32 v137, v137
    v_mfma_f32_16x16x32_bf16 a[48:51], a[252:255], v[164:167], a[48:51]
    ds_read_b64_tr_b16 a[244:245], v30 offset:40960
    ds_read_b64_tr_b16 a[246:247], v30 offset:45056
    v_mfma_f32_16x16x32_bf16 a[48:51], a[248:251], v[160:163], a[48:51]
    v_exp_f32 v138, v138
    v_mfma_f32_16x16x32_bf16 a[52:55], a[248:251], v[168:171], a[52:55]
    buffer_load_dwordx4 v16, s[16:19], s43 offen offset:2048 lds
    v_mfma_f32_16x16x32_bf16 a[52:55], a[252:255], v[172:175], a[52:55]
    v_exp_f32 v139, v139
    v_mfma_f32_16x16x32_bf16 a[56:59], a[252:255], v[180:183], a[56:59]
    ds_read_b64_tr_b16 a[240:241], v30 offset:32768
    ds_read_b64_tr_b16 a[242:243], v30 offset:36864
    v_mfma_f32_16x16x32_bf16 a[56:59], a[248:251], v[176:179], a[56:59]
    v_exp_f32 v144, v144
    v_mfma_f32_16x16x32_bf16 a[60:63], a[248:251], v[184:187], a[60:63]
    buffer_load_dwordx4 v17, s[16:19], s43 offen offset:3072 lds
    v_mfma_f32_16x16x32_bf16 a[60:63], a[252:255], v[188:191], a[60:63]
    s_waitcnt lgkmcnt(8)
    v_exp_f32 v145, v145
    v_mfma_f32_16x16x32_bf16 a[76:79], a[228:231], v[188:191], a[76:79]
    s_add_u32 s43, s43, 65536
    ds_read_b64_tr_b16 a[252:253], v31 offset:40960
    ds_read_b64_tr_b16 a[254:255], v31 offset:45056
    v_mfma_f32_16x16x32_bf16 a[76:79], a[224:227], v[184:187], a[76:79]
    v_exp_f32 v146, v146
    v_mfma_f32_16x16x32_bf16 a[72:75], a[224:227], v[176:179], a[72:75]
    buffer_load_dwordx2 a[148:149], v9, s[24:27], s44 offen offset:0 sc1
    v_mfma_f32_16x16x32_bf16 a[72:75], a[228:231], v[180:183], a[72:75]
    v_exp_f32 v147, v147
    v_mfma_f32_16x16x32_bf16 a[68:71], a[228:231], v[172:175], a[68:71]
    ds_read_b64_tr_b16 a[248:249], v31 offset:32768
    ds_read_b64_tr_b16 a[250:251], v31 offset:36864
    v_mfma_f32_16x16x32_bf16 a[68:71], a[224:227], v[168:171], a[68:71]
    v_exp_f32 v152, v152
    v_mfma_f32_16x16x32_bf16 a[64:67], a[224:227], v[160:163], a[64:67]
    buffer_load_dwordx2 a[152:153], v9, s[24:27], s44 offen offset:8 sc1
    v_mfma_f32_16x16x32_bf16 a[64:67], a[228:231], v[164:167], a[64:67]
    s_waitcnt lgkmcnt(8)
    v_exp_f32 v153, v153
    v_mfma_f32_16x16x32_bf16 a[80:83], a[236:239], v[164:167], a[80:83]
    s_add_u32 s44, s44, 65536
    buffer_load_dwordx2 a[150:151], v9, s[24:27], s44 offen offset:0 sc1
    v_mfma_f32_16x16x32_bf16 a[80:83], a[232:235], v[160:163], a[80:83]
    v_exp_f32 v154, v154
    v_mfma_f32_16x16x32_bf16 a[84:87], a[232:235], v[168:171], a[84:87]
    buffer_load_dwordx2 a[154:155], v9, s[24:27], s44 offen offset:8 sc1
    v_mfma_f32_16x16x32_bf16 a[84:87], a[236:239], v[172:175], a[84:87]
    s_add_u32 s44, s44, 65536
    v_exp_f32 v155, v155
    v_mfma_f32_16x16x32_bf16 a[88:91], a[236:239], v[180:183], a[88:91]
    buffer_load_dwordx2 a[156:157], v9, s[24:27], s44 offen offset:0 sc1
    v_mfma_f32_16x16x32_bf16 a[88:91], a[232:235], v[176:179], a[88:91]
    s_waitcnt vmcnt(34) lgkmcnt(0)
    v_exp_f32 v156, v156
    v_mfma_f32_16x16x32_bf16 a[92:95], a[232:235], v[184:187], a[92:95]
    s_barrier
    v_mfma_f32_16x16x32_bf16 a[92:95], a[236:239], v[188:191], a[92:95]
    v_exp_f32 v157, v157
    v_mfma_f32_16x16x32_bf16 a[108:111], a[244:247], v[188:191], a[108:111]
    ds_read_b128 a[192:195], v10 offset:49152
    buffer_load_dwordx2 a[160:161], v9, s[24:27], s44 offen offset:8 sc1
    v_mfma_f32_16x16x32_bf16 a[108:111], a[240:243], v[184:187], a[108:111]
    s_add_u32 s44, s44, 65536
    v_exp_f32 v158, v158
    v_mfma_f32_16x16x32_bf16 a[104:107], a[240:243], v[176:179], a[104:107]
    ds_read_b128 a[196:199], v11 offset:49152
    buffer_load_dwordx2 a[158:159], v9, s[24:27], s44 offen offset:0 sc1
    v_mfma_f32_16x16x32_bf16 a[104:107], a[244:247], v[180:183], a[104:107]
    v_exp_f32 v159, v159
    v_mfma_f32_16x16x32_bf16 a[100:103], a[244:247], v[172:175], a[100:103]
    ds_read_b128 a[200:203], v12 offset:49152
    buffer_load_dwordx2 a[162:163], v9, s[24:27], s44 offen offset:8 sc1
    v_mfma_f32_16x16x32_bf16 a[100:103], a[240:243], v[168:171], a[100:103]
    s_add_u32 s44, s44, 65536
    v_exp_f32 v148, v148
    v_mfma_f32_16x16x32_bf16 a[96:99], a[240:243], v[160:163], a[96:99]
    ds_read_b128 a[204:207], v13 offset:49152
    buffer_load_dwordx2 a[164:165], v9, s[24:27], s44 offen offset:0 sc1
    v_mfma_f32_16x16x32_bf16 a[96:99], a[244:247], v[164:167], a[96:99]
    v_exp_f32 v149, v149
    v_mfma_f32_16x16x32_bf16 a[112:115], a[252:255], v[164:167], a[112:115]
    buffer_load_dwordx2 a[168:169], v9, s[24:27], s44 offen offset:8 sc1
    v_mfma_f32_16x16x32_bf16 a[112:115], a[248:251], v[160:163], a[112:115]
    s_add_u32 s44, s44, 65536
    v_exp_f32 v150, v150
    v_mfma_f32_16x16x32_bf16 a[116:119], a[248:251], v[168:171], a[116:119]
    v_cvt_pk_bf16_f32 v160, v96, v97
    v_cvt_pk_bf16_f32 v161, v98, v99
    v_mfma_f32_16x16x32_bf16 a[116:119], a[252:255], v[172:175], a[116:119]
    v_exp_f32 v151, v151
    v_mfma_f32_16x16x32_bf16 a[120:123], a[252:255], v[180:183], a[120:123]
    v_cvt_pk_bf16_f32 v168, v104, v105
    v_cvt_pk_bf16_f32 v169, v106, v107
    v_mfma_f32_16x16x32_bf16 a[120:123], a[248:251], v[176:179], a[120:123]
    v_exp_f32 v140, v140
    v_mfma_f32_16x16x32_bf16 a[124:127], a[248:251], v[184:187], a[124:127]
    v_cvt_pk_bf16_f32 v176, v112, v113
    v_cvt_pk_bf16_f32 v177, v114, v115
    v_mfma_f32_16x16x32_bf16 a[124:127], a[252:255], v[188:191], a[124:127]
    s_waitcnt lgkmcnt(0)
    v_exp_f32 v141, v141
    v_mfma_f32_16x16x32_bf16 v[96:99], a[192:195], v[32:35], v[192:195]
    v_exp_f32 v142, v142
    v_mfma_f32_16x16x32_bf16 v[96:99], a[196:199], v[36:39], v[96:99]
    ds_read_b128 a[208:211], v10 offset:53248
    v_cvt_pk_bf16_f32 v184, v120, v121
    v_mfma_f32_16x16x32_bf16 v[96:99], a[200:203], v[40:43], v[96:99]
    v_exp_f32 v143, v143
    v_mfma_f32_16x16x32_bf16 v[96:99], a[204:207], v[44:47], v[96:99]
    ds_read_b128 a[212:215], v11 offset:53248
    v_cvt_pk_bf16_f32 v185, v122, v123
    v_mfma_f32_16x16x32_bf16 v[104:107], a[204:207], v[60:63], v[196:199]
    v_exp_f32 v132, v132
    v_mfma_f32_16x16x32_bf16 v[104:107], a[200:203], v[56:59], v[104:107]
    ds_read_b128 a[216:219], v12 offset:53248
    v_cvt_pk_bf16_f32 v186, v124, v125
    v_mfma_f32_16x16x32_bf16 v[104:107], a[196:199], v[52:55], v[104:107]
    v_exp_f32 v133, v133
    v_mfma_f32_16x16x32_bf16 v[104:107], a[192:195], v[48:51], v[104:107]
    ds_read_b128 a[220:223], v13 offset:53248
    v_cvt_pk_bf16_f32 v187, v126, v127
    v_mfma_f32_16x16x32_bf16 v[112:115], a[192:195], v[64:67], v[200:203]
    v_exp_f32 v134, v134
    v_mfma_f32_16x16x32_bf16 v[112:115], a[196:199], v[68:71], v[112:115]
    v_cvt_pk_bf16_f32 v178, v116, v117
    v_cvt_pk_bf16_f32 v179, v118, v119
    v_mfma_f32_16x16x32_bf16 v[112:115], a[200:203], v[72:75], v[112:115]
    v_exp_f32 v135, v135
    v_mfma_f32_16x16x32_bf16 v[112:115], a[204:207], v[76:79], v[112:115]
    v_cvt_pk_bf16_f32 v170, v108, v109
    v_cvt_pk_bf16_f32 v171, v110, v111
    v_mfma_f32_16x16x32_bf16 v[120:123], a[204:207], v[92:95], v[204:207]
    v_exp_f32 v96, v96
    v_mfma_f32_16x16x32_bf16 v[120:123], a[200:203], v[88:91], v[120:123]
    buffer_load_dwordx2 a[166:167], v9, s[24:27], s44 offen offset:0 sc1
    v_mfma_f32_16x16x32_bf16 v[120:123], a[196:199], v[84:87], v[120:123]
    v_exp_f32 v97, v97
    v_mfma_f32_16x16x32_bf16 v[120:123], a[192:195], v[80:83], v[120:123]
    s_waitcnt lgkmcnt(0)
    v_cvt_pk_bf16_f32 v162, v100, v101
    v_cvt_pk_bf16_f32 v163, v102, v103
    v_mfma_f32_16x16x32_bf16 v[124:127], a[208:211], v[80:83], v[204:207]
    v_exp_f32 v98, v98
    v_mfma_f32_16x16x32_bf16 v[124:127], a[212:215], v[84:87], v[124:127]
    ds_read_b128 a[192:195], v10 offset:57344
    buffer_load_dwordx2 a[170:171], v9, s[24:27], s44 offen offset:8 sc1
    v_mfma_f32_16x16x32_bf16 v[124:127], a[216:219], v[88:91], v[124:127]
    s_add_u32 s44, s44, 65536
    v_exp_f32 v99, v99
    v_mfma_f32_16x16x32_bf16 v[124:127], a[220:223], v[92:95], v[124:127]
    ds_read_b128 a[196:199], v11 offset:57344
    v_cvt_pk_bf16_f32 v164, v128, v129
    v_mfma_f32_16x16x32_bf16 v[116:119], a[220:223], v[76:79], v[200:203]
    v_exp_f32 v104, v104
    v_mfma_f32_16x16x32_bf16 v[116:119], a[216:219], v[72:75], v[116:119]
    ds_read_b128 a[200:203], v12 offset:57344
    v_cvt_pk_bf16_f32 v165, v130, v131
    v_mfma_f32_16x16x32_bf16 v[116:119], a[212:215], v[68:71], v[116:119]
    v_exp_f32 v105, v105
    v_mfma_f32_16x16x32_bf16 v[116:119], a[208:211], v[64:67], v[116:119]
    ds_read_b128 a[204:207], v13 offset:57344
    v_cvt_pk_bf16_f32 v172, v136, v137
    v_mfma_f32_16x16x32_bf16 v[108:111], a[208:211], v[48:51], v[196:199]
    v_exp_f32 v106, v106
    v_mfma_f32_16x16x32_bf16 v[108:111], a[212:215], v[52:55], v[108:111]
    buffer_load_dwordx2 a[172:173], v9, s[24:27], s44 offen offset:0 sc1
    v_cvt_pk_bf16_f32 v173, v138, v139
    v_mfma_f32_16x16x32_bf16 v[108:111], a[216:219], v[56:59], v[108:111]
    v_exp_f32 v107, v107
    v_mfma_f32_16x16x32_bf16 v[108:111], a[220:223], v[60:63], v[108:111]
    v_cvt_pk_bf16_f32 v180, v144, v145
    v_cvt_pk_bf16_f32 v181, v146, v147
    v_mfma_f32_16x16x32_bf16 v[100:103], a[220:223], v[44:47], v[192:195]
    v_exp_f32 v112, v112
    v_mfma_f32_16x16x32_bf16 v[100:103], a[216:219], v[40:43], v[100:103]
    buffer_load_dwordx2 a[176:177], v9, s[24:27], s44 offen offset:8 sc1
    v_mfma_f32_16x16x32_bf16 v[100:103], a[212:215], v[36:39], v[100:103]
    s_add_u32 s44, s44, 65536
    v_exp_f32 v113, v113
    v_mfma_f32_16x16x32_bf16 v[100:103], a[208:211], v[32:35], v[100:103]
    s_waitcnt lgkmcnt(0)
    v_cvt_pk_bf16_f32 v188, v152, v153
    v_cvt_pk_bf16_f32 v189, v154, v155
    v_mfma_f32_16x16x32_bf16 v[128:131], a[192:195], v[32:35], v[192:195]
    v_exp_f32 v114, v114
    v_mfma_f32_16x16x32_bf16 v[128:131], a[196:199], v[36:39], v[128:131]
    ds_read_b128 a[208:211], v10 offset:61440
    buffer_load_dwordx2 a[174:175], v9, s[24:27], s44 offen offset:0 sc1
    v_mfma_f32_16x16x32_bf16 v[128:131], a[200:203], v[40:43], v[128:131]
    v_exp_f32 v115, v115
    v_mfma_f32_16x16x32_bf16 v[128:131], a[204:207], v[44:47], v[128:131]
    ds_read_b128 a[212:215], v11 offset:61440
    v_cvt_pk_bf16_f32 v190, v156, v157
    v_mfma_f32_16x16x32_bf16 v[136:139], a[204:207], v[60:63], v[196:199]
    v_exp_f32 v120, v120
    v_mfma_f32_16x16x32_bf16 v[136:139], a[200:203], v[56:59], v[136:139]
    ds_read_b128 a[216:219], v12 offset:61440
    v_cvt_pk_bf16_f32 v191, v158, v159
    v_mfma_f32_16x16x32_bf16 v[136:139], a[196:199], v[52:55], v[136:139]
    v_exp_f32 v121, v121
    v_mfma_f32_16x16x32_bf16 v[136:139], a[192:195], v[48:51], v[136:139]
    ds_read_b128 a[220:223], v13 offset:61440
    v_cvt_pk_bf16_f32 v182, v148, v149
    v_mfma_f32_16x16x32_bf16 v[144:147], a[192:195], v[64:67], v[200:203]
    s_waitcnt vmcnt(23)
    v_exp_f32 v122, v122
    v_mfma_f32_16x16x32_bf16 v[144:147], a[196:199], v[68:71], v[144:147]
    buffer_load_dwordx2 a[178:179], v9, s[24:27], s44 offen offset:8 sc1
    v_cvt_pk_bf16_f32 v183, v150, v151
    v_mfma_f32_16x16x32_bf16 v[144:147], a[200:203], v[72:75], v[144:147]
    s_add_u32 s44, s44, 65536
    v_exp_f32 v123, v123
    v_mfma_f32_16x16x32_bf16 v[144:147], a[204:207], v[76:79], v[144:147]
    v_cvt_pk_bf16_f32 v174, v140, v141
    v_cvt_pk_bf16_f32 v175, v142, v143
    v_mfma_f32_16x16x32_bf16 v[152:155], a[204:207], v[92:95], v[204:207]
    v_exp_f32 v124, v124
    v_mfma_f32_16x16x32_bf16 v[152:155], a[200:203], v[88:91], v[152:155]
    ds_read_b64_tr_b16 a[228:229], v24 offset:57344
    buffer_load_dwordx2 a[180:181], v9, s[24:27], s44 offen offset:0 sc1
    v_mfma_f32_16x16x32_bf16 v[152:155], a[196:199], v[84:87], v[152:155]
    v_exp_f32 v125, v125
    v_mfma_f32_16x16x32_bf16 v[152:155], a[192:195], v[80:83], v[152:155]
    s_waitcnt lgkmcnt(1)
    ds_read_b64_tr_b16 a[230:231], v24 offset:61440
    v_cvt_pk_bf16_f32 v166, v132, v133
    v_mfma_f32_16x16x32_bf16 v[156:159], a[208:211], v[80:83], v[204:207]
    v_exp_f32 v126, v126
    v_mfma_f32_16x16x32_bf16 v[156:159], a[212:215], v[84:87], v[156:159]
    ds_read_b64_tr_b16 a[224:225], v24 offset:49152
    v_cvt_pk_bf16_f32 v167, v134, v135
    v_mfma_f32_16x16x32_bf16 v[156:159], a[216:219], v[88:91], v[156:159]
    v_exp_f32 v127, v127
    v_mfma_f32_16x16x32_bf16 v[156:159], a[220:223], v[92:95], v[156:159]
    ds_read_b64_tr_b16 a[226:227], v24 offset:53248
    buffer_load_dwordx2 a[184:185], v9, s[24:27], s44 offen offset:8 sc1
    v_mfma_f32_16x16x32_bf16 v[148:151], a[220:223], v[76:79], v[200:203]
    s_add_u32 s44, s44, 65536
    v_exp_f32 v116, v116
    v_mfma_f32_16x16x32_bf16 v[148:151], a[216:219], v[72:75], v[148:151]
    ds_read_b64_tr_b16 a[236:237], v25 offset:57344
    buffer_load_dwordx2 a[182:183], v9, s[24:27], s44 offen offset:0 sc1
    v_mfma_f32_16x16x32_bf16 v[148:151], a[212:215], v[68:71], v[148:151]
    v_exp_f32 v117, v117
    v_mfma_f32_16x16x32_bf16 v[148:151], a[208:211], v[64:67], v[148:151]
    ds_read_b64_tr_b16 a[238:239], v25 offset:61440
    buffer_load_dwordx2 a[186:187], v9, s[24:27], s44 offen offset:8 sc1
    v_mfma_f32_16x16x32_bf16 v[140:143], a[208:211], v[48:51], v[196:199]
    s_add_u32 s44, s44, 65536
    v_exp_f32 v118, v118
    v_mfma_f32_16x16x32_bf16 v[140:143], a[212:215], v[52:55], v[140:143]
    s_add_u32 m0, s39, 32768
    ds_read_b64_tr_b16 a[232:233], v25 offset:49152
    v_swap_b32 v210, v212
    v_mfma_f32_16x16x32_bf16 v[140:143], a[216:219], v[56:59], v[140:143]
    v_exp_f32 v119, v119
    v_mfma_f32_16x16x32_bf16 v[140:143], a[220:223], v[60:63], v[140:143]
    ds_read_b64_tr_b16 a[234:235], v25 offset:53248
    buffer_load_dwordx4 v14, s[16:19], s43 offen offset:0 lds
    v_mfma_f32_16x16x32_bf16 v[132:135], a[220:223], v[44:47], v[192:195]
    v_exp_f32 v108, v108
    v_mfma_f32_16x16x32_bf16 v[132:135], a[216:219], v[40:43], v[132:135]
    ds_read_b64_tr_b16 a[244:245], v26 offset:57344
    v_swap_b32 v211, v213
    v_mfma_f32_16x16x32_bf16 v[132:135], a[212:215], v[36:39], v[132:135]
    v_exp_f32 v109, v109
    v_mfma_f32_16x16x32_bf16 v[132:135], a[208:211], v[32:35], v[132:135]
    ds_read_b64_tr_b16 a[246:247], v26 offset:61440
    buffer_load_dwordx4 v15, s[16:19], s43 offen offset:1024 lds
    v_smfmac_f32_16x16x64_bf16 a[128:131], a[144:147], v[160:167], v23
    ds_read_b64_tr_b16 a[240:241], v26 offset:49152
    v_smfmac_f32_16x16x64_bf16 a[132:135], a[144:147], v[168:175], v23
    v_swap_b32 v218, v220
    v_smfmac_f32_16x16x64_bf16 a[136:139], a[144:147], v[176:183], v23
    ds_read_b64_tr_b16 a[242:243], v26 offset:53248
    v_smfmac_f32_16x16x64_bf16 a[140:143], a[144:147], v[184:191], v23
    s_waitcnt lgkmcnt(8)
    buffer_load_dwordx4 v16, s[16:19], s43 offen offset:2048 lds
    v_mfma_f32_16x16x32_bf16 a[12:15], a[228:231], v[188:191], a[12:15]
    ds_read_b64_tr_b16 a[252:253], v27 offset:57344
    ds_read_b64_tr_b16 a[254:255], v27 offset:61440
    v_mfma_f32_16x16x32_bf16 a[12:15], a[224:227], v[184:187], a[12:15]
    v_exp_f32 v110, v110
    v_mfma_f32_16x16x32_bf16 a[8:11], a[224:227], v[176:179], a[8:11]
    buffer_load_dwordx4 v17, s[16:19], s43 offen offset:3072 lds
    v_swap_b32 v219, v221
    v_mfma_f32_16x16x32_bf16 a[8:11], a[228:231], v[180:183], a[8:11]
    s_add_u32 s43, s43, 65536
    v_exp_f32 v111, v111
    v_mfma_f32_16x16x32_bf16 a[4:7], a[228:231], v[172:175], a[4:7]
    s_add_u32 m0, s39, 98304
    ds_read_b64_tr_b16 a[248:249], v27 offset:49152
    ds_read_b64_tr_b16 a[250:251], v27 offset:53248
    v_mfma_f32_16x16x32_bf16 a[4:7], a[224:227], v[168:171], a[4:7]
    v_exp_f32 v100, v100
    v_mfma_f32_16x16x32_bf16 a[0:3], a[224:227], v[160:163], a[0:3]
    buffer_load_dwordx4 v14, s[16:19], s43 offen offset:0 lds
    v_swap_b32 v226, v228
    v_mfma_f32_16x16x32_bf16 a[0:3], a[228:231], v[164:167], a[0:3]
    s_waitcnt lgkmcnt(8)
    v_exp_f32 v101, v101
    v_mfma_f32_16x16x32_bf16 a[16:19], a[236:239], v[164:167], a[16:19]
    ds_read_b64_tr_b16 a[228:229], v28 offset:57344
    ds_read_b64_tr_b16 a[230:231], v28 offset:61440
    v_mfma_f32_16x16x32_bf16 a[16:19], a[232:235], v[160:163], a[16:19]
    v_exp_f32 v102, v102
    v_mfma_f32_16x16x32_bf16 a[20:23], a[232:235], v[168:171], a[20:23]
    buffer_load_dwordx4 v15, s[16:19], s43 offen offset:1024 lds
    v_swap_b32 v227, v229
    v_mfma_f32_16x16x32_bf16 a[20:23], a[236:239], v[172:175], a[20:23]
    v_exp_f32 v103, v103
    v_mfma_f32_16x16x32_bf16 a[24:27], a[236:239], v[180:183], a[24:27]
    ds_read_b64_tr_b16 a[224:225], v28 offset:49152
    ds_read_b64_tr_b16 a[226:227], v28 offset:53248
    v_mfma_f32_16x16x32_bf16 a[24:27], a[232:235], v[176:179], a[24:27]
    v_exp_f32 v128, v128
    v_mfma_f32_16x16x32_bf16 a[28:31], a[232:235], v[184:187], a[28:31]
    buffer_load_dwordx4 v16, s[16:19], s43 offen offset:2048 lds
    v_swap_b32 v234, v236
    v_mfma_f32_16x16x32_bf16 a[28:31], a[236:239], v[188:191], a[28:31]
    s_waitcnt lgkmcnt(8)
    v_exp_f32 v129, v129
    v_mfma_f32_16x16x32_bf16 a[44:47], a[244:247], v[188:191], a[44:47]
    ds_read_b64_tr_b16 a[236:237], v29 offset:57344
    ds_read_b64_tr_b16 a[238:239], v29 offset:61440
    v_mfma_f32_16x16x32_bf16 a[44:47], a[240:243], v[184:187], a[44:47]
    v_exp_f32 v130, v130
    v_mfma_f32_16x16x32_bf16 a[40:43], a[240:243], v[176:179], a[40:43]
    buffer_load_dwordx4 v17, s[16:19], s43 offen offset:3072 lds
    v_swap_b32 v235, v237
    v_mfma_f32_16x16x32_bf16 a[40:43], a[244:247], v[180:183], a[40:43]
    s_add_u32 s43, s43, 65536
    v_exp_f32 v131, v131
    v_mfma_f32_16x16x32_bf16 a[36:39], a[244:247], v[172:175], a[36:39]
    s_add_u32 m0, s39, 131072
    ds_read_b64_tr_b16 a[232:233], v29 offset:49152
    ds_read_b64_tr_b16 a[234:235], v29 offset:53248
    v_mfma_f32_16x16x32_bf16 a[36:39], a[240:243], v[168:171], a[36:39]
    v_exp_f32 v136, v136
    v_mfma_f32_16x16x32_bf16 a[32:35], a[240:243], v[160:163], a[32:35]
    buffer_load_dwordx4 v14, s[20:23], s45 offen offset:0 lds
    v_swap_b32 v242, v244
    v_mfma_f32_16x16x32_bf16 a[32:35], a[244:247], v[164:167], a[32:35]
    s_waitcnt lgkmcnt(8)
    v_exp_f32 v137, v137
    v_mfma_f32_16x16x32_bf16 a[48:51], a[252:255], v[164:167], a[48:51]
    ds_read_b64_tr_b16 a[244:245], v30 offset:57344
    ds_read_b64_tr_b16 a[246:247], v30 offset:61440
    v_mfma_f32_16x16x32_bf16 a[48:51], a[248:251], v[160:163], a[48:51]
    v_exp_f32 v138, v138
    v_mfma_f32_16x16x32_bf16 a[52:55], a[248:251], v[168:171], a[52:55]
    buffer_load_dwordx4 v15, s[20:23], s45 offen offset:1024 lds
    v_swap_b32 v243, v245
    v_mfma_f32_16x16x32_bf16 a[52:55], a[252:255], v[172:175], a[52:55]
    v_exp_f32 v139, v139
    v_mfma_f32_16x16x32_bf16 a[56:59], a[252:255], v[180:183], a[56:59]
    ds_read_b64_tr_b16 a[240:241], v30 offset:49152
    ds_read_b64_tr_b16 a[242:243], v30 offset:53248
    v_mfma_f32_16x16x32_bf16 a[56:59], a[248:251], v[176:179], a[56:59]
    v_exp_f32 v144, v144
    v_mfma_f32_16x16x32_bf16 a[60:63], a[248:251], v[184:187], a[60:63]
    buffer_load_dwordx4 v16, s[20:23], s45 offen offset:2048 lds
    v_swap_b32 v250, v252
    v_mfma_f32_16x16x32_bf16 a[60:63], a[252:255], v[188:191], a[60:63]
    s_waitcnt lgkmcnt(8)
    v_exp_f32 v145, v145
    v_mfma_f32_16x16x32_bf16 a[76:79], a[228:231], v[188:191], a[76:79]
    ds_read_b64_tr_b16 a[252:253], v31 offset:57344
    ds_read_b64_tr_b16 a[254:255], v31 offset:61440
    v_mfma_f32_16x16x32_bf16 a[76:79], a[224:227], v[184:187], a[76:79]
    v_exp_f32 v146, v146
    v_mfma_f32_16x16x32_bf16 a[72:75], a[224:227], v[176:179], a[72:75]
    buffer_load_dwordx4 v17, s[20:23], s45 offen offset:3072 lds
    v_swap_b32 v251, v253
    v_mfma_f32_16x16x32_bf16 a[72:75], a[228:231], v[180:183], a[72:75]
    s_add_u32 s45, s45, 65536
    v_exp_f32 v147, v147
    v_mfma_f32_16x16x32_bf16 a[68:71], a[228:231], v[172:175], a[68:71]
    s_add_u32 m0, s39, 147456
    ds_read_b64_tr_b16 a[248:249], v31 offset:49152
    ds_read_b64_tr_b16 a[250:251], v31 offset:53248
    v_mfma_f32_16x16x32_bf16 a[68:71], a[224:227], v[168:171], a[68:71]
    v_exp_f32 v152, v152
    v_mfma_f32_16x16x32_bf16 a[64:67], a[224:227], v[160:163], a[64:67]
    buffer_load_dwordx4 v14, s[20:23], s45 offen offset:0 lds
    v_mfma_f32_16x16x32_bf16 a[64:67], a[228:231], v[164:167], a[64:67]
    s_waitcnt lgkmcnt(8)
    v_exp_f32 v153, v153
    v_mfma_f32_16x16x32_bf16 a[80:83], a[236:239], v[164:167], a[80:83]
    v_mfma_f32_16x16x32_bf16 a[80:83], a[232:235], v[160:163], a[80:83]
    v_exp_f32 v154, v154
    v_mfma_f32_16x16x32_bf16 a[84:87], a[232:235], v[168:171], a[84:87]
    buffer_load_dwordx4 v15, s[20:23], s45 offen offset:1024 lds
    v_mfma_f32_16x16x32_bf16 a[84:87], a[236:239], v[172:175], a[84:87]
    v_exp_f32 v155, v155
    v_mfma_f32_16x16x32_bf16 a[88:91], a[236:239], v[180:183], a[88:91]
    v_mfma_f32_16x16x32_bf16 a[88:91], a[232:235], v[176:179], a[88:91]
    s_waitcnt vmcnt(55) lgkmcnt(0)
    v_exp_f32 v156, v156
    v_mfma_f32_16x16x32_bf16 a[92:95], a[232:235], v[184:187], a[92:95]
    s_barrier
    v_mfma_f32_16x16x32_bf16 a[92:95], a[236:239], v[188:191], a[92:95]
    v_exp_f32 v157, v157
    v_mfma_f32_16x16x32_bf16 a[108:111], a[244:247], v[188:191], a[108:111]
    buffer_load_dwordx4 v16, s[20:23], s45 offen offset:2048 lds
    v_mfma_f32_16x16x32_bf16 a[108:111], a[240:243], v[184:187], a[108:111]
    v_exp_f32 v158, v158
    v_mfma_f32_16x16x32_bf16 a[104:107], a[240:243], v[176:179], a[104:107]
    buffer_load_dwordx4 v17, s[20:23], s45 offen offset:3072 lds
    v_mfma_f32_16x16x32_bf16 a[104:107], a[244:247], v[180:183], a[104:107]
    s_add_u32 s45, s45, 65536
    v_exp_f32 v159, v159
    v_mfma_f32_16x16x32_bf16 a[100:103], a[244:247], v[172:175], a[100:103]
    buffer_load_dwordx2 v[200:201], v18, s[12:15], 0 offen offset:0
    v_mfma_f32_16x16x32_bf16 a[100:103], a[240:243], v[168:171], a[100:103]
    v_exp_f32 v148, v148
    v_mfma_f32_16x16x32_bf16 a[96:99], a[240:243], v[160:163], a[96:99]
    buffer_load_dwordx2 v[202:203], v19, s[12:15], 0 offen offset:0
    v_mfma_f32_16x16x32_bf16 a[96:99], a[244:247], v[164:167], a[96:99]
    v_exp_f32 v149, v149
    v_mfma_f32_16x16x32_bf16 a[112:115], a[252:255], v[164:167], a[112:115]
    buffer_load_dwordx2 v[204:205], v18, s[12:15], 0 offen offset:32
    v_mfma_f32_16x16x32_bf16 a[112:115], a[248:251], v[160:163], a[112:115]
    v_exp_f32 v150, v150
    v_mfma_f32_16x16x32_bf16 a[116:119], a[248:251], v[168:171], a[116:119]
    v_cvt_pk_bf16_f32 v160, v96, v97
    v_cvt_pk_bf16_f32 v161, v98, v99
    v_mfma_f32_16x16x32_bf16 a[116:119], a[252:255], v[172:175], a[116:119]
    v_exp_f32 v151, v151
    v_mfma_f32_16x16x32_bf16 a[120:123], a[252:255], v[180:183], a[120:123]
    v_cvt_pk_bf16_f32 v168, v104, v105
    v_cvt_pk_bf16_f32 v169, v106, v107
    v_mfma_f32_16x16x32_bf16 a[120:123], a[248:251], v[176:179], a[120:123]
    v_exp_f32 v140, v140
    v_mfma_f32_16x16x32_bf16 a[124:127], a[248:251], v[184:187], a[124:127]
    v_cvt_pk_bf16_f32 v176, v112, v113
    v_cvt_pk_bf16_f32 v177, v114, v115
    v_mfma_f32_16x16x32_bf16 a[124:127], a[252:255], v[188:191], a[124:127]
    v_exp_f32 v141, v141
    ds_read_b64_tr_b16 a[228:229], v24 offset:8192
    ds_read_b64_tr_b16 a[230:231], v24 offset:12288
    ds_read_b64_tr_b16 a[224:225], v24 offset:0
    ds_read_b64_tr_b16 a[226:227], v24 offset:4096
    ds_read_b64_tr_b16 a[236:237], v25 offset:8192
    ds_read_b64_tr_b16 a[238:239], v25 offset:12288
    ds_read_b64_tr_b16 a[232:233], v25 offset:0
    ds_read_b64_tr_b16 a[234:235], v25 offset:4096
    ds_read_b64_tr_b16 a[244:245], v26 offset:8192
    ds_read_b64_tr_b16 a[246:247], v26 offset:12288
    ds_read_b64_tr_b16 a[240:241], v26 offset:0
    ds_read_b64_tr_b16 a[242:243], v26 offset:4096
    v_exp_f32 v142, v142
    v_exp_f32 v143, v143
    v_exp_f32 v132, v132
    v_exp_f32 v133, v133
    v_exp_f32 v134, v134
    v_exp_f32 v135, v135
    v_cvt_pk_bf16_f32 v184, v120, v121
    v_cvt_pk_bf16_f32 v185, v122, v123
    v_cvt_pk_bf16_f32 v186, v124, v125
    v_cvt_pk_bf16_f32 v187, v126, v127
    v_cvt_pk_bf16_f32 v178, v116, v117
    v_cvt_pk_bf16_f32 v179, v118, v119
    v_cvt_pk_bf16_f32 v170, v108, v109
    v_cvt_pk_bf16_f32 v171, v110, v111
    v_cvt_pk_bf16_f32 v162, v100, v101
    v_cvt_pk_bf16_f32 v163, v102, v103
    v_cvt_pk_bf16_f32 v164, v128, v129
    v_cvt_pk_bf16_f32 v165, v130, v131
    v_cvt_pk_bf16_f32 v172, v136, v137
    v_cvt_pk_bf16_f32 v173, v138, v139
    v_cvt_pk_bf16_f32 v180, v144, v145
    v_cvt_pk_bf16_f32 v181, v146, v147
    v_cvt_pk_bf16_f32 v188, v152, v153
    v_cvt_pk_bf16_f32 v189, v154, v155
    v_cvt_pk_bf16_f32 v190, v156, v157
    v_cvt_pk_bf16_f32 v191, v158, v159
    v_cvt_pk_bf16_f32 v182, v148, v149
    v_cvt_pk_bf16_f32 v183, v150, v151
    v_cvt_pk_bf16_f32 v174, v140, v141
    v_cvt_pk_bf16_f32 v175, v142, v143
    v_cvt_pk_bf16_f32 v166, v132, v133
    v_cvt_pk_bf16_f32 v167, v134, v135
    s_waitcnt lgkmcnt(0)
    s_nop 0
    v_smfmac_f32_16x16x64_bf16 a[128:131], a[144:147], v[160:167], v23
    buffer_load_dwordx2 v[206:207], v19, s[12:15], 0 offen offset:32
    v_smfmac_f32_16x16x64_bf16 a[132:135], a[144:147], v[168:175], v23
    s_add_u32 m0, s39, 49152
    v_smfmac_f32_16x16x64_bf16 a[136:139], a[144:147], v[176:183], v23
    buffer_load_dwordx4 v14, s[16:19], s43 offen offset:0 lds
    v_smfmac_f32_16x16x64_bf16 a[140:143], a[144:147], v[184:191], v23
    v_mfma_f32_16x16x32_bf16 a[12:15], a[228:231], v[188:191], a[12:15]
    ds_read_b64_tr_b16 a[252:253], v27 offset:8192
    ds_read_b64_tr_b16 a[254:255], v27 offset:12288
    v_mfma_f32_16x16x32_bf16 a[12:15], a[224:227], v[184:187], a[12:15]
    buffer_load_dwordx4 v15, s[16:19], s43 offen offset:1024 lds
    v_mfma_f32_16x16x32_bf16 a[8:11], a[224:227], v[176:179], a[8:11]
    v_mfma_f32_16x16x32_bf16 a[8:11], a[228:231], v[180:183], a[8:11]
    buffer_load_dwordx4 v16, s[16:19], s43 offen offset:2048 lds
    v_mfma_f32_16x16x32_bf16 a[4:7], a[228:231], v[172:175], a[4:7]
    ds_read_b64_tr_b16 a[248:249], v27 offset:0
    ds_read_b64_tr_b16 a[250:251], v27 offset:4096
    v_mfma_f32_16x16x32_bf16 a[4:7], a[224:227], v[168:171], a[4:7]
    buffer_load_dwordx4 v17, s[16:19], s43 offen offset:3072 lds
    v_mfma_f32_16x16x32_bf16 a[0:3], a[224:227], v[160:163], a[0:3]
    s_add_u32 s43, s43, 65536
    v_mfma_f32_16x16x32_bf16 a[0:3], a[228:231], v[164:167], a[0:3]
    s_add_u32 m0, s39, 114688
    v_accvgpr_read_b32 v192, a128
    v_accvgpr_read_b32 v196, a129
    v_mfma_f32_16x16x32_bf16 a[16:19], a[236:239], v[164:167], a[16:19]
    ds_read_b64_tr_b16 a[228:229], v28 offset:8192
    ds_read_b64_tr_b16 a[230:231], v28 offset:12288
    v_mfma_f32_16x16x32_bf16 a[16:19], a[232:235], v[160:163], a[16:19]
    buffer_load_dwordx4 v14, s[16:19], s43 offen offset:0 lds
    v_accvgpr_read_b32 v193, a132
    v_mfma_f32_16x16x32_bf16 a[20:23], a[232:235], v[168:171], a[20:23]
    v_accvgpr_read_b32 v197, a133
    v_accvgpr_read_b32 v194, a136
    v_mfma_f32_16x16x32_bf16 a[20:23], a[236:239], v[172:175], a[20:23]
    buffer_load_dwordx4 v15, s[16:19], s43 offen offset:1024 lds
    v_accvgpr_read_b32 v198, a137
    v_mfma_f32_16x16x32_bf16 a[24:27], a[236:239], v[180:183], a[24:27]
    ds_read_b64_tr_b16 a[224:225], v28 offset:0
    ds_read_b64_tr_b16 a[226:227], v28 offset:4096
    v_mfma_f32_16x16x32_bf16 a[24:27], a[232:235], v[176:179], a[24:27]
    buffer_load_dwordx4 v16, s[16:19], s43 offen offset:2048 lds
    v_accvgpr_read_b32 v195, a140
    v_mfma_f32_16x16x32_bf16 a[28:31], a[232:235], v[184:187], a[28:31]
    v_accvgpr_read_b32 v199, a141
    v_add_f32 v192, v192, v196
    v_mfma_f32_16x16x32_bf16 a[28:31], a[236:239], v[188:191], a[28:31]
    buffer_load_dwordx4 v17, s[16:19], s43 offen offset:3072 lds
    v_add_f32 v193, v193, v197
    v_mfma_f32_16x16x32_bf16 a[44:47], a[244:247], v[188:191], a[44:47]
    s_add_u32 s43, s43, 65536
    ds_read_b64_tr_b16 a[236:237], v29 offset:8192
    ds_read_b64_tr_b16 a[238:239], v29 offset:12288
    v_mfma_f32_16x16x32_bf16 a[44:47], a[240:243], v[184:187], a[44:47]
    v_add_f32 v194, v194, v198
    v_add_f32 v195, v195, v199
    v_mfma_f32_16x16x32_bf16 a[40:43], a[240:243], v[176:179], a[40:43]
    v_max3_f32 v196, v192, v193, v194
    v_max_f32 v196, v196, v195
    v_mfma_f32_16x16x32_bf16 a[40:43], a[244:247], v[180:183], a[40:43]
    v_mov_b32 v197, 0x5f800000
    v_cmp_nlt_f32 vcc, v196, v197
    v_mfma_f32_16x16x32_bf16 a[36:39], a[244:247], v[172:175], a[36:39]
    ds_read_b64_tr_b16 a[232:233], v29 offset:0
    ds_read_b64_tr_b16 a[234:235], v29 offset:4096
    v_mfma_f32_16x16x32_bf16 a[36:39], a[240:243], v[168:171], a[36:39]
    v_rcp_f32 v192, v192
    v_mfma_f32_16x16x32_bf16 a[32:35], a[240:243], v[160:163], a[32:35]
    v_rcp_f32 v193, v193
    v_mfma_f32_16x16x32_bf16 a[32:35], a[244:247], v[164:167], a[32:35]
    s_waitcnt lgkmcnt(8)
    v_rcp_f32 v194, v194
    v_mfma_f32_16x16x32_bf16 a[48:51], a[252:255], v[164:167], a[48:51]
    ds_read_b64_tr_b16 a[244:245], v30 offset:8192
    ds_read_b64_tr_b16 a[246:247], v30 offset:12288
    v_mfma_f32_16x16x32_bf16 a[48:51], a[248:251], v[160:163], a[48:51]
    v_rcp_f32 v195, v195
    v_mfma_f32_16x16x32_bf16 a[52:55], a[248:251], v[168:171], a[52:55]
    s_mov_b32 s3, 0
    v_accvgpr_read_b32 v96, a0
    v_accvgpr_read_b32 v97, a1
    v_mfma_f32_16x16x32_bf16 a[52:55], a[252:255], v[172:175], a[52:55]
    v_accvgpr_read_b32 v98, a2
    v_accvgpr_read_b32 v99, a3
    v_mfma_f32_16x16x32_bf16 a[56:59], a[252:255], v[180:183], a[56:59]
    ds_read_b64_tr_b16 a[240:241], v30 offset:0
    ds_read_b64_tr_b16 a[242:243], v30 offset:4096
    v_mfma_f32_16x16x32_bf16 a[56:59], a[248:251], v[176:179], a[56:59]
    v_accvgpr_read_b32 v100, a16
    v_accvgpr_read_b32 v101, a17
    v_mfma_f32_16x16x32_bf16 a[60:63], a[248:251], v[184:187], a[60:63]
    v_accvgpr_read_b32 v102, a18
    v_accvgpr_read_b32 v103, a19
    v_mfma_f32_16x16x32_bf16 a[60:63], a[252:255], v[188:191], a[60:63]
    s_waitcnt lgkmcnt(8)
    v_mul_f32 v96, v96, v192
    v_mul_f32 v97, v97, v192
    v_mfma_f32_16x16x32_bf16 a[76:79], a[228:231], v[188:191], a[76:79]
    ds_read_b64_tr_b16 a[252:253], v31 offset:8192
    ds_read_b64_tr_b16 a[254:255], v31 offset:12288
    v_mfma_f32_16x16x32_bf16 a[76:79], a[224:227], v[184:187], a[76:79]
    v_mul_f32 v98, v98, v192
    v_mul_f32 v99, v99, v192
    v_mfma_f32_16x16x32_bf16 a[72:75], a[224:227], v[176:179], a[72:75]
    v_mul_f32 v100, v100, v192
    v_mul_f32 v101, v101, v192
    v_mfma_f32_16x16x32_bf16 a[72:75], a[228:231], v[180:183], a[72:75]
    v_mul_f32 v102, v102, v192
    v_mul_f32 v103, v103, v192
    v_mfma_f32_16x16x32_bf16 a[68:71], a[228:231], v[172:175], a[68:71]
    ds_read_b64_tr_b16 a[248:249], v31 offset:0
    ds_read_b64_tr_b16 a[250:251], v31 offset:4096
    v_mfma_f32_16x16x32_bf16 a[68:71], a[224:227], v[168:171], a[68:71]
    v_cvt_pk_bf16_f32 v104, v96, v97
    v_cvt_pk_bf16_f32 v105, v98, v99
    v_mfma_f32_16x16x32_bf16 a[64:67], a[224:227], v[160:163], a[64:67]
    v_cvt_pk_bf16_f32 v106, v100, v101
    v_cvt_pk_bf16_f32 v107, v102, v103
    v_mfma_f32_16x16x32_bf16 a[64:67], a[228:231], v[164:167], a[64:67]
    s_waitcnt lgkmcnt(8)
    buffer_store_dwordx4 v[104:107], v9, s[32:35], s3 offen offset:0 sc1
    v_mfma_f32_16x16x32_bf16 a[80:83], a[236:239], v[164:167], a[80:83]
    v_accvgpr_read_b32 v128, a8
    v_accvgpr_read_b32 v129, a9
    v_mfma_f32_16x16x32_bf16 a[80:83], a[232:235], v[160:163], a[80:83]
    v_accvgpr_read_b32 v130, a10
    v_accvgpr_read_b32 v131, a11
    v_mfma_f32_16x16x32_bf16 a[84:87], a[232:235], v[168:171], a[84:87]
    v_accvgpr_read_b32 v132, a24
    v_accvgpr_read_b32 v133, a25
    v_mfma_f32_16x16x32_bf16 a[84:87], a[236:239], v[172:175], a[84:87]
    v_accvgpr_read_b32 v134, a26
    v_accvgpr_read_b32 v135, a27
    v_mfma_f32_16x16x32_bf16 a[88:91], a[236:239], v[180:183], a[88:91]
    v_mul_f32 v128, v128, v194
    v_mul_f32 v129, v129, v194
    v_mfma_f32_16x16x32_bf16 a[88:91], a[232:235], v[176:179], a[88:91]
    v_mul_f32 v130, v130, v194
    v_mul_f32 v131, v131, v194
    v_mfma_f32_16x16x32_bf16 a[92:95], a[232:235], v[184:187], a[92:95]
    v_mul_f32 v132, v132, v194
    v_mul_f32 v133, v133, v194
    v_mfma_f32_16x16x32_bf16 a[92:95], a[236:239], v[188:191], a[92:95]
    s_waitcnt lgkmcnt(4)
    v_mul_f32 v134, v134, v194
    v_mul_f32 v135, v135, v194
    v_mfma_f32_16x16x32_bf16 a[108:111], a[244:247], v[188:191], a[108:111]
    v_cvt_pk_bf16_f32 v136, v128, v129
    v_cvt_pk_bf16_f32 v137, v130, v131
    v_mfma_f32_16x16x32_bf16 a[108:111], a[240:243], v[184:187], a[108:111]
    v_cvt_pk_bf16_f32 v138, v132, v133
    v_cvt_pk_bf16_f32 v139, v134, v135
    v_mfma_f32_16x16x32_bf16 a[104:107], a[240:243], v[176:179], a[104:107]
    buffer_store_dwordx4 v[136:139], v9, s[32:35], s3 offen offset:2048 sc1
    v_mfma_f32_16x16x32_bf16 a[104:107], a[244:247], v[180:183], a[104:107]
    v_accvgpr_read_b32 v112, a4
    v_accvgpr_read_b32 v113, a5
    v_mfma_f32_16x16x32_bf16 a[100:103], a[244:247], v[172:175], a[100:103]
    v_accvgpr_read_b32 v114, a6
    v_accvgpr_read_b32 v115, a7
    v_mfma_f32_16x16x32_bf16 a[100:103], a[240:243], v[168:171], a[100:103]
    v_accvgpr_read_b32 v116, a20
    v_accvgpr_read_b32 v117, a21
    v_mfma_f32_16x16x32_bf16 a[96:99], a[240:243], v[160:163], a[96:99]
    v_accvgpr_read_b32 v118, a22
    v_accvgpr_read_b32 v119, a23
    v_mfma_f32_16x16x32_bf16 a[96:99], a[244:247], v[164:167], a[96:99]
    s_waitcnt lgkmcnt(0)
    v_mul_f32 v112, v112, v193
    v_mul_f32 v113, v113, v193
    v_mfma_f32_16x16x32_bf16 a[112:115], a[252:255], v[164:167], a[112:115]
    v_mul_f32 v114, v114, v193
    v_mul_f32 v115, v115, v193
    v_mfma_f32_16x16x32_bf16 a[112:115], a[248:251], v[160:163], a[112:115]
    v_mul_f32 v116, v116, v193
    v_mul_f32 v117, v117, v193
    v_mfma_f32_16x16x32_bf16 a[116:119], a[248:251], v[168:171], a[116:119]
    v_mul_f32 v118, v118, v193
    v_mul_f32 v119, v119, v193
    v_mfma_f32_16x16x32_bf16 a[116:119], a[252:255], v[172:175], a[116:119]
    v_cvt_pk_bf16_f32 v120, v112, v113
    v_cvt_pk_bf16_f32 v121, v114, v115
    v_mfma_f32_16x16x32_bf16 a[120:123], a[252:255], v[180:183], a[120:123]
    v_cvt_pk_bf16_f32 v122, v116, v117
    v_cvt_pk_bf16_f32 v123, v118, v119
    v_mfma_f32_16x16x32_bf16 a[120:123], a[248:251], v[176:179], a[120:123]
    buffer_store_dwordx4 v[120:123], v9, s[32:35], s3 offen offset:1024 sc1
    v_mfma_f32_16x16x32_bf16 a[124:127], a[248:251], v[184:187], a[124:127]
    v_accvgpr_read_b32 v144, a12
    v_accvgpr_read_b32 v145, a13
    v_mfma_f32_16x16x32_bf16 a[124:127], a[252:255], v[188:191], a[124:127]
    v_accvgpr_read_b32 v146, a14
    v_accvgpr_read_b32 v147, a15
    s_cmp_lg_u64 vcc, 0
    s_cselect_b32 s49, 1, 0
    s_lshl_b32 s50, s36, 2
    v_mov_b32 v197, s49
    v_mov_b32 v198, s50
    ds_write_b32 v198, v197 offset:0
    s_lshl_b32 s51, s40, 6
    v_mov_b32 v198, 0
    v_xor_b32 v24, s51, v24
    v_xor_b32 v25, s51, v25
    v_xor_b32 v26, s51, v26
    v_xor_b32 v27, s51, v27
    v_xor_b32 v28, s51, v28
    v_xor_b32 v29, s51, v29
    v_xor_b32 v30, s51, v30
    v_xor_b32 v31, s51, v31
    v_subrev_u32 v160, 65536, v24
    v_subrev_u32 v161, 65536, v25
    v_subrev_u32 v162, 65536, v26
    v_subrev_u32 v163, 65536, v27
    v_subrev_u32 v164, 65536, v28
    v_subrev_u32 v165, 65536, v29
    v_subrev_u32 v166, 65536, v30
    v_subrev_u32 v167, 65536, v31
    v_accvgpr_read_b32 v148, a28
    v_accvgpr_read_b32 v149, a29
    v_accvgpr_read_b32 v150, a30
    v_accvgpr_read_b32 v151, a31
    v_mul_f32 v144, v144, v195
    v_mul_f32 v145, v145, v195
    v_mul_f32 v146, v146, v195
    v_mul_f32 v147, v147, v195
    v_mul_f32 v148, v148, v195
    v_mul_f32 v149, v149, v195
    v_mul_f32 v150, v150, v195
    v_mul_f32 v151, v151, v195
    v_cvt_pk_bf16_f32 v152, v144, v145
    v_cvt_pk_bf16_f32 v153, v146, v147
    v_cvt_pk_bf16_f32 v154, v148, v149
    v_cvt_pk_bf16_f32 v155, v150, v151
    buffer_store_dwordx4 v[152:155], v9, s[32:35], s3 offen offset:3072 sc1
    s_waitcnt vmcnt(4) lgkmcnt(0)
    s_barrier
    ds_read_b128 v[196:199], v198 offset:0
    ds_read_b64_tr_b16 a[192:193], v160 offset:16384
    ds_read_b64_tr_b16 a[194:195], v160 offset:20480
    ds_read_b64_tr_b16 a[196:197], v160 offset:24576
    ds_read_b64_tr_b16 a[198:199], v160 offset:28672
    ds_read_b64_tr_b16 a[200:201], v161 offset:16384
    ds_read_b64_tr_b16 a[202:203], v161 offset:20480
    ds_read_b64_tr_b16 a[204:205], v161 offset:24576
    ds_read_b64_tr_b16 a[206:207], v161 offset:28672
    ds_read_b64_tr_b16 a[208:209], v162 offset:16384
    ds_read_b64_tr_b16 a[210:211], v162 offset:20480
    ds_read_b64_tr_b16 a[212:213], v162 offset:24576
    ds_read_b64_tr_b16 a[214:215], v162 offset:28672
    ds_read_b64_tr_b16 a[216:217], v163 offset:16384
    ds_read_b64_tr_b16 a[218:219], v163 offset:20480
    ds_read_b64_tr_b16 a[220:221], v163 offset:24576
    ds_read_b64_tr_b16 a[222:223], v163 offset:28672
    s_mov_b32 s3, 131072
    v_accvgpr_read_b32 v96, a32
    v_accvgpr_read_b32 v97, a33
    v_accvgpr_read_b32 v98, a34
    v_accvgpr_read_b32 v99, a35
    v_accvgpr_read_b32 v100, a48
    v_accvgpr_read_b32 v101, a49
    v_accvgpr_read_b32 v102, a50
    v_accvgpr_read_b32 v103, a51
    v_mul_f32 v96, v96, v192
    v_mul_f32 v97, v97, v192
    v_mul_f32 v98, v98, v192
    v_mul_f32 v99, v99, v192
    v_mul_f32 v100, v100, v192
    v_mul_f32 v101, v101, v192
    v_mul_f32 v102, v102, v192
    v_mul_f32 v103, v103, v192
    v_cvt_pk_bf16_f32 v104, v96, v97
    v_cvt_pk_bf16_f32 v105, v98, v99
    v_cvt_pk_bf16_f32 v106, v100, v101
    v_cvt_pk_bf16_f32 v107, v102, v103
    buffer_store_dwordx4 v[104:107], v9, s[32:35], s3 offen offset:0 sc1
    s_waitcnt lgkmcnt(12)
    v_or_b32 v196, v196, v197
    v_or3_b32 v196, v196, v198, v199
    s_nop 0
    v_readfirstlane_b32 s49, v196
    s_andn2_b32 s49, s49, s48
    s_cbranch_scc1 L_retry
    v_mfma_f32_16x16x32_bf16 v[32:35], a[192:195], v[208:211], 0
    s_lshl_b32 s49, s41, 10
    ds_read_b64_tr_b16 a[224:225], v164 offset:16384
    v_accvgpr_read_b32 v128, a40
    v_accvgpr_read_b32 v129, a41
    v_accvgpr_read_b32 v130, a42
    v_accvgpr_read_b32 v131, a43
    v_accvgpr_read_b32 v132, a56
    v_accvgpr_read_b32 v133, a57
    v_mfma_f32_16x16x32_bf16 v[32:35], a[196:199], v[216:219], v[32:35]
    s_add_u32 s50, s49, 8388608
    ds_read_b64_tr_b16 a[226:227], v164 offset:20480
    v_accvgpr_read_b32 v134, a58
    v_accvgpr_read_b32 v135, a59
    v_mul_f32 v128, v128, v194
    v_mul_f32 v129, v129, v194
    v_mul_f32 v130, v130, v194
    v_mfma_f32_16x16x32_bf16 v[36:39], a[196:199], v[220:223], 0
    s_add_u32 s24, s4, s50
    ds_read_b64_tr_b16 a[228:229], v164 offset:24576
    v_mul_f32 v131, v131, v194
    v_mul_f32 v132, v132, v194
    v_mul_f32 v133, v133, v194
    v_mul_f32 v134, v134, v194
    v_mul_f32 v135, v135, v194
    v_mfma_f32_16x16x32_bf16 v[36:39], a[192:195], v[212:215], v[36:39]
    s_waitcnt lgkmcnt(11)
    ds_read_b64_tr_b16 a[230:231], v164 offset:28672
    v_cvt_pk_bf16_f32 v136, v128, v129
    v_cvt_pk_bf16_f32 v137, v130, v131
    v_cvt_pk_bf16_f32 v138, v132, v133
    v_cvt_pk_bf16_f32 v139, v134, v135
    v_mfma_f32_16x16x32_bf16 v[44:47], a[200:203], v[212:215], 0
    s_addc_u32 s25, s5, 0
    ds_read_b64_tr_b16 a[232:233], v165 offset:16384
    buffer_store_dwordx4 v[136:139], v9, s[32:35], s3 offen offset:2048 sc1
    v_accvgpr_read_b32 v112, a36
    v_accvgpr_read_b32 v113, a37
    v_accvgpr_read_b32 v114, a38
    v_accvgpr_read_b32 v115, a39
    v_accvgpr_read_b32 v116, a52
    v_mfma_f32_16x16x32_bf16 v[44:47], a[204:207], v[220:223], v[44:47]
    s_sub_u32 s26, 16777216, s49
    ds_read_b64_tr_b16 a[234:235], v165 offset:20480
    v_accvgpr_read_b32 v117, a53
    v_accvgpr_read_b32 v118, a54
    v_accvgpr_read_b32 v119, a55
    v_mul_f32 v112, v112, v193
    v_mul_f32 v113, v113, v193
    v_mfma_f32_16x16x32_bf16 v[40:43], a[204:207], v[216:219], 0
    s_lshl_b32 s44, s40, 22
    ds_read_b64_tr_b16 a[236:237], v165 offset:24576
    v_mul_f32 v114, v114, v193
    v_mul_f32 v115, v115, v193
    v_mul_f32 v116, v116, v193
    v_mul_f32 v117, v117, v193
    v_mul_f32 v118, v118, v193
    v_mfma_f32_16x16x32_bf16 v[40:43], a[200:203], v[208:211], v[40:43]
    s_waitcnt lgkmcnt(11)
    ds_read_b64_tr_b16 a[238:239], v165 offset:28672
    v_mul_f32 v119, v119, v193
    v_cvt_pk_bf16_f32 v120, v112, v113
    v_cvt_pk_bf16_f32 v121, v114, v115
    v_cvt_pk_bf16_f32 v122, v116, v117
    v_cvt_pk_bf16_f32 v123, v118, v119
    v_mfma_f32_16x16x32_bf16 v[48:51], a[208:211], v[208:211], 0
    s_lshl_b32 s43, s40, 22
    ds_read_b64_tr_b16 a[240:241], v166 offset:16384
    buffer_store_dwordx4 v[120:123], v9, s[32:35], s3 offen offset:1024 sc1
    v_accvgpr_read_b32 v144, a44
    v_accvgpr_read_b32 v145, a45
    v_accvgpr_read_b32 v146, a46
    v_accvgpr_read_b32 v147, a47
    v_mfma_f32_16x16x32_bf16 v[48:51], a[212:215], v[216:219], v[48:51]
    s_lshl_b32 s49, s54, 4
    ds_read_b64_tr_b16 a[242:243], v166 offset:20480
    v_accvgpr_read_b32 v148, a60
    v_accvgpr_read_b32 v149, a61
    v_accvgpr_read_b32 v150, a62
    v_accvgpr_read_b32 v151, a63
    v_mul_f32 v144, v144, v195
    v_mfma_f32_16x16x32_bf16 v[52:55], a[212:215], v[220:223], 0
    s_add_u32 s49, s49, s36
    ds_read_b64_tr_b16 a[244:245], v166 offset:24576
    v_mul_f32 v145, v145, v195
    v_mul_f32 v146, v146, v195
    v_mul_f32 v147, v147, v195
    v_mul_f32 v148, v148, v195
    v_mul_f32 v149, v149, v195
    v_mfma_f32_16x16x32_bf16 v[52:55], a[208:211], v[212:215], v[52:55]
    s_waitcnt lgkmcnt(11)
    ds_read_b64_tr_b16 a[246:247], v166 offset:28672
    v_mul_f32 v150, v150, v195
    v_mul_f32 v151, v151, v195
    v_cvt_pk_bf16_f32 v152, v144, v145
    v_cvt_pk_bf16_f32 v153, v146, v147
    v_cvt_pk_bf16_f32 v154, v148, v149
    v_mfma_f32_16x16x32_bf16 v[60:63], a[216:219], v[212:215], 0
    s_mul_i32 s49, s49, 12288
    ds_read_b64_tr_b16 a[248:249], v167 offset:16384
    v_cvt_pk_bf16_f32 v155, v150, v151
    v_mfma_f32_16x16x32_bf16 v[60:63], a[220:223], v[220:223], v[60:63]
    s_add_u32 s49, s49, 26214400
    ds_read_b64_tr_b16 a[250:251], v167 offset:20480
    buffer_store_dwordx4 v[152:155], v9, s[32:35], s3 offen offset:3072 sc1
    v_mfma_f32_16x16x32_bf16 v[56:59], a[220:223], v[216:219], 0
    s_mov_b32 s3, 262144
    ds_read_b64_tr_b16 a[252:253], v167 offset:24576
    v_accvgpr_read_b32 v96, a64
    v_accvgpr_read_b32 v97, a65
    v_accvgpr_read_b32 v98, a66
    v_accvgpr_read_b32 v99, a67
    v_accvgpr_read_b32 v100, a80
    v_accvgpr_read_b32 v101, a81
    v_accvgpr_read_b32 v102, a82
    v_accvgpr_read_b32 v103, a83
    v_mul_f32 v96, v96, v192
    v_mul_f32 v97, v97, v192
    v_mul_f32 v98, v98, v192
    v_mul_f32 v99, v99, v192
    v_mfma_f32_16x16x32_bf16 v[56:59], a[216:219], v[208:211], v[56:59]
    s_waitcnt lgkmcnt(11)
    ds_read_b64_tr_b16 a[254:255], v167 offset:28672
    v_mul_f32 v100, v100, v192
    v_mul_f32 v101, v101, v192
    v_mul_f32 v102, v102, v192
    v_mul_f32 v103, v103, v192
    v_cvt_pk_bf16_f32 v104, v96, v97
    v_cvt_pk_bf16_f32 v105, v98, v99
    v_mfma_f32_16x16x32_bf16 v[64:67], a[224:227], v[208:211], 0
    s_add_u32 s8, s4, s49
    ds_read_b64_tr_b16 a[192:193], v24 offset:16384
    v_cvt_pk_bf16_f32 v106, v100, v101
    v_cvt_pk_bf16_f32 v107, v102, v103
    v_mfma_f32_16x16x32_bf16 v[64:67], a[228:231], v[216:219], v[64:67]
    s_addc_u32 s9, s5, 0
    ds_read_b64_tr_b16 a[194:195], v24 offset:20480
    buffer_store_dwordx4 v[104:107], v9, s[32:35], s3 offen offset:0 sc1
    v_accvgpr_read_b32 v128, a72
    v_accvgpr_read_b32 v129, a73
    v_accvgpr_read_b32 v130, a74
    v_accvgpr_read_b32 v131, a75
    v_accvgpr_read_b32 v132, a88
    v_accvgpr_read_b32 v133, a89
    v_accvgpr_read_b32 v134, a90
    v_mfma_f32_16x16x32_bf16 v[68:71], a[228:231], v[220:223], 0
    s_mov_b32 s10, 159744
    ds_read_b64_tr_b16 a[196:197], v24 offset:24576
    v_accvgpr_read_b32 v135, a91
    v_mul_f32 v128, v128, v194
    v_mul_f32 v129, v129, v194
    v_mul_f32 v130, v130, v194
    v_mul_f32 v131, v131, v194
    v_mfma_f32_16x16x32_bf16 v[68:71], a[224:227], v[212:215], v[68:71]
    s_waitcnt lgkmcnt(11)
    ds_read_b64_tr_b16 a[198:199], v24 offset:28672
    v_mul_f32 v132, v132, v194
    v_mul_f32 v133, v133, v194
    v_mul_f32 v134, v134, v194
    v_mul_f32 v135, v135, v194
    v_cvt_pk_bf16_f32 v136, v128, v129
    v_mfma_f32_16x16x32_bf16 v[76:79], a[232:235], v[212:215], 0
    s_mov_b32 s12, s62
    ds_read_b64_tr_b16 a[200:201], v25 offset:16384
    v_cvt_pk_bf16_f32 v137, v130, v131
    v_cvt_pk_bf16_f32 v138, v132, v133
    v_cvt_pk_bf16_f32 v139, v134, v135
    v_mfma_f32_16x16x32_bf16 v[76:79], a[236:239], v[220:223], v[76:79]
    s_mov_b32 s13, s63
    ds_read_b64_tr_b16 a[202:203], v25 offset:20480
    buffer_store_dwordx4 v[136:139], v9, s[32:35], s3 offen offset:2048 sc1
    v_accvgpr_read_b32 v112, a68
    v_accvgpr_read_b32 v113, a69
    v_accvgpr_read_b32 v114, a70
    v_accvgpr_read_b32 v115, a71
    v_accvgpr_read_b32 v116, a84
    v_accvgpr_read_b32 v117, a85
    v_mfma_f32_16x16x32_bf16 v[72:75], a[236:239], v[216:219], 0
    s_mov_b32 s6, 0xbfb8aa3b
    ds_read_b64_tr_b16 a[204:205], v25 offset:24576
    v_accvgpr_read_b32 v118, a86
    v_accvgpr_read_b32 v119, a87
    v_mul_f32 v112, v112, v193
    v_mul_f32 v113, v113, v193
    v_mul_f32 v114, v114, v193
    v_mfma_f32_16x16x32_bf16 v[72:75], a[232:235], v[208:211], v[72:75]
    s_waitcnt lgkmcnt(11)
    ds_read_b64_tr_b16 a[206:207], v25 offset:28672
    v_mul_f32 v115, v115, v193
    v_mul_f32 v116, v116, v193
    v_mul_f32 v117, v117, v193
    v_mul_f32 v118, v118, v193
    v_mul_f32 v119, v119, v193
    v_mfma_f32_16x16x32_bf16 v[80:83], a[240:243], v[208:211], 0
    s_mov_b32 s7, 0xbfb8aa3b
    ds_read_b64_tr_b16 a[208:209], v26 offset:16384
    v_cvt_pk_bf16_f32 v120, v112, v113
    v_cvt_pk_bf16_f32 v121, v114, v115
    v_cvt_pk_bf16_f32 v122, v116, v117
    v_cvt_pk_bf16_f32 v123, v118, v119
    v_mfma_f32_16x16x32_bf16 v[80:83], a[244:247], v[216:219], v[80:83]
    s_lshl_b32 s52, s38, 2
    ds_read_b64_tr_b16 a[210:211], v26 offset:20480
    buffer_store_dwordx4 v[120:123], v9, s[32:35], s3 offen offset:1024 sc1
    v_accvgpr_read_b32 v144, a76
    v_accvgpr_read_b32 v145, a77
    v_accvgpr_read_b32 v146, a78
    v_accvgpr_read_b32 v147, a79
    v_accvgpr_read_b32 v148, a92
    v_mfma_f32_16x16x32_bf16 v[84:87], a[244:247], v[220:223], 0
    s_add_u32 s52, s52, s36
    ds_read_b64_tr_b16 a[212:213], v26 offset:24576
    v_accvgpr_read_b32 v149, a93
    v_accvgpr_read_b32 v150, a94
    v_accvgpr_read_b32 v151, a95
    v_mul_f32 v144, v144, v195
    v_mul_f32 v145, v145, v195
    v_mfma_f32_16x16x32_bf16 v[84:87], a[240:243], v[212:215], v[84:87]
    s_waitcnt lgkmcnt(11)
    ds_read_b64_tr_b16 a[214:215], v26 offset:28672
    v_mul_f32 v146, v146, v195
    v_mul_f32 v147, v147, v195
    v_mul_f32 v148, v148, v195
    v_mul_f32 v149, v149, v195
    v_mul_f32 v150, v150, v195
    v_mfma_f32_16x16x32_bf16 v[92:95], a[248:251], v[212:215], 0
    s_lshl_b32 s52, s52, 2
    ds_read_b64_tr_b16 a[216:217], v27 offset:16384
    v_mul_f32 v151, v151, v195
    v_cvt_pk_bf16_f32 v152, v144, v145
    v_cvt_pk_bf16_f32 v153, v146, v147
    v_cvt_pk_bf16_f32 v154, v148, v149
    v_cvt_pk_bf16_f32 v155, v150, v151
    v_mfma_f32_16x16x32_bf16 v[92:95], a[252:255], v[220:223], v[92:95]
    s_add_u32 s52, s52, s40
    ds_read_b64_tr_b16 a[218:219], v27 offset:20480
    buffer_store_dwordx4 v[152:155], v9, s[32:35], s3 offen offset:3072 sc1
    v_mfma_f32_16x16x32_bf16 v[88:91], a[252:255], v[216:219], 0
    s_mov_b32 s3, 393216
    ds_read_b64_tr_b16 a[220:221], v27 offset:24576
    v_accvgpr_read_b32 v96, a96
    v_accvgpr_read_b32 v97, a97
    v_accvgpr_read_b32 v98, a98
    v_accvgpr_read_b32 v99, a99
    v_accvgpr_read_b32 v100, a112
    v_accvgpr_read_b32 v101, a113
    v_accvgpr_read_b32 v102, a114
    v_accvgpr_read_b32 v103, a115
    v_mul_f32 v96, v96, v192
    v_mfma_f32_16x16x32_bf16 v[88:91], a[248:251], v[208:211], v[88:91]
    s_waitcnt lgkmcnt(11)
    ds_read_b64_tr_b16 a[222:223], v27 offset:28672
    v_mul_f32 v97, v97, v192
    v_mul_f32 v98, v98, v192
    v_mul_f32 v99, v99, v192
    v_mul_f32 v100, v100, v192
    v_mul_f32 v101, v101, v192
    v_mfma_f32_16x16x32_bf16 v[32:35], a[192:195], v[224:227], v[32:35]
    s_lshl_b32 s52, s52, 7
    ds_read_b64_tr_b16 a[224:225], v28 offset:16384
    v_mul_f32 v102, v102, v192
    v_mul_f32 v103, v103, v192
    v_cvt_pk_bf16_f32 v104, v96, v97
    v_cvt_pk_bf16_f32 v105, v98, v99
    v_cvt_pk_bf16_f32 v106, v100, v101
    v_mfma_f32_16x16x32_bf16 v[32:35], a[196:199], v[232:235], v[32:35]
    s_add_u32 s52, s52, 8192
    ds_read_b64_tr_b16 a[226:227], v28 offset:20480
    v_cvt_pk_bf16_f32 v107, v102, v103
    v_mfma_f32_16x16x32_bf16 v[36:39], a[196:199], v[236:239], v[36:39]
    s_lshl_b32 s53, s38, 2
    ds_read_b64_tr_b16 a[228:229], v28 offset:24576
    buffer_store_dwordx4 v[104:107], v9, s[32:35], s3 offen offset:0 sc1
    v_accvgpr_read_b32 v128, a104
    v_accvgpr_read_b32 v129, a105
    v_accvgpr_read_b32 v130, a106
    v_accvgpr_read_b32 v131, a107
    v_accvgpr_read_b32 v132, a120
    v_accvgpr_read_b32 v133, a121
    v_accvgpr_read_b32 v134, a122
    v_accvgpr_read_b32 v135, a123
    v_mfma_f32_16x16x32_bf16 v[36:39], a[192:195], v[228:231], v[36:39]
    s_waitcnt lgkmcnt(11)
    ds_read_b64_tr_b16 a[230:231], v28 offset:28672
    v_mul_f32 v128, v128, v194
    v_mul_f32 v129, v129, v194
    v_mul_f32 v130, v130, v194
    v_mul_f32 v131, v131, v194
    v_mul_f32 v132, v132, v194
    v_mfma_f32_16x16x32_bf16 v[44:47], a[200:203], v[228:231], v[44:47]
    s_add_u32 s53, s53, s55
    ds_read_b64_tr_b16 a[232:233], v29 offset:16384
    v_mul_f32 v133, v133, v194
    v_mul_f32 v134, v134, v194
    v_mul_f32 v135, v135, v194
    v_cvt_pk_bf16_f32 v136, v128, v129
    v_cvt_pk_bf16_f32 v137, v130, v131
    v_mfma_f32_16x16x32_bf16 v[44:47], a[204:207], v[236:239], v[44:47]
    s_lshl_b32 s53, s53, 2
    ds_read_b64_tr_b16 a[234:235], v29 offset:20480
    v_cvt_pk_bf16_f32 v138, v132, v133
    v_cvt_pk_bf16_f32 v139, v134, v135
    v_mfma_f32_16x16x32_bf16 v[40:43], a[204:207], v[232:235], v[40:43]
    s_add_u32 s53, s53, s40
    ds_read_b64_tr_b16 a[236:237], v29 offset:24576
    buffer_store_dwordx4 v[136:139], v9, s[32:35], s3 offen offset:2048 sc1
    v_accvgpr_read_b32 v112, a100
    v_accvgpr_read_b32 v113, a101
    v_accvgpr_read_b32 v114, a102
    v_accvgpr_read_b32 v115, a103
    v_accvgpr_read_b32 v116, a116
    v_accvgpr_read_b32 v117, a117
    v_accvgpr_read_b32 v118, a118
    v_mfma_f32_16x16x32_bf16 v[40:43], a[200:203], v[224:227], v[40:43]
    s_waitcnt lgkmcnt(11)
    ds_read_b64_tr_b16 a[238:239], v29 offset:28672
    v_accvgpr_read_b32 v119, a119
    v_mul_f32 v112, v112, v193
    v_mul_f32 v113, v113, v193
    v_mul_f32 v114, v114, v193
    v_mul_f32 v115, v115, v193
    v_mfma_f32_16x16x32_bf16 v[48:51], a[208:211], v[224:227], v[48:51]
    s_lshl_b32 s53, s53, 7
    ds_read_b64_tr_b16 a[240:241], v30 offset:16384
    v_mul_f32 v116, v116, v193
    v_mul_f32 v117, v117, v193
    v_mul_f32 v118, v118, v193
    v_mul_f32 v119, v119, v193
    v_cvt_pk_bf16_f32 v120, v112, v113
    v_mfma_f32_16x16x32_bf16 v[48:51], a[212:215], v[232:235], v[48:51]
    s_add_u32 s53, s53, 8192
    ds_read_b64_tr_b16 a[242:243], v30 offset:20480
    v_cvt_pk_bf16_f32 v121, v114, v115
    v_cvt_pk_bf16_f32 v122, v116, v117
    v_cvt_pk_bf16_f32 v123, v118, v119
    v_mfma_f32_16x16x32_bf16 v[52:55], a[212:215], v[236:239], v[52:55]
    s_and_b32 s49, s37, 7
    ds_read_b64_tr_b16 a[244:245], v30 offset:24576
    buffer_store_dwordx4 v[120:123], v9, s[32:35], s3 offen offset:1024 sc1
    v_accvgpr_read_b32 v144, a108
    v_accvgpr_read_b32 v145, a109
    v_accvgpr_read_b32 v146, a110
    v_accvgpr_read_b32 v147, a111
    v_accvgpr_read_b32 v148, a124
    v_accvgpr_read_b32 v149, a125
    v_mfma_f32_16x16x32_bf16 v[52:55], a[208:211], v[228:231], v[52:55]
    s_waitcnt lgkmcnt(11)
    ds_read_b64_tr_b16 a[246:247], v30 offset:28672
    v_accvgpr_read_b32 v150, a126
    v_accvgpr_read_b32 v151, a127
    v_mul_f32 v144, v144, v195
    v_mul_f32 v145, v145, v195
    v_mul_f32 v146, v146, v195
    v_mfma_f32_16x16x32_bf16 v[60:63], a[216:219], v[228:231], v[60:63]
    s_lshl_b32 s49, s49, 3
    ds_read_b64_tr_b16 a[248:249], v31 offset:16384
    v_mul_f32 v147, v147, v195
    v_mul_f32 v148, v148, v195
    v_mul_f32 v149, v149, v195
    v_mul_f32 v150, v150, v195
    v_mul_f32 v151, v151, v195
    v_mfma_f32_16x16x32_bf16 v[60:63], a[220:223], v[236:239], v[60:63]
    s_add_u32 s52, s52, s49
    ds_read_b64_tr_b16 a[250:251], v31 offset:20480
    v_cvt_pk_bf16_f32 v152, v144, v145
    v_cvt_pk_bf16_f32 v153, v146, v147
    v_cvt_pk_bf16_f32 v154, v148, v149
    v_cvt_pk_bf16_f32 v155, v150, v151
    v_mfma_f32_16x16x32_bf16 v[56:59], a[220:223], v[232:235], v[56:59]
    ds_read_b64_tr_b16 a[252:253], v31 offset:24576
    buffer_store_dwordx4 v[152:155], v9, s[32:35], s3 offen offset:3072 sc1
    v_mfma_f32_16x16x32_bf16 v[56:59], a[216:219], v[224:227], v[56:59]
    s_waitcnt lgkmcnt(11)
    ds_read_b64_tr_b16 a[254:255], v31 offset:28672
    v_mfma_f32_16x16x32_bf16 v[64:67], a[224:227], v[224:227], v[64:67]
    ds_read_b64_tr_b16 a[192:193], v160 offset:32768
    v_mfma_f32_16x16x32_bf16 v[64:67], a[228:231], v[232:235], v[64:67]
    ds_read_b64_tr_b16 a[194:195], v160 offset:36864
    v_mfma_f32_16x16x32_bf16 v[68:71], a[228:231], v[236:239], v[68:71]
    ds_read_b64_tr_b16 a[196:197], v160 offset:40960
    v_mfma_f32_16x16x32_bf16 v[68:71], a[224:227], v[228:231], v[68:71]
    s_waitcnt lgkmcnt(11)
    ds_read_b64_tr_b16 a[198:199], v160 offset:45056
    v_mfma_f32_16x16x32_bf16 v[76:79], a[232:235], v[228:231], v[76:79]
    ds_read_b64_tr_b16 a[200:201], v161 offset:32768
    v_mfma_f32_16x16x32_bf16 v[76:79], a[236:239], v[236:239], v[76:79]
    ds_read_b64_tr_b16 a[202:203], v161 offset:36864
    v_mfma_f32_16x16x32_bf16 v[72:75], a[236:239], v[232:235], v[72:75]
    ds_read_b64_tr_b16 a[204:205], v161 offset:40960
    v_mfma_f32_16x16x32_bf16 v[72:75], a[232:235], v[224:227], v[72:75]
    s_waitcnt lgkmcnt(11)
    ds_read_b64_tr_b16 a[206:207], v161 offset:45056
    v_mfma_f32_16x16x32_bf16 v[80:83], a[240:243], v[224:227], v[80:83]
    ds_read_b64_tr_b16 a[208:209], v162 offset:32768
    v_mfma_f32_16x16x32_bf16 v[80:83], a[244:247], v[232:235], v[80:83]
    ds_read_b64_tr_b16 a[210:211], v162 offset:36864
    v_mfma_f32_16x16x32_bf16 v[84:87], a[244:247], v[236:239], v[84:87]
    ds_read_b64_tr_b16 a[212:213], v162 offset:40960
    v_mfma_f32_16x16x32_bf16 v[84:87], a[240:243], v[228:231], v[84:87]
    s_waitcnt lgkmcnt(11)
    ds_read_b64_tr_b16 a[214:215], v162 offset:45056
    v_mfma_f32_16x16x32_bf16 v[92:95], a[248:251], v[228:231], v[92:95]
    ds_read_b64_tr_b16 a[216:217], v163 offset:32768
    v_mfma_f32_16x16x32_bf16 v[92:95], a[252:255], v[236:239], v[92:95]
    ds_read_b64_tr_b16 a[218:219], v163 offset:36864
    v_mfma_f32_16x16x32_bf16 v[88:91], a[252:255], v[232:235], v[88:91]
    ds_read_b64_tr_b16 a[220:221], v163 offset:40960
    v_mfma_f32_16x16x32_bf16 v[88:91], a[248:251], v[224:227], v[88:91]
    s_waitcnt lgkmcnt(11)
    ds_read_b64_tr_b16 a[222:223], v163 offset:45056
    v_mfma_f32_16x16x32_bf16 v[32:35], a[192:195], v[240:243], v[32:35]
    ds_read_b64_tr_b16 a[224:225], v164 offset:32768
    v_mfma_f32_16x16x32_bf16 v[32:35], a[196:199], v[248:251], v[32:35]
    ds_read_b64_tr_b16 a[226:227], v164 offset:36864
    v_mfma_f32_16x16x32_bf16 v[36:39], a[196:199], v[252:255], v[36:39]
    ds_read_b64_tr_b16 a[228:229], v164 offset:40960
    v_mfma_f32_16x16x32_bf16 v[36:39], a[192:195], v[244:247], v[36:39]
    s_waitcnt lgkmcnt(11)
    ds_read_b64_tr_b16 a[230:231], v164 offset:45056
    v_mfma_f32_16x16x32_bf16 v[44:47], a[200:203], v[244:247], v[44:47]
    ds_read_b64_tr_b16 a[232:233], v165 offset:32768
    v_mfma_f32_16x16x32_bf16 v[44:47], a[204:207], v[252:255], v[44:47]
    ds_read_b64_tr_b16 a[234:235], v165 offset:36864
    v_mfma_f32_16x16x32_bf16 v[40:43], a[204:207], v[248:251], v[40:43]
    ds_read_b64_tr_b16 a[236:237], v165 offset:40960
    v_mfma_f32_16x16x32_bf16 v[40:43], a[200:203], v[240:243], v[40:43]
    s_waitcnt lgkmcnt(11)
    ds_read_b64_tr_b16 a[238:239], v165 offset:45056
    v_mfma_f32_16x16x32_bf16 v[48:51], a[208:211], v[240:243], v[48:51]
    ds_read_b64_tr_b16 a[240:241], v166 offset:32768
    v_mfma_f32_16x16x32_bf16 v[48:51], a[212:215], v[248:251], v[48:51]
    ds_read_b64_tr_b16 a[242:243], v166 offset:36864
    v_mfma_f32_16x16x32_bf16 v[52:55], a[212:215], v[252:255], v[52:55]
    ds_read_b64_tr_b16 a[244:245], v166 offset:40960
    v_mfma_f32_16x16x32_bf16 v[52:55], a[208:211], v[244:247], v[52:55]
    s_waitcnt lgkmcnt(11)
    ds_read_b64_tr_b16 a[246:247], v166 offset:45056
    v_mfma_f32_16x16x32_bf16 v[60:63], a[216:219], v[244:247], v[60:63]
    ds_read_b64_tr_b16 a[248:249], v167 offset:32768
    v_mfma_f32_16x16x32_bf16 v[60:63], a[220:223], v[252:255], v[60:63]
    ds_read_b64_tr_b16 a[250:251], v167 offset:36864
    v_mfma_f32_16x16x32_bf16 v[56:59], a[220:223], v[248:251], v[56:59]
    ds_read_b64_tr_b16 a[252:253], v167 offset:40960
    v_mfma_f32_16x16x32_bf16 v[56:59], a[216:219], v[240:243], v[56:59]
    s_waitcnt lgkmcnt(11)
    ds_read_b64_tr_b16 a[254:255], v167 offset:45056
    s_waitcnt vmcnt(0)
    v_lshlrev_b32 v7, 2, v0
    s_mov_b64 exec, 3
    buffer_store_dword v22, v7, s[28:31], s52 offen sc1
    s_mov_b64 exec, -1
    v_mfma_f32_16x16x32_bf16 v[64:67], a[224:227], v[240:243], v[64:67]
    s_barrier
    ds_read_b64_tr_b16 a[192:193], v24 offset:32768
    v_and_b32 v7, 15, v0
    v_mfma_f32_16x16x32_bf16 v[64:67], a[228:231], v[248:251], v[64:67]
    s_add_u32 m0, s39, 0
    ds_read_b64_tr_b16 a[194:195], v24 offset:36864
    buffer_load_dwordx4 v14, s[20:23], s45 offen offset:0 lds
    v_mfma_f32_16x16x32_bf16 v[68:71], a[228:231], v[252:255], v[68:71]
    ds_read_b64_tr_b16 a[196:197], v24 offset:40960
    v_lshlrev_b32 v7, 2, v7
    v_mfma_f32_16x16x32_bf16 v[68:71], a[224:227], v[244:247], v[68:71]
    s_waitcnt lgkmcnt(11)
    ds_read_b64_tr_b16 a[198:199], v24 offset:45056
    v_add_u32 v1, 65536, v24
    v_mfma_f32_16x16x32_bf16 v[76:79], a[232:235], v[244:247], v[76:79]
    ds_read_b64_tr_b16 a[200:201], v25 offset:32768
    v_add_u32 v2, 65536, v25
    v_mfma_f32_16x16x32_bf16 v[76:79], a[236:239], v[252:255], v[76:79]
    ds_read_b64_tr_b16 a[202:203], v25 offset:36864
    buffer_load_dwordx4 v15, s[20:23], s45 offen offset:1024 lds
    v_mfma_f32_16x16x32_bf16 v[72:75], a[236:239], v[248:251], v[72:75]
    ds_read_b64_tr_b16 a[204:205], v25 offset:40960
    v_add_u32 v3, 65536, v26
    v_mfma_f32_16x16x32_bf16 v[72:75], a[232:235], v[240:243], v[72:75]
    s_waitcnt lgkmcnt(11)
    ds_read_b64_tr_b16 a[206:207], v25 offset:45056
    v_add_u32 v4, 65536, v27
    v_mfma_f32_16x16x32_bf16 v[80:83], a[240:243], v[240:243], v[80:83]
    ds_read_b64_tr_b16 a[208:209], v26 offset:32768
    v_add_u32 v5, 65536, v28
    v_mfma_f32_16x16x32_bf16 v[80:83], a[244:247], v[248:251], v[80:83]
    ds_read_b64_tr_b16 a[210:211], v26 offset:36864
    buffer_load_dwordx4 v16, s[20:23], s45 offen offset:2048 lds
    v_mfma_f32_16x16x32_bf16 v[84:87], a[244:247], v[252:255], v[84:87]
    ds_read_b64_tr_b16 a[212:213], v26 offset:40960
    v_add_u32 v6, 65536, v29
    v_mfma_f32_16x16x32_bf16 v[84:87], a[240:243], v[244:247], v[84:87]
    s_waitcnt lgkmcnt(11)
    ds_read_b64_tr_b16 a[214:215], v26 offset:45056
    v_add_u32 v10, 65536, v30
    v_mfma_f32_16x16x32_bf16 v[92:95], a[248:251], v[244:247], v[92:95]
    ds_read_b64_tr_b16 a[216:217], v27 offset:32768
    v_add_u32 v11, 65536, v31
    v_mfma_f32_16x16x32_bf16 v[92:95], a[252:255], v[252:255], v[92:95]
    ds_read_b64_tr_b16 a[218:219], v27 offset:36864
    buffer_load_dwordx4 v17, s[20:23], s45 offen offset:3072 lds
    v_mfma_f32_16x16x32_bf16 v[88:91], a[252:255], v[248:251], v[88:91]
    s_add_u32 s45, s45, 65536
    ds_read_b64_tr_b16 a[220:221], v27 offset:40960
    v_mfma_f32_16x16x32_bf16 v[88:91], a[248:251], v[240:243], v[88:91]
    s_waitcnt lgkmcnt(11)
    ds_read_b64_tr_b16 a[222:223], v27 offset:45056
    v_mfma_f32_16x16x32_bf16 v[32:35], a[192:195], a[148:151], v[32:35]
    s_add_u32 m0, s39, 65536
    ds_read_b64_tr_b16 a[224:225], v28 offset:32768
    v_mfma_f32_16x16x32_bf16 v[32:35], a[196:199], a[156:159], v[32:35]
    ds_read_b64_tr_b16 a[226:227], v28 offset:36864
    buffer_load_dwordx4 v14, s[20:23], s45 offen offset:0 lds
    v_mfma_f32_16x16x32_bf16 v[36:39], a[196:199], a[160:163], v[36:39]
    ds_read_b64_tr_b16 a[228:229], v28 offset:40960
    v_mfma_f32_16x16x32_bf16 v[36:39], a[192:195], a[152:155], v[36:39]
    s_waitcnt lgkmcnt(11)
    ds_read_b64_tr_b16 a[230:231], v28 offset:45056
    v_mfma_f32_16x16x32_bf16 v[44:47], a[200:203], a[152:155], v[44:47]
    ds_read_b64_tr_b16 a[232:233], v29 offset:32768
    v_mfma_f32_16x16x32_bf16 v[44:47], a[204:207], a[160:163], v[44:47]
    ds_read_b64_tr_b16 a[234:235], v29 offset:36864
    buffer_load_dwordx4 v15, s[20:23], s45 offen offset:1024 lds
    v_mfma_f32_16x16x32_bf16 v[40:43], a[204:207], a[156:159], v[40:43]
    ds_read_b64_tr_b16 a[236:237], v29 offset:40960
    v_mfma_f32_16x16x32_bf16 v[40:43], a[200:203], a[148:151], v[40:43]
    s_waitcnt lgkmcnt(11)
    ds_read_b64_tr_b16 a[238:239], v29 offset:45056
    v_mfma_f32_16x16x32_bf16 v[48:51], a[208:211], a[148:151], v[48:51]
    ds_read_b64_tr_b16 a[240:241], v30 offset:32768
    v_mfma_f32_16x16x32_bf16 v[48:51], a[212:215], a[156:159], v[48:51]
    ds_read_b64_tr_b16 a[242:243], v30 offset:36864
    buffer_load_dwordx4 v16, s[20:23], s45 offen offset:2048 lds
    v_mfma_f32_16x16x32_bf16 v[52:55], a[212:215], a[160:163], v[52:55]
    ds_read_b64_tr_b16 a[244:245], v30 offset:40960
    v_mfma_f32_16x16x32_bf16 v[52:55], a[208:211], a[152:155], v[52:55]
    s_waitcnt lgkmcnt(11)
    ds_read_b64_tr_b16 a[246:247], v30 offset:45056
    v_mfma_f32_16x16x32_bf16 v[60:63], a[216:219], a[152:155], v[60:63]
    ds_read_b64_tr_b16 a[248:249], v31 offset:32768
    v_mfma_f32_16x16x32_bf16 v[60:63], a[220:223], a[160:163], v[60:63]
    ds_read_b64_tr_b16 a[250:251], v31 offset:36864
    buffer_load_dwordx4 v17, s[20:23], s45 offen offset:3072 lds
    v_mfma_f32_16x16x32_bf16 v[56:59], a[220:223], a[156:159], v[56:59]
    s_add_u32 s45, s45, 65536
    ds_read_b64_tr_b16 a[252:253], v31 offset:40960
    v_mfma_f32_16x16x32_bf16 v[56:59], a[216:219], a[148:151], v[56:59]
    s_waitcnt lgkmcnt(11)
    ds_read_b64_tr_b16 a[254:255], v31 offset:45056
    v_mfma_f32_16x16x32_bf16 v[64:67], a[224:227], a[148:151], v[64:67]
    s_add_u32 m0, s39, 16384
    ds_read_b64_tr_b16 a[192:193], v160 offset:49152
    v_mfma_f32_16x16x32_bf16 v[64:67], a[228:231], a[156:159], v[64:67]
    ds_read_b64_tr_b16 a[194:195], v160 offset:53248
    buffer_load_dwordx4 v14, s[20:23], s45 offen offset:0 lds
    v_mfma_f32_16x16x32_bf16 v[68:71], a[228:231], a[160:163], v[68:71]
    ds_read_b64_tr_b16 a[196:197], v160 offset:57344
    v_mfma_f32_16x16x32_bf16 v[68:71], a[224:227], a[152:155], v[68:71]
    s_waitcnt lgkmcnt(11)
    ds_read_b64_tr_b16 a[198:199], v160 offset:61440
    v_mfma_f32_16x16x32_bf16 v[76:79], a[232:235], a[152:155], v[76:79]
    ds_read_b64_tr_b16 a[200:201], v161 offset:49152
    v_mfma_f32_16x16x32_bf16 v[76:79], a[236:239], a[160:163], v[76:79]
    ds_read_b64_tr_b16 a[202:203], v161 offset:53248
    buffer_load_dwordx4 v15, s[20:23], s45 offen offset:1024 lds
    v_mfma_f32_16x16x32_bf16 v[72:75], a[236:239], a[156:159], v[72:75]
    ds_read_b64_tr_b16 a[204:205], v161 offset:57344
    v_mfma_f32_16x16x32_bf16 v[72:75], a[232:235], a[148:151], v[72:75]
    s_waitcnt lgkmcnt(11)
    ds_read_b64_tr_b16 a[206:207], v161 offset:61440
    v_mfma_f32_16x16x32_bf16 v[80:83], a[240:243], a[148:151], v[80:83]
    ds_read_b64_tr_b16 a[208:209], v162 offset:49152
    v_mfma_f32_16x16x32_bf16 v[80:83], a[244:247], a[156:159], v[80:83]
    ds_read_b64_tr_b16 a[210:211], v162 offset:53248
    buffer_load_dwordx4 v16, s[20:23], s45 offen offset:2048 lds
    v_mfma_f32_16x16x32_bf16 v[84:87], a[244:247], a[160:163], v[84:87]
    ds_read_b64_tr_b16 a[212:213], v162 offset:57344
    v_mfma_f32_16x16x32_bf16 v[84:87], a[240:243], a[152:155], v[84:87]
    s_waitcnt lgkmcnt(11)
    ds_read_b64_tr_b16 a[214:215], v162 offset:61440
    v_mfma_f32_16x16x32_bf16 v[92:95], a[248:251], a[152:155], v[92:95]
    ds_read_b64_tr_b16 a[216:217], v163 offset:49152
    v_mfma_f32_16x16x32_bf16 v[92:95], a[252:255], a[160:163], v[92:95]
    ds_read_b64_tr_b16 a[218:219], v163 offset:53248
    buffer_load_dwordx4 v17, s[20:23], s45 offen offset:3072 lds
    v_mfma_f32_16x16x32_bf16 v[88:91], a[252:255], a[156:159], v[88:91]
    s_add_u32 s45, s45, 65536
    ds_read_b64_tr_b16 a[220:221], v163 offset:57344
    v_mfma_f32_16x16x32_bf16 v[88:91], a[248:251], a[148:151], v[88:91]
    s_waitcnt lgkmcnt(11)
    ds_read_b64_tr_b16 a[222:223], v163 offset:61440
    v_mfma_f32_16x16x32_bf16 v[32:35], a[192:195], a[164:167], v[32:35]
    s_add_u32 m0, s39, 81920
    ds_read_b64_tr_b16 a[224:225], v164 offset:49152
    v_mfma_f32_16x16x32_bf16 v[32:35], a[196:199], a[172:175], v[32:35]
    ds_read_b64_tr_b16 a[226:227], v164 offset:53248
    buffer_load_dwordx4 v14, s[20:23], s45 offen offset:0 lds
    v_mfma_f32_16x16x32_bf16 v[36:39], a[196:199], a[176:179], v[36:39]
    ds_read_b64_tr_b16 a[228:229], v164 offset:57344
    v_mfma_f32_16x16x32_bf16 v[36:39], a[192:195], a[168:171], v[36:39]
    s_waitcnt lgkmcnt(11)
    ds_read_b64_tr_b16 a[230:231], v164 offset:61440
    v_mfma_f32_16x16x32_bf16 v[44:47], a[200:203], a[168:171], v[44:47]
    ds_read_b64_tr_b16 a[232:233], v165 offset:49152
    v_mfma_f32_16x16x32_bf16 v[44:47], a[204:207], a[176:179], v[44:47]
    ds_read_b64_tr_b16 a[234:235], v165 offset:53248
    buffer_load_dwordx4 v15, s[20:23], s45 offen offset:1024 lds
    v_mfma_f32_16x16x32_bf16 v[40:43], a[204:207], a[172:175], v[40:43]
    ds_read_b64_tr_b16 a[236:237], v165 offset:57344
    v_mfma_f32_16x16x32_bf16 v[40:43], a[200:203], a[164:167], v[40:43]
    s_waitcnt lgkmcnt(11)
    ds_read_b64_tr_b16 a[238:239], v165 offset:61440
    v_mfma_f32_16x16x32_bf16 v[48:51], a[208:211], a[164:167], v[48:51]
    ds_read_b64_tr_b16 a[240:241], v166 offset:49152
    v_mfma_f32_16x16x32_bf16 v[48:51], a[212:215], a[172:175], v[48:51]
    ds_read_b64_tr_b16 a[242:243], v166 offset:53248
    buffer_load_dword v8, v7, s[28:31], s53 offen sc1
    v_mfma_f32_16x16x32_bf16 v[52:55], a[212:215], a[176:179], v[52:55]
    ds_read_b64_tr_b16 a[244:245], v166 offset:57344
    v_mfma_f32_16x16x32_bf16 v[52:55], a[208:211], a[168:171], v[52:55]
    s_waitcnt lgkmcnt(11)
    ds_read_b64_tr_b16 a[246:247], v166 offset:61440
    v_mfma_f32_16x16x32_bf16 v[60:63], a[216:219], a[168:171], v[60:63]
    ds_read_b64_tr_b16 a[248:249], v167 offset:49152
    v_mfma_f32_16x16x32_bf16 v[60:63], a[220:223], a[176:179], v[60:63]
    ds_read_b64_tr_b16 a[250:251], v167 offset:53248
    buffer_load_dwordx4 v16, s[20:23], s45 offen offset:2048 lds
    v_mfma_f32_16x16x32_bf16 v[56:59], a[220:223], a[172:175], v[56:59]
    ds_read_b64_tr_b16 a[252:253], v167 offset:57344
    v_mfma_f32_16x16x32_bf16 v[56:59], a[216:219], a[164:167], v[56:59]
    s_waitcnt lgkmcnt(11)
    ds_read_b64_tr_b16 a[254:255], v167 offset:61440
    v_mfma_f32_16x16x32_bf16 v[64:67], a[224:227], a[164:167], v[64:67]
    ds_read_b64_tr_b16 a[192:193], v24 offset:49152
    v_mfma_f32_16x16x32_bf16 v[64:67], a[228:231], a[172:175], v[64:67]
    ds_read_b64_tr_b16 a[194:195], v24 offset:53248
    buffer_load_dwordx4 v17, s[20:23], s45 offen offset:3072 lds
    v_mfma_f32_16x16x32_bf16 v[68:71], a[228:231], a[176:179], v[68:71]
    s_add_u32 s45, s45, 65536
    ds_read_b64_tr_b16 a[196:197], v25 offset:49152
    v_mfma_f32_16x16x32_bf16 v[68:71], a[224:227], a[168:171], v[68:71]
    s_waitcnt lgkmcnt(11)
    ds_read_b64_tr_b16 a[198:199], v25 offset:53248
    v_mfma_f32_16x16x32_bf16 v[76:79], a[232:235], a[168:171], v[76:79]
    s_barrier
    ds_read_b64_tr_b16 a[200:201], v26 offset:49152
    v_mfma_f32_16x16x32_bf16 v[76:79], a[236:239], a[176:179], v[76:79]
    s_add_u32 m0, s39, 32768
    ds_read_b64_tr_b16 a[202:203], v26 offset:53248
    buffer_load_dwordx4 v14, s[20:23], s45 offen offset:0 lds
    v_mfma_f32_16x16x32_bf16 v[72:75], a[236:239], a[172:175], v[72:75]
    ds_read_b64_tr_b16 a[204:205], v27 offset:49152
    v_mfma_f32_16x16x32_bf16 v[72:75], a[232:235], a[164:167], v[72:75]
    s_waitcnt lgkmcnt(11)
    ds_read_b64_tr_b16 a[206:207], v27 offset:53248
    v_mfma_f32_16x16x32_bf16 v[80:83], a[240:243], a[164:167], v[80:83]
    ds_read_b64_tr_b16 a[208:209], v28 offset:49152
    v_mfma_f32_16x16x32_bf16 v[80:83], a[244:247], a[172:175], v[80:83]
    ds_read_b64_tr_b16 a[210:211], v28 offset:53248
    buffer_load_dwordx4 v15, s[20:23], s45 offen offset:1024 lds
    v_mfma_f32_16x16x32_bf16 v[84:87], a[244:247], a[176:179], v[84:87]
    ds_read_b64_tr_b16 a[212:213], v29 offset:49152
    v_mfma_f32_16x16x32_bf16 v[84:87], a[240:243], a[168:171], v[84:87]
    s_waitcnt lgkmcnt(11)
    ds_read_b64_tr_b16 a[214:215], v29 offset:53248
    v_mfma_f32_16x16x32_bf16 v[92:95], a[248:251], a[168:171], v[92:95]
    ds_read_b64_tr_b16 a[216:217], v30 offset:49152
    v_mfma_f32_16x16x32_bf16 v[92:95], a[252:255], a[176:179], v[92:95]
    ds_read_b64_tr_b16 a[218:219], v30 offset:53248
    buffer_load_dwordx4 v16, s[20:23], s45 offen offset:2048 lds
    v_mfma_f32_16x16x32_bf16 v[88:91], a[252:255], a[172:175], v[88:91]
    ds_read_b64_tr_b16 a[220:221], v31 offset:49152
    v_mfma_f32_16x16x32_bf16 v[88:91], a[248:251], a[164:167], v[88:91]
    s_waitcnt lgkmcnt(11)
    ds_read_b64_tr_b16 a[222:223], v31 offset:53248
    s_waitcnt vmcnt(5)
    v_cmp_ne_u32 vcc, v22, v8
    s_nop 1
    s_cbranch_vccz L_ook
    s_mov_b32 s49, 262144
L_po:
    buffer_load_dword v8, v7, s[28:31], s53 offen sc1
    s_sub_u32 s49, s49, 1
    s_cbranch_scc1 L_po_x
    s_waitcnt vmcnt(0)
    v_cmp_ne_u32 vcc, v22, v8
    s_nop 1
    s_cbranch_vccnz L_po
L_po_x:
L_ook:
    buffer_load_dwordx4 a[0:3], v9, s[24:27], s44 offen offset:0 sc1
    buffer_load_dwordx4 a[4:7], v9, s[24:27], s44 offen offset:1024 sc1
    s_add_u32 s44, s44, 131072
    buffer_load_dwordx4 a[8:11], v9, s[24:27], s44 offen offset:0 sc1
    buffer_load_dwordx4 a[12:15], v9, s[24:27], s44 offen offset:1024 sc1
    s_add_u32 s44, s44, 131072
    buffer_load_dwordx4 a[16:19], v9, s[24:27], s44 offen offset:0 sc1
    buffer_load_dwordx4 a[20:23], v9, s[24:27], s44 offen offset:1024 sc1
    s_add_u32 s44, s44, 131072
    buffer_load_dwordx4 a[24:27], v9, s[24:27], s44 offen offset:0 sc1
    buffer_load_dwordx4 a[28:31], v9, s[24:27], s44 offen offset:1024 sc1
    s_add_u32 s44, s44, 131072
    v_mfma_f32_16x16x32_bf16 v[32:35], a[192:195], a[180:183], v[32:35]
    ds_read_b64_tr_b16 a[224:225], v1 offset:0
    v_mfma_f32_16x16x32_bf16 v[36:39], a[192:195], a[184:187], v[36:39]
    ds_read_b64_tr_b16 a[226:227], v1 offset:4096
    buffer_load_dwordx4 v17, s[20:23], s45 offen offset:3072 lds
    v_mfma_f32_16x16x32_bf16 v[44:47], a[196:199], a[184:187], v[44:47]
    s_add_u32 s45, s45, 65536
    ds_read_b64_tr_b16 a[228:229], v1 offset:8192
    v_mfma_f32_16x16x32_bf16 v[40:43], a[196:199], a[180:183], v[40:43]
    s_waitcnt lgkmcnt(11)
    ds_read_b64_tr_b16 a[230:231], v1 offset:12288
    v_mfma_f32_16x16x32_bf16 v[48:51], a[200:203], a[180:183], v[48:51]
    s_add_u32 m0, s39, 98304
    ds_read_b64_tr_b16 a[232:233], v2 offset:0
    v_mfma_f32_16x16x32_bf16 v[52:55], a[200:203], a[184:187], v[52:55]
    ds_read_b64_tr_b16 a[234:235], v2 offset:4096
    buffer_load_dwordx4 v14, s[20:23], s45 offen offset:0 lds
    v_mfma_f32_16x16x32_bf16 v[60:63], a[204:207], a[184:187], v[60:63]
    ds_read_b64_tr_b16 a[236:237], v2 offset:8192
    v_mfma_f32_16x16x32_bf16 v[56:59], a[204:207], a[180:183], v[56:59]
    s_waitcnt lgkmcnt(11)
    ds_read_b64_tr_b16 a[238:239], v2 offset:12288
    v_mfma_f32_16x16x32_bf16 v[64:67], a[208:211], a[180:183], v[64:67]
    ds_read_b64_tr_b16 a[240:241], v3 offset:0
    v_mfma_f32_16x16x32_bf16 v[68:71], a[208:211], a[184:187], v[68:71]
    ds_read_b64_tr_b16 a[242:243], v3 offset:4096
    buffer_load_dwordx4 v15, s[20:23], s45 offen offset:1024 lds
    v_mfma_f32_16x16x32_bf16 v[76:79], a[212:215], a[184:187], v[76:79]
    ds_read_b64_tr_b16 a[244:245], v3 offset:8192
    v_mfma_f32_16x16x32_bf16 v[72:75], a[212:215], a[180:183], v[72:75]
    s_waitcnt lgkmcnt(11)
    ds_read_b64_tr_b16 a[246:247], v3 offset:12288
    v_mfma_f32_16x16x32_bf16 v[80:83], a[216:219], a[180:183], v[80:83]
    ds_read_b64_tr_b16 a[248:249], v4 offset:0
    v_mfma_f32_16x16x32_bf16 v[84:87], a[216:219], a[184:187], v[84:87]
    ds_read_b64_tr_b16 a[250:251], v4 offset:4096
    buffer_load_dwordx4 v16, s[20:23], s45 offen offset:2048 lds
    v_mfma_f32_16x16x32_bf16 v[92:95], a[220:223], a[184:187], v[92:95]
    ds_read_b64_tr_b16 a[252:253], v4 offset:8192
    v_mfma_f32_16x16x32_bf16 v[88:91], a[220:223], a[180:183], v[88:91]
    s_waitcnt lgkmcnt(11)
    ds_read_b64_tr_b16 a[254:255], v4 offset:12288
    s_waitcnt vmcnt(8)
    v_mfma_f32_16x16x32_bf16 v[96:99], a[224:227], a[0:3], 0
    ds_read_b64_tr_b16 a[192:193], v5 offset:0
    v_mfma_f32_16x16x32_bf16 v[96:99], a[228:231], a[8:11], v[96:99]
    ds_read_b64_tr_b16 a[194:195], v5 offset:4096
    buffer_load_dwordx4 a[32:35], v9, s[24:27], s44 offen offset:0 sc1
    v_mfma_f32_16x16x32_bf16 v[100:103], a[228:231], a[12:15], 0
    ds_read_b64_tr_b16 a[196:197], v5 offset:8192
    v_mfma_f32_16x16x32_bf16 v[100:103], a[224:227], a[4:7], v[100:103]
    s_waitcnt lgkmcnt(11)
    ds_read_b64_tr_b16 a[198:199], v5 offset:12288
    v_mfma_f32_16x16x32_bf16 v[108:111], a[232:235], a[4:7], 0
    ds_read_b64_tr_b16 a[200:201], v6 offset:0
    v_mfma_f32_16x16x32_bf16 v[108:111], a[236:239], a[12:15], v[108:111]
    ds_read_b64_tr_b16 a[202:203], v6 offset:4096
    buffer_load_dwordx4 a[36:39], v9, s[24:27], s44 offen offset:1024 sc1
    v_mfma_f32_16x16x32_bf16 v[104:107], a[236:239], a[8:11], 0
    s_add_u32 s44, s44, 131072
    ds_read_b64_tr_b16 a[204:205], v6 offset:8192
    v_mfma_f32_16x16x32_bf16 v[104:107], a[232:235], a[0:3], v[104:107]
    s_waitcnt lgkmcnt(11)
    ds_read_b64_tr_b16 a[206:207], v6 offset:12288
    v_mfma_f32_16x16x32_bf16 v[112:115], a[240:243], a[0:3], 0
    ds_read_b64_tr_b16 a[208:209], v10 offset:0
    v_cvt_pk_bf16_f32 v168, v48, v49
    v_mfma_f32_16x16x32_bf16 v[112:115], a[244:247], a[8:11], v[112:115]
    ds_read_b64_tr_b16 a[210:211], v10 offset:4096
    buffer_load_dwordx4 a[40:43], v9, s[24:27], s44 offen offset:0 sc1
    v_mfma_f32_16x16x32_bf16 v[116:119], a[244:247], a[12:15], 0
    ds_read_b64_tr_b16 a[212:213], v10 offset:8192
    v_cvt_pk_bf16_f32 v169, v50, v51
    v_mfma_f32_16x16x32_bf16 v[116:119], a[240:243], a[4:7], v[116:119]
    s_waitcnt lgkmcnt(11)
    ds_read_b64_tr_b16 a[214:215], v10 offset:12288
    v_cvt_pk_bf16_f32 v170, v52, v53
    v_mfma_f32_16x16x32_bf16 v[124:127], a[248:251], a[4:7], 0
    ds_read_b64_tr_b16 a[216:217], v11 offset:0
    v_cvt_pk_bf16_f32 v171, v54, v55
    v_mfma_f32_16x16x32_bf16 v[124:127], a[252:255], a[12:15], v[124:127]
    ds_read_b64_tr_b16 a[218:219], v11 offset:4096
    buffer_load_dwordx4 a[44:47], v9, s[24:27], s44 offen offset:1024 sc1
    v_mfma_f32_16x16x32_bf16 v[120:123], a[252:255], a[8:11], 0
    s_add_u32 s44, s44, 131072
    ds_read_b64_tr_b16 a[220:221], v11 offset:8192
    v_cvt_pk_bf16_f32 v172, v56, v57
    v_mfma_f32_16x16x32_bf16 v[120:123], a[248:251], a[0:3], v[120:123]
    s_waitcnt lgkmcnt(11)
    ds_read_b64_tr_b16 a[222:223], v11 offset:12288
    v_cvt_pk_bf16_f32 v173, v58, v59
    v_mfma_f32_16x16x32_bf16 v[128:131], a[192:195], a[0:3], 0
    ds_read_b64_tr_b16 a[224:225], v1 offset:16384
    v_cvt_pk_bf16_f32 v174, v60, v61
    v_mfma_f32_16x16x32_bf16 v[128:131], a[196:199], a[8:11], v[128:131]
    ds_read_b64_tr_b16 a[226:227], v1 offset:20480
    buffer_load_dwordx4 a[48:51], v9, s[24:27], s44 offen offset:0 sc1
    v_mfma_f32_16x16x32_bf16 v[132:135], a[196:199], a[12:15], 0
    ds_read_b64_tr_b16 a[228:229], v1 offset:24576
    v_cvt_pk_bf16_f32 v175, v62, v63
    v_mfma_f32_16x16x32_bf16 v[132:135], a[192:195], a[4:7], v[132:135]
    s_waitcnt lgkmcnt(11)
    ds_read_b64_tr_b16 a[230:231], v1 offset:28672
    v_cvt_pk_bf16_f32 v176, v64, v65
    v_mfma_f32_16x16x32_bf16 v[140:143], a[200:203], a[4:7], 0
    ds_read_b64_tr_b16 a[232:233], v2 offset:16384
    v_cvt_pk_bf16_f32 v177, v66, v67
    v_mfma_f32_16x16x32_bf16 v[140:143], a[204:207], a[12:15], v[140:143]
    ds_read_b64_tr_b16 a[234:235], v2 offset:20480
    buffer_load_dwordx4 a[52:55], v9, s[24:27], s44 offen offset:1024 sc1
    v_mfma_f32_16x16x32_bf16 v[136:139], a[204:207], a[8:11], 0
    s_add_u32 s44, s44, 131072
    ds_read_b64_tr_b16 a[236:237], v2 offset:24576
    v_cvt_pk_bf16_f32 v178, v68, v69
    v_mfma_f32_16x16x32_bf16 v[136:139], a[200:203], a[0:3], v[136:139]
    s_waitcnt lgkmcnt(11)
    ds_read_b64_tr_b16 a[238:239], v2 offset:28672
    v_cvt_pk_bf16_f32 v179, v70, v71
    v_mfma_f32_16x16x32_bf16 v[144:147], a[208:211], a[0:3], 0
    ds_read_b64_tr_b16 a[240:241], v3 offset:16384
    v_cvt_pk_bf16_f32 v180, v72, v73
    v_mfma_f32_16x16x32_bf16 v[144:147], a[212:215], a[8:11], v[144:147]
    ds_read_b64_tr_b16 a[242:243], v3 offset:20480
    buffer_load_dwordx4 a[56:59], v9, s[24:27], s44 offen offset:0 sc1
    v_mfma_f32_16x16x32_bf16 v[148:151], a[212:215], a[12:15], 0
    ds_read_b64_tr_b16 a[244:245], v3 offset:24576
    v_cvt_pk_bf16_f32 v181, v74, v75
    v_mfma_f32_16x16x32_bf16 v[148:151], a[208:211], a[4:7], v[148:151]
    s_waitcnt lgkmcnt(11)
    ds_read_b64_tr_b16 a[246:247], v3 offset:28672
    v_cvt_pk_bf16_f32 v182, v76, v77
    v_mfma_f32_16x16x32_bf16 v[156:159], a[216:219], a[4:7], 0
    ds_read_b64_tr_b16 a[248:249], v4 offset:16384
    v_cvt_pk_bf16_f32 v183, v78, v79
    v_mfma_f32_16x16x32_bf16 v[156:159], a[220:223], a[12:15], v[156:159]
    ds_read_b64_tr_b16 a[250:251], v4 offset:20480
    buffer_load_dwordx4 a[60:63], v9, s[24:27], s44 offen offset:1024 sc1
    v_mfma_f32_16x16x32_bf16 v[152:155], a[220:223], a[8:11], 0
    s_add_u32 s44, s44, 131072
    ds_read_b64_tr_b16 a[252:253], v4 offset:24576
    v_cvt_pk_bf16_f32 v184, v80, v81
    v_mfma_f32_16x16x32_bf16 v[152:155], a[216:219], a[0:3], v[152:155]
    s_waitcnt lgkmcnt(11)
    ds_read_b64_tr_b16 a[254:255], v4 offset:28672
    v_cvt_pk_bf16_f32 v185, v82, v83
    s_waitcnt vmcnt(12)
    v_mfma_f32_16x16x32_bf16 v[96:99], a[224:227], a[16:19], v[96:99]
    ds_read_b64_tr_b16 a[192:193], v5 offset:16384
    v_cvt_pk_bf16_f32 v186, v84, v85
    v_mfma_f32_16x16x32_bf16 v[96:99], a[228:231], a[24:27], v[96:99]
    ds_read_b64_tr_b16 a[194:195], v5 offset:20480
    buffer_load_dwordx4 a[64:67], v9, s[24:27], s44 offen offset:0 sc1
    v_mfma_f32_16x16x32_bf16 v[100:103], a[228:231], a[28:31], v[100:103]
    ds_read_b64_tr_b16 a[196:197], v5 offset:24576
    v_cvt_pk_bf16_f32 v187, v86, v87
    v_mfma_f32_16x16x32_bf16 v[100:103], a[224:227], a[20:23], v[100:103]
    s_waitcnt lgkmcnt(11)
    ds_read_b64_tr_b16 a[198:199], v5 offset:28672
    v_cvt_pk_bf16_f32 v188, v88, v89
    v_mfma_f32_16x16x32_bf16 v[108:111], a[232:235], a[20:23], v[108:111]
    ds_read_b64_tr_b16 a[200:201], v6 offset:16384
    v_cvt_pk_bf16_f32 v189, v90, v91
    v_mfma_f32_16x16x32_bf16 v[108:111], a[236:239], a[28:31], v[108:111]
    ds_read_b64_tr_b16 a[202:203], v6 offset:20480
    buffer_load_dwordx4 a[68:71], v9, s[24:27], s44 offen offset:1024 sc1
    v_mfma_f32_16x16x32_bf16 v[104:107], a[236:239], a[24:27], v[104:107]
    s_add_u32 s44, s44, 131072
    ds_read_b64_tr_b16 a[204:205], v6 offset:24576
    v_cvt_pk_bf16_f32 v190, v92, v93
    v_mfma_f32_16x16x32_bf16 v[104:107], a[232:235], a[16:19], v[104:107]
    s_waitcnt lgkmcnt(11)
    ds_read_b64_tr_b16 a[206:207], v6 offset:28672
    v_cvt_pk_bf16_f32 v191, v94, v95
    v_mfma_f32_16x16x32_bf16 v[112:115], a[240:243], a[16:19], v[112:115]
    ds_read_b64_tr_b16 a[208:209], v10 offset:16384
    v_lshlrev_b32 v80, 16, v200
    v_mfma_f32_16x16x32_bf16 v[112:115], a[244:247], a[24:27], v[112:115]
    ds_read_b64_tr_b16 a[210:211], v10 offset:20480
    buffer_load_dwordx4 a[72:75], v9, s[24:27], s44 offen offset:0 sc1
    v_mfma_f32_16x16x32_bf16 v[116:119], a[244:247], a[28:31], v[116:119]
    ds_read_b64_tr_b16 a[212:213], v10 offset:24576
    v_and_b32 v81, 0xffff0000, v200
    v_mfma_f32_16x16x32_bf16 v[116:119], a[240:243], a[20:23], v[116:119]
    s_waitcnt lgkmcnt(11)
    ds_read_b64_tr_b16 a[214:215], v10 offset:28672
    v_lshlrev_b32 v82, 16, v201
    v_mfma_f32_16x16x32_bf16 v[124:127], a[248:251], a[20:23], v[124:127]
    ds_read_b64_tr_b16 a[216:217], v11 offset:16384
    v_and_b32 v83, 0xffff0000, v201
    v_mfma_f32_16x16x32_bf16 v[124:127], a[252:255], a[28:31], v[124:127]
    ds_read_b64_tr_b16 a[218:219], v11 offset:20480
    buffer_load_dwordx4 a[76:79], v9, s[24:27], s44 offen offset:1024 sc1
    v_mfma_f32_16x16x32_bf16 v[120:123], a[252:255], a[24:27], v[120:123]
    s_add_u32 s44, s44, 131072
    ds_read_b64_tr_b16 a[220:221], v11 offset:24576
    v_lshlrev_b32 v84, 16, v202
    v_mfma_f32_16x16x32_bf16 v[120:123], a[248:251], a[16:19], v[120:123]
    s_waitcnt lgkmcnt(11)
    ds_read_b64_tr_b16 a[222:223], v11 offset:28672
    v_and_b32 v85, 0xffff0000, v202
    v_mfma_f32_16x16x32_bf16 v[128:131], a[192:195], a[16:19], v[128:131]
    s_waitcnt vmcnt(36)
    s_barrier
    ds_read_b64_tr_b16 a[224:225], v160 offset:0
    v_lshlrev_b32 v86, 16, v203
    v_mfma_f32_16x16x32_bf16 v[128:131], a[196:199], a[24:27], v[128:131]
    ds_read_b64_tr_b16 a[226:227], v160 offset:4096
    buffer_load_dwordx4 a[80:83], v9, s[24:27], s44 offen offset:0 sc1
    v_mfma_f32_16x16x32_bf16 v[132:135], a[196:199], a[28:31], v[132:135]
    ds_read_b64_tr_b16 a[228:229], v160 offset:8192
    v_and_b32 v87, 0xffff0000, v203
    v_mfma_f32_16x16x32_bf16 v[132:135], a[192:195], a[20:23], v[132:135]
    s_waitcnt lgkmcnt(11)
    ds_read_b64_tr_b16 a[230:231], v160 offset:12288
    v_lshlrev_b32 v88, 16, v204
    v_mfma_f32_16x16x32_bf16 v[140:143], a[200:203], a[20:23], v[140:143]
    ds_read_b64_tr_b16 a[232:233], v161 offset:0
    v_and_b32 v89, 0xffff0000, v204
    v_mfma_f32_16x16x32_bf16 v[140:143], a[204:207], a[28:31], v[140:143]
    ds_read_b64_tr_b16 a[234:235], v161 offset:4096
    buffer_load_dwordx4 a[84:87], v9, s[24:27], s44 offen offset:1024 sc1
    v_mfma_f32_16x16x32_bf16 v[136:139], a[204:207], a[24:27], v[136:139]
    s_add_u32 s44, s44, 131072
    ds_read_b64_tr_b16 a[236:237], v161 offset:8192
    v_lshlrev_b32 v90, 16, v205
    v_mfma_f32_16x16x32_bf16 v[136:139], a[200:203], a[16:19], v[136:139]
    s_waitcnt lgkmcnt(11)
    ds_read_b64_tr_b16 a[238:239], v161 offset:12288
    v_and_b32 v91, 0xffff0000, v205
    v_mfma_f32_16x16x32_bf16 v[144:147], a[208:211], a[16:19], v[144:147]
    ds_read_b64_tr_b16 a[240:241], v162 offset:0
    v_lshlrev_b32 v92, 16, v206
    v_mfma_f32_16x16x32_bf16 v[144:147], a[212:215], a[24:27], v[144:147]
    ds_read_b64_tr_b16 a[242:243], v162 offset:4096
    buffer_load_dwordx4 a[88:91], v9, s[24:27], s44 offen offset:0 sc1
    v_mfma_f32_16x16x32_bf16 v[148:151], a[212:215], a[28:31], v[148:151]
    ds_read_b64_tr_b16 a[244:245], v162 offset:8192
    v_and_b32 v93, 0xffff0000, v206
    v_mfma_f32_16x16x32_bf16 v[148:151], a[208:211], a[20:23], v[148:151]
    s_waitcnt lgkmcnt(11)
    ds_read_b64_tr_b16 a[246:247], v162 offset:12288
    v_lshlrev_b32 v94, 16, v207
    v_mfma_f32_16x16x32_bf16 v[156:159], a[216:219], a[20:23], v[156:159]
    ds_read_b64_tr_b16 a[248:249], v163 offset:0
    v_and_b32 v95, 0xffff0000, v207
    v_mfma_f32_16x16x32_bf16 v[156:159], a[220:223], a[28:31], v[156:159]
    ds_read_b64_tr_b16 a[250:251], v163 offset:4096
    buffer_load_dwordx4 a[92:95], v9, s[24:27], s44 offen offset:1024 sc1
    v_mfma_f32_16x16x32_bf16 v[152:155], a[220:223], a[24:27], v[152:155]
    s_add_u32 s44, s44, 131072
    ds_read_b64_tr_b16 a[252:253], v163 offset:8192
    v_mfma_f32_16x16x32_bf16 v[152:155], a[216:219], a[16:19], v[152:155]
    s_waitcnt lgkmcnt(11)
    ds_read_b64_tr_b16 a[254:255], v163 offset:12288
    s_waitcnt vmcnt(12)
    v_mfma_f32_16x16x32_bf16 v[96:99], a[224:227], a[32:35], v[96:99]
    ds_read_b64_tr_b16 a[192:193], v164 offset:0
    v_mfma_f32_16x16x32_bf16 v[96:99], a[228:231], a[40:43], v[96:99]
    ds_read_b64_tr_b16 a[194:195], v164 offset:4096
    buffer_load_dwordx4 v17, s[20:23], s45 offen offset:3072 lds
    v_mfma_f32_16x16x32_bf16 v[100:103], a[228:231], a[44:47], v[100:103]
    s_add_u32 s45, s45, 65536
    ds_read_b64_tr_b16 a[196:197], v164 offset:8192
    v_mfma_f32_16x16x32_bf16 v[100:103], a[224:227], a[36:39], v[100:103]
    s_waitcnt lgkmcnt(11)
    ds_read_b64_tr_b16 a[198:199], v164 offset:12288
    v_mfma_f32_16x16x32_bf16 v[108:111], a[232:235], a[36:39], v[108:111]
    s_add_u32 m0, s39, 49152
    ds_read_b64_tr_b16 a[200:201], v165 offset:0
    v_mfma_f32_16x16x32_bf16 v[108:111], a[236:239], a[44:47], v[108:111]
    ds_read_b64_tr_b16 a[202:203], v165 offset:4096
    buffer_load_dwordx4 a[96:99], v9, s[24:27], s44 offen offset:0 sc1
    v_mfma_f32_16x16x32_bf16 v[104:107], a[236:239], a[40:43], v[104:107]
    ds_read_b64_tr_b16 a[204:205], v165 offset:8192
    v_mfma_f32_16x16x32_bf16 v[104:107], a[232:235], a[32:35], v[104:107]
    s_waitcnt lgkmcnt(11)
    ds_read_b64_tr_b16 a[206:207], v165 offset:12288
    v_mfma_f32_16x16x32_bf16 v[112:115], a[240:243], a[32:35], v[112:115]
    ds_read_b64_tr_b16 a[208:209], v166 offset:0
    v_mfma_f32_16x16x32_bf16 v[112:115], a[244:247], a[40:43], v[112:115]
    ds_read_b64_tr_b16 a[210:211], v166 offset:4096
    buffer_load_dwordx4 a[100:103], v9, s[24:27], s44 offen offset:1024 sc1
    v_mfma_f32_16x16x32_bf16 v[116:119], a[244:247], a[44:47], v[116:119]
    s_add_u32 s44, s44, 131072
    ds_read_b64_tr_b16 a[212:213], v166 offset:8192
    v_mfma_f32_16x16x32_bf16 v[116:119], a[240:243], a[36:39], v[116:119]
    s_waitcnt lgkmcnt(11)
    ds_read_b64_tr_b16 a[214:215], v166 offset:12288
    v_mfma_f32_16x16x32_bf16 v[124:127], a[248:251], a[36:39], v[124:127]
    ds_read_b64_tr_b16 a[216:217], v167 offset:0
    v_mfma_f32_16x16x32_bf16 v[124:127], a[252:255], a[44:47], v[124:127]
    ds_read_b64_tr_b16 a[218:219], v167 offset:4096
    buffer_load_dwordx4 a[104:107], v9, s[24:27], s44 offen offset:0 sc1
    v_mfma_f32_16x16x32_bf16 v[120:123], a[252:255], a[40:43], v[120:123]
    ds_read_b64_tr_b16 a[220:221], v167 offset:8192
    v_mfma_f32_16x16x32_bf16 v[120:123], a[248:251], a[32:35], v[120:123]
    s_waitcnt lgkmcnt(11)
    ds_read_b64_tr_b16 a[222:223], v167 offset:12288
    v_mfma_f32_16x16x32_bf16 v[128:131], a[192:195], a[32:35], v[128:131]
    s_lshl_b32 s52, s54, 2
    ds_read_b64_tr_b16 a[224:225], v24 offset:0
    v_bfe_u32 v12, v0, 1, 2
    v_mfma_f32_16x16x32_bf16 v[128:131], a[196:199], a[40:43], v[128:131]
    s_add_u32 s52, s52, s36
    ds_read_b64_tr_b16 a[226:227], v24 offset:4096
    buffer_load_dwordx4 a[108:111], v9, s[24:27], s44 offen offset:1024 sc1
    v_mfma_f32_16x16x32_bf16 v[132:135], a[196:199], a[44:47], v[132:135]
    s_lshl_b32 s52, s52, 7
    ds_read_b64_tr_b16 a[228:229], v24 offset:8192
    v_max_u32 v12, 1, v12
    v_mfma_f32_16x16x32_bf16 v[132:135], a[192:195], a[36:39], v[132:135]
    s_waitcnt lgkmcnt(11)
    ds_read_b64_tr_b16 a[230:231], v24 offset:12288
    v_xor_b32 v12, s40, v12
    v_mfma_f32_16x16x32_bf16 v[140:143], a[200:203], a[36:39], v[140:143]
    s_add_u32 s52, s52, 65536
    ds_read_b64_tr_b16 a[232:233], v25 offset:0
    v_and_b32 v13, 1, v0
    v_mfma_f32_16x16x32_bf16 v[140:143], a[204:207], a[44:47], v[140:143]
    s_lshl_b32 s51, s40, 3
    ds_read_b64_tr_b16 a[234:235], v25 offset:4096
    buffer_load_dwordx4 v14, s[20:23], s45 offen offset:0 lds
    v_mfma_f32_16x16x32_bf16 v[136:139], a[204:207], a[40:43], v[136:139]
    s_add_u32 s51, s51, s52
    ds_read_b64_tr_b16 a[236:237], v25 offset:8192
    v_lshlrev_b32 v13, 2, v13
    v_mfma_f32_16x16x32_bf16 v[136:139], a[200:203], a[32:35], v[136:139]
    s_waitcnt lgkmcnt(11)
    ds_read_b64_tr_b16 a[238:239], v25 offset:12288
    v_lshl_add_u32 v20, v12, 8, v13
    v_mfma_f32_16x16x32_bf16 v[144:147], a[208:211], a[32:35], v[144:147]
    s_add_u32 s53, s52, 64
    ds_read_b64_tr_b16 a[240:241], v26 offset:0
    v_lshl_add_u32 v12, v12, 3, v13
    v_mfma_f32_16x16x32_bf16 v[144:147], a[212:215], a[40:43], v[144:147]
    s_add_u32 s3, s51, 64
    ds_read_b64_tr_b16 a[242:243], v26 offset:4096
    buffer_load_dwordx4 v15, s[20:23], s45 offen offset:1024 lds
    v_mfma_f32_16x16x32_bf16 v[148:151], a[212:215], a[44:47], v[148:151]
    s_add_u32 s44, s44, 131072
    ds_read_b64_tr_b16 a[244:245], v26 offset:8192
    v_mfma_f32_16x16x32_bf16 v[148:151], a[208:211], a[36:39], v[148:151]
    s_waitcnt lgkmcnt(11)
    ds_read_b64_tr_b16 a[246:247], v26 offset:12288
    v_mfma_f32_16x16x32_bf16 v[156:159], a[216:219], a[36:39], v[156:159]
    ds_read_b64_tr_b16 a[248:249], v27 offset:0
    v_mfma_f32_16x16x32_bf16 v[156:159], a[220:223], a[44:47], v[156:159]
    ds_read_b64_tr_b16 a[250:251], v27 offset:4096
    buffer_load_dwordx4 a[112:115], v9, s[24:27], s44 offen offset:0 sc1
    v_mfma_f32_16x16x32_bf16 v[152:155], a[220:223], a[40:43], v[152:155]
    ds_read_b64_tr_b16 a[252:253], v27 offset:8192
    v_mfma_f32_16x16x32_bf16 v[152:155], a[216:219], a[32:35], v[152:155]
    s_waitcnt lgkmcnt(11)
    ds_read_b64_tr_b16 a[254:255], v27 offset:12288
    s_waitcnt vmcnt(16)
    v_mfma_f32_16x16x32_bf16 v[96:99], a[224:227], a[48:51], v[96:99]
    ds_read_b64_tr_b16 a[192:193], v28 offset:0
    v_mfma_f32_16x16x32_bf16 v[96:99], a[228:231], a[56:59], v[96:99]
    ds_read_b64_tr_b16 a[194:195], v28 offset:4096
    buffer_load_dwordx4 a[116:119], v9, s[24:27], s44 offen offset:1024 sc1
    v_mfma_f32_16x16x32_bf16 v[100:103], a[228:231], a[60:63], v[100:103]
    s_add_u32 s44, s44, 131072
    ds_read_b64_tr_b16 a[196:197], v28 offset:8192
    v_mfma_f32_16x16x32_bf16 v[100:103], a[224:227], a[52:55], v[100:103]
    s_waitcnt lgkmcnt(11)
    ds_read_b64_tr_b16 a[198:199], v28 offset:12288
    v_mfma_f32_16x16x32_bf16 v[108:111], a[232:235], a[52:55], v[108:111]
    ds_read_b64_tr_b16 a[200:201], v29 offset:0
    v_mfma_f32_16x16x32_bf16 v[108:111], a[236:239], a[60:63], v[108:111]
    ds_read_b64_tr_b16 a[202:203], v29 offset:4096
    buffer_load_dwordx4 a[120:123], v9, s[24:27], s44 offen offset:0 sc1
    v_mfma_f32_16x16x32_bf16 v[104:107], a[236:239], a[56:59], v[104:107]
    ds_read_b64_tr_b16 a[204:205], v29 offset:8192
    v_mfma_f32_16x16x32_bf16 v[104:107], a[232:235], a[48:51], v[104:107]
    s_waitcnt lgkmcnt(11)
    ds_read_b64_tr_b16 a[206:207], v29 offset:12288
    v_mfma_f32_16x16x32_bf16 v[112:115], a[240:243], a[48:51], v[112:115]
    ds_read_b64_tr_b16 a[208:209], v30 offset:0
    v_mfma_f32_16x16x32_bf16 v[112:115], a[244:247], a[56:59], v[112:115]
    ds_read_b64_tr_b16 a[210:211], v30 offset:4096
    buffer_load_dwordx4 a[124:127], v9, s[24:27], s44 offen offset:1024 sc1
    v_mfma_f32_16x16x32_bf16 v[116:119], a[244:247], a[60:63], v[116:119]
    s_add_u32 s44, s44, 131072
    ds_read_b64_tr_b16 a[212:213], v30 offset:8192
    v_mfma_f32_16x16x32_bf16 v[116:119], a[240:243], a[52:55], v[116:119]
    s_waitcnt lgkmcnt(11)
    ds_read_b64_tr_b16 a[214:215], v30 offset:12288
    v_mfma_f32_16x16x32_bf16 v[124:127], a[248:251], a[52:55], v[124:127]
    ds_read_b64_tr_b16 a[216:217], v31 offset:0
    v_mfma_f32_16x16x32_bf16 v[124:127], a[252:255], a[60:63], v[124:127]
    ds_read_b64_tr_b16 a[218:219], v31 offset:4096
    buffer_load_dwordx4 v16, s[20:23], s45 offen offset:2048 lds
    v_mfma_f32_16x16x32_bf16 v[120:123], a[252:255], a[56:59], v[120:123]
    ds_read_b64_tr_b16 a[220:221], v31 offset:8192
    v_mfma_f32_16x16x32_bf16 v[120:123], a[248:251], a[48:51], v[120:123]
    s_waitcnt lgkmcnt(11)
    ds_read_b64_tr_b16 a[222:223], v31 offset:12288
    v_mfma_f32_16x16x32_bf16 v[128:131], a[192:195], a[48:51], v[128:131]
    s_waitcnt vmcnt(43)
    s_barrier
    ds_read_b64_tr_b16 a[224:225], v160 offset:16384
    v_mfma_f32_16x16x32_bf16 v[128:131], a[196:199], a[56:59], v[128:131]
    ds_read_b64_tr_b16 a[226:227], v160 offset:20480
    buffer_load_dwordx4 v17, s[20:23], s45 offen offset:3072 lds
    v_mfma_f32_16x16x32_bf16 v[132:135], a[196:199], a[60:63], v[132:135]
    s_add_u32 s45, s45, 65536
    ds_read_b64_tr_b16 a[228:229], v160 offset:24576
    v_mfma_f32_16x16x32_bf16 v[132:135], a[192:195], a[52:55], v[132:135]
    s_waitcnt lgkmcnt(11)
    ds_read_b64_tr_b16 a[230:231], v160 offset:28672
    v_mfma_f32_16x16x32_bf16 v[140:143], a[200:203], a[52:55], v[140:143]
    s_add_u32 m0, s39, 114688
    ds_read_b64_tr_b16 a[232:233], v161 offset:16384
    v_mfma_f32_16x16x32_bf16 v[140:143], a[204:207], a[60:63], v[140:143]
    ds_read_b64_tr_b16 a[234:235], v161 offset:20480
    buffer_load_dwordx4 v14, s[20:23], s45 offen offset:0 lds
    v_mfma_f32_16x16x32_bf16 v[136:139], a[204:207], a[56:59], v[136:139]
    ds_read_b64_tr_b16 a[236:237], v161 offset:24576
    v_mfma_f32_16x16x32_bf16 v[136:139], a[200:203], a[48:51], v[136:139]
    s_waitcnt lgkmcnt(11)
    ds_read_b64_tr_b16 a[238:239], v161 offset:28672
    v_mfma_f32_16x16x32_bf16 v[144:147], a[208:211], a[48:51], v[144:147]
    ds_read_b64_tr_b16 a[240:241], v162 offset:16384
    v_mfma_f32_16x16x32_bf16 v[144:147], a[212:215], a[56:59], v[144:147]
    ds_read_b64_tr_b16 a[242:243], v162 offset:20480
    buffer_load_dwordx4 v15, s[20:23], s45 offen offset:1024 lds
    v_mfma_f32_16x16x32_bf16 v[148:151], a[212:215], a[60:63], v[148:151]
    ds_read_b64_tr_b16 a[244:245], v162 offset:24576
    v_mfma_f32_16x16x32_bf16 v[148:151], a[208:211], a[52:55], v[148:151]
    s_waitcnt lgkmcnt(11)
    ds_read_b64_tr_b16 a[246:247], v162 offset:28672
    v_mfma_f32_16x16x32_bf16 v[156:159], a[216:219], a[52:55], v[156:159]
    ds_read_b64_tr_b16 a[248:249], v163 offset:16384
    v_mfma_f32_16x16x32_bf16 v[156:159], a[220:223], a[60:63], v[156:159]
    ds_read_b64_tr_b16 a[250:251], v163 offset:20480
    buffer_load_dwordx4 v16, s[20:23], s45 offen offset:2048 lds
    v_mfma_f32_16x16x32_bf16 v[152:155], a[220:223], a[56:59], v[152:155]
    ds_read_b64_tr_b16 a[252:253], v163 offset:24576
    v_mfma_f32_16x16x32_bf16 v[152:155], a[216:219], a[48:51], v[152:155]
    s_waitcnt lgkmcnt(11)
    ds_read_b64_tr_b16 a[254:255], v163 offset:28672
    s_waitcnt vmcnt(20)
    v_mfma_f32_16x16x32_bf16 v[96:99], a[224:227], a[64:67], v[96:99]
    ds_read_b64_tr_b16 a[192:193], v164 offset:16384
    v_mfma_f32_16x16x32_bf16 v[96:99], a[228:231], a[72:75], v[96:99]
    ds_read_b64_tr_b16 a[194:195], v164 offset:20480
    buffer_load_dwordx4 v17, s[20:23], s45 offen offset:3072 lds
    v_mfma_f32_16x16x32_bf16 v[100:103], a[228:231], a[76:79], v[100:103]
    s_add_u32 s45, s45, 65536
    ds_read_b64_tr_b16 a[196:197], v164 offset:24576
    v_mfma_f32_16x16x32_bf16 v[100:103], a[224:227], a[68:71], v[100:103]
    s_waitcnt lgkmcnt(11)
    ds_read_b64_tr_b16 a[198:199], v164 offset:28672
    v_mfma_f32_16x16x32_bf16 v[108:111], a[232:235], a[68:71], v[108:111]
    s_add_u32 m0, s39, 131072
    ds_read_b64_tr_b16 a[200:201], v165 offset:16384
    v_mfma_f32_16x16x32_bf16 v[108:111], a[236:239], a[76:79], v[108:111]
    ds_read_b64_tr_b16 a[202:203], v165 offset:20480
    buffer_load_dwordx4 a[0:3], v9, s[24:27], s44 offen offset:0 sc1
    v_mfma_f32_16x16x32_bf16 v[104:107], a[236:239], a[72:75], v[104:107]
    ds_read_b64_tr_b16 a[204:205], v165 offset:24576
    v_mfma_f32_16x16x32_bf16 v[104:107], a[232:235], a[64:67], v[104:107]
    s_waitcnt lgkmcnt(11)
    ds_read_b64_tr_b16 a[206:207], v165 offset:28672
    v_mfma_f32_16x16x32_bf16 v[112:115], a[240:243], a[64:67], v[112:115]
    ds_read_b64_tr_b16 a[208:209], v166 offset:16384
    v_mfma_f32_16x16x32_bf16 v[112:115], a[244:247], a[72:75], v[112:115]
    ds_read_b64_tr_b16 a[210:211], v166 offset:20480
    buffer_load_dwordx4 a[4:7], v9, s[24:27], s44 offen offset:1024 sc1
    v_mfma_f32_16x16x32_bf16 v[116:119], a[244:247], a[76:79], v[116:119]
    s_add_u32 s44, s44, 131072
    ds_read_b64_tr_b16 a[212:213], v166 offset:24576
    v_mfma_f32_16x16x32_bf16 v[116:119], a[240:243], a[68:71], v[116:119]
    s_waitcnt lgkmcnt(11)
    ds_read_b64_tr_b16 a[214:215], v166 offset:28672
    v_mfma_f32_16x16x32_bf16 v[124:127], a[248:251], a[68:71], v[124:127]
    ds_read_b64_tr_b16 a[216:217], v167 offset:16384
    v_mfma_f32_16x16x32_bf16 v[124:127], a[252:255], a[76:79], v[124:127]
    ds_read_b64_tr_b16 a[218:219], v167 offset:20480
    buffer_load_dwordx4 a[8:11], v9, s[24:27], s44 offen offset:0 sc1
    v_mfma_f32_16x16x32_bf16 v[120:123], a[252:255], a[72:75], v[120:123]
    ds_read_b64_tr_b16 a[220:221], v167 offset:24576
    v_mfma_f32_16x16x32_bf16 v[120:123], a[248:251], a[64:67], v[120:123]
    s_waitcnt lgkmcnt(11)
    ds_read_b64_tr_b16 a[222:223], v167 offset:28672
    v_mfma_f32_16x16x32_bf16 v[128:131], a[192:195], a[64:67], v[128:131]
    ds_read_b64_tr_b16 a[224:225], v24 offset:16384
    v_mfma_f32_16x16x32_bf16 v[128:131], a[196:199], a[72:75], v[128:131]
    ds_read_b64_tr_b16 a[226:227], v24 offset:20480
    buffer_load_dwordx4 a[12:15], v9, s[24:27], s44 offen offset:1024 sc1
    v_mfma_f32_16x16x32_bf16 v[132:135], a[196:199], a[76:79], v[132:135]
    s_add_u32 s44, s44, 131072
    ds_read_b64_tr_b16 a[228:229], v24 offset:24576
    v_mfma_f32_16x16x32_bf16 v[132:135], a[192:195], a[68:71], v[132:135]
    s_waitcnt lgkmcnt(11)
    ds_read_b64_tr_b16 a[230:231], v24 offset:28672
    v_mfma_f32_16x16x32_bf16 v[140:143], a[200:203], a[68:71], v[140:143]
    ds_read_b64_tr_b16 a[232:233], v25 offset:16384
    v_mfma_f32_16x16x32_bf16 v[140:143], a[204:207], a[76:79], v[140:143]
    ds_read_b64_tr_b16 a[234:235], v25 offset:20480
    buffer_load_dwordx4 a[16:19], v9, s[24:27], s44 offen offset:0 sc1
    v_mfma_f32_16x16x32_bf16 v[136:139], a[204:207], a[72:75], v[136:139]
    ds_read_b64_tr_b16 a[236:237], v25 offset:24576
    v_mfma_f32_16x16x32_bf16 v[136:139], a[200:203], a[64:67], v[136:139]
    s_waitcnt lgkmcnt(11)
    ds_read_b64_tr_b16 a[238:239], v25 offset:28672
    v_mfma_f32_16x16x32_bf16 v[144:147], a[208:211], a[64:67], v[144:147]
    ds_read_b64_tr_b16 a[240:241], v26 offset:16384
    v_mfma_f32_16x16x32_bf16 v[144:147], a[212:215], a[72:75], v[144:147]
    ds_read_b64_tr_b16 a[242:243], v26 offset:20480
    buffer_load_dwordx4 a[20:23], v9, s[24:27], s44 offen offset:1024 sc1
    v_mfma_f32_16x16x32_bf16 v[148:151], a[212:215], a[76:79], v[148:151]
    s_add_u32 s44, s44, 131072
    ds_read_b64_tr_b16 a[244:245], v26 offset:24576
    v_mfma_f32_16x16x32_bf16 v[148:151], a[208:211], a[68:71], v[148:151]
    s_waitcnt lgkmcnt(11)
    ds_read_b64_tr_b16 a[246:247], v26 offset:28672
    v_mfma_f32_16x16x32_bf16 v[156:159], a[216:219], a[68:71], v[156:159]
    ds_read_b64_tr_b16 a[248:249], v27 offset:16384
    v_mfma_f32_16x16x32_bf16 v[156:159], a[220:223], a[76:79], v[156:159]
    ds_read_b64_tr_b16 a[250:251], v27 offset:20480
    buffer_load_dwordx4 v14, s[20:23], s45 offen offset:0 lds
    v_mfma_f32_16x16x32_bf16 v[152:155], a[220:223], a[72:75], v[152:155]
    ds_read_b64_tr_b16 a[252:253], v27 offset:24576
    v_mfma_f32_16x16x32_bf16 v[152:155], a[216:219], a[64:67], v[152:155]
    s_waitcnt lgkmcnt(11)
    ds_read_b64_tr_b16 a[254:255], v27 offset:28672
    s_waitcnt vmcnt(24)
    v_mfma_f32_16x16x32_bf16 v[96:99], a[224:227], a[80:83], v[96:99]
    ds_read_b64_tr_b16 a[192:193], v28 offset:16384
    v_mfma_f32_16x16x32_bf16 v[96:99], a[228:231], a[88:91], v[96:99]
    ds_read_b64_tr_b16 a[194:195], v28 offset:20480
    buffer_load_dwordx4 a[24:27], v9, s[24:27], s44 offen offset:0 sc1
    v_mfma_f32_16x16x32_bf16 v[100:103], a[228:231], a[92:95], v[100:103]
    ds_read_b64_tr_b16 a[196:197], v28 offset:24576
    v_mfma_f32_16x16x32_bf16 v[100:103], a[224:227], a[84:87], v[100:103]
    s_waitcnt lgkmcnt(11)
    ds_read_b64_tr_b16 a[198:199], v28 offset:28672
    v_mfma_f32_16x16x32_bf16 v[108:111], a[232:235], a[84:87], v[108:111]
    ds_read_b64_tr_b16 a[200:201], v29 offset:16384
    v_mfma_f32_16x16x32_bf16 v[108:111], a[236:239], a[92:95], v[108:111]
    ds_read_b64_tr_b16 a[202:203], v29 offset:20480
    buffer_load_dwordx4 a[28:31], v9, s[24:27], s44 offen offset:1024 sc1
    v_mfma_f32_16x16x32_bf16 v[104:107], a[236:239], a[88:91], v[104:107]
    s_add_u32 s44, s44, 131072
    ds_read_b64_tr_b16 a[204:205], v29 offset:24576
    v_mfma_f32_16x16x32_bf16 v[104:107], a[232:235], a[80:83], v[104:107]
    s_waitcnt lgkmcnt(11)
    ds_read_b64_tr_b16 a[206:207], v29 offset:28672
    v_mfma_f32_16x16x32_bf16 v[112:115], a[240:243], a[80:83], v[112:115]
    ds_read_b64_tr_b16 a[208:209], v30 offset:16384
    v_mfma_f32_16x16x32_bf16 v[112:115], a[244:247], a[88:91], v[112:115]
    ds_read_b64_tr_b16 a[210:211], v30 offset:20480
    buffer_load_dwordx4 v15, s[20:23], s45 offen offset:1024 lds
    v_mfma_f32_16x16x32_bf16 v[116:119], a[244:247], a[92:95], v[116:119]
    ds_read_b64_tr_b16 a[212:213], v30 offset:24576
    v_mfma_f32_16x16x32_bf16 v[116:119], a[240:243], a[84:87], v[116:119]
    s_waitcnt lgkmcnt(11)
    ds_read_b64_tr_b16 a[214:215], v30 offset:28672
    v_mfma_f32_16x16x32_bf16 v[124:127], a[248:251], a[84:87], v[124:127]
    ds_read_b64_tr_b16 a[216:217], v31 offset:16384
    v_mfma_f32_16x16x32_bf16 v[124:127], a[252:255], a[92:95], v[124:127]
    ds_read_b64_tr_b16 a[218:219], v31 offset:20480
    buffer_load_dwordx4 v16, s[20:23], s45 offen offset:2048 lds
    v_mfma_f32_16x16x32_bf16 v[120:123], a[252:255], a[88:91], v[120:123]
    ds_read_b64_tr_b16 a[220:221], v31 offset:24576
    v_mfma_f32_16x16x32_bf16 v[120:123], a[248:251], a[80:83], v[120:123]
    s_waitcnt lgkmcnt(11)
    ds_read_b64_tr_b16 a[222:223], v31 offset:28672
    v_mfma_f32_16x16x32_bf16 v[128:131], a[192:195], a[80:83], v[128:131]
    s_waitcnt vmcnt(27)
    s_barrier
    ds_read_b64_tr_b16 a[224:225], v160 offset:32768
    v_mfma_f32_16x16x32_bf16 v[128:131], a[196:199], a[88:91], v[128:131]
    ds_read_b64_tr_b16 a[226:227], v160 offset:36864
    buffer_load_dwordx4 v17, s[20:23], s45 offen offset:3072 lds
    v_mfma_f32_16x16x32_bf16 v[132:135], a[196:199], a[92:95], v[132:135]
    s_add_u32 s45, s45, 65536
    ds_read_b64_tr_b16 a[228:229], v160 offset:40960
    v_mfma_f32_16x16x32_bf16 v[132:135], a[192:195], a[84:87], v[132:135]
    s_waitcnt lgkmcnt(11)
    ds_read_b64_tr_b16 a[230:231], v160 offset:45056
    v_mfma_f32_16x16x32_bf16 v[140:143], a[200:203], a[84:87], v[140:143]
    s_add_u32 m0, s39, 147456
    ds_read_b64_tr_b16 a[232:233], v161 offset:32768
    v_mfma_f32_16x16x32_bf16 v[140:143], a[204:207], a[92:95], v[140:143]
    ds_read_b64_tr_b16 a[234:235], v161 offset:36864
    buffer_load_dwordx4 v14, s[20:23], s45 offen offset:0 lds
    v_mfma_f32_16x16x32_bf16 v[136:139], a[204:207], a[88:91], v[136:139]
    ds_read_b64_tr_b16 a[236:237], v161 offset:40960
    v_mfma_f32_16x16x32_bf16 v[136:139], a[200:203], a[80:83], v[136:139]
    s_waitcnt lgkmcnt(11)
    ds_read_b64_tr_b16 a[238:239], v161 offset:45056
    v_mfma_f32_16x16x32_bf16 v[144:147], a[208:211], a[80:83], v[144:147]
    ds_read_b64_tr_b16 a[240:241], v162 offset:32768
    v_mfma_f32_16x16x32_bf16 v[144:147], a[212:215], a[88:91], v[144:147]
    ds_read_b64_tr_b16 a[242:243], v162 offset:36864
    buffer_load_dwordx4 v15, s[20:23], s45 offen offset:1024 lds
    v_mfma_f32_16x16x32_bf16 v[148:151], a[212:215], a[92:95], v[148:151]
    ds_read_b64_tr_b16 a[244:245], v162 offset:40960
    v_mfma_f32_16x16x32_bf16 v[148:151], a[208:211], a[84:87], v[148:151]
    s_waitcnt lgkmcnt(11)
    ds_read_b64_tr_b16 a[246:247], v162 offset:45056
    v_mfma_f32_16x16x32_bf16 v[156:159], a[216:219], a[84:87], v[156:159]
    ds_read_b64_tr_b16 a[248:249], v163 offset:32768
    v_mfma_f32_16x16x32_bf16 v[156:159], a[220:223], a[92:95], v[156:159]
    ds_read_b64_tr_b16 a[250:251], v163 offset:36864
    buffer_load_dwordx4 v16, s[20:23], s45 offen offset:2048 lds
    v_mfma_f32_16x16x32_bf16 v[152:155], a[220:223], a[88:91], v[152:155]
    ds_read_b64_tr_b16 a[252:253], v163 offset:40960
    v_mfma_f32_16x16x32_bf16 v[152:155], a[216:219], a[80:83], v[152:155]
    s_waitcnt lgkmcnt(11)
    ds_read_b64_tr_b16 a[254:255], v163 offset:45056
    s_waitcnt vmcnt(27)
    v_mfma_f32_16x16x32_bf16 v[96:99], a[224:227], a[96:99], v[96:99]
    ds_read_b64_tr_b16 a[192:193], v164 offset:32768
    v_mfma_f32_16x16x32_bf16 v[96:99], a[228:231], a[104:107], v[96:99]
    ds_read_b64_tr_b16 a[194:195], v164 offset:36864
    buffer_load_dwordx4 v17, s[20:23], s45 offen offset:3072 lds
    v_mfma_f32_16x16x32_bf16 v[100:103], a[228:231], a[108:111], v[100:103]
    s_add_u32 s45, s45, 65536
    ds_read_b64_tr_b16 a[196:197], v164 offset:40960
    v_mfma_f32_16x16x32_bf16 v[100:103], a[224:227], a[100:103], v[100:103]
    s_waitcnt lgkmcnt(11)
    ds_read_b64_tr_b16 a[198:199], v164 offset:45056
    v_mfma_f32_16x16x32_bf16 v[108:111], a[232:235], a[100:103], v[108:111]
    s_add_u32 m0, s39, 0
    ds_read_b64_tr_b16 a[200:201], v165 offset:32768
    v_mfma_f32_16x16x32_bf16 v[108:111], a[236:239], a[108:111], v[108:111]
    ds_read_b64_tr_b16 a[202:203], v165 offset:36864
    buffer_load_dwordx4 a[32:35], v9, s[24:27], s44 offen offset:0 sc1
    v_mfma_f32_16x16x32_bf16 v[104:107], a[236:239], a[104:107], v[104:107]
    ds_read_b64_tr_b16 a[204:205], v165 offset:40960
    v_mfma_f32_16x16x32_bf16 v[104:107], a[232:235], a[96:99], v[104:107]
    s_waitcnt lgkmcnt(11)
    ds_read_b64_tr_b16 a[206:207], v165 offset:45056
    v_mfma_f32_16x16x32_bf16 v[112:115], a[240:243], a[96:99], v[112:115]
    ds_read_b64_tr_b16 a[208:209], v166 offset:32768
    v_mfma_f32_16x16x32_bf16 v[112:115], a[244:247], a[104:107], v[112:115]
    ds_read_b64_tr_b16 a[210:211], v166 offset:36864
    buffer_load_dwordx4 a[36:39], v9, s[24:27], s44 offen offset:1024 sc1
    v_mfma_f32_16x16x32_bf16 v[116:119], a[244:247], a[108:111], v[116:119]
    s_add_u32 s44, s44, 131072
    ds_read_b64_tr_b16 a[212:213], v166 offset:40960
    v_mfma_f32_16x16x32_bf16 v[116:119], a[240:243], a[100:103], v[116:119]
    s_waitcnt lgkmcnt(11)
    ds_read_b64_tr_b16 a[214:215], v166 offset:45056
    v_mfma_f32_16x16x32_bf16 v[124:127], a[248:251], a[100:103], v[124:127]
    ds_read_b64_tr_b16 a[216:217], v167 offset:32768
    v_mfma_f32_16x16x32_bf16 v[124:127], a[252:255], a[108:111], v[124:127]
    ds_read_b64_tr_b16 a[218:219], v167 offset:36864
    buffer_load_dwordx4 a[40:43], v9, s[24:27], s44 offen offset:0 sc1
    v_mfma_f32_16x16x32_bf16 v[120:123], a[252:255], a[104:107], v[120:123]
    ds_read_b64_tr_b16 a[220:221], v167 offset:40960
    v_mfma_f32_16x16x32_bf16 v[120:123], a[248:251], a[96:99], v[120:123]
    s_waitcnt lgkmcnt(11)
    ds_read_b64_tr_b16 a[222:223], v167 offset:45056
    v_mfma_f32_16x16x32_bf16 v[128:131], a[192:195], a[96:99], v[128:131]
    ds_read_b64_tr_b16 a[224:225], v24 offset:32768
    v_mfma_f32_16x16x32_bf16 v[128:131], a[196:199], a[104:107], v[128:131]
    ds_read_b64_tr_b16 a[226:227], v24 offset:36864
    buffer_load_dwordx4 a[44:47], v9, s[24:27], s44 offen offset:1024 sc1
    v_mfma_f32_16x16x32_bf16 v[132:135], a[196:199], a[108:111], v[132:135]
    s_add_u32 s44, s44, 131072
    ds_read_b64_tr_b16 a[228:229], v24 offset:40960
    v_mfma_f32_16x16x32_bf16 v[132:135], a[192:195], a[100:103], v[132:135]
    s_waitcnt lgkmcnt(11)
    ds_read_b64_tr_b16 a[230:231], v24 offset:45056
    v_mfma_f32_16x16x32_bf16 v[140:143], a[200:203], a[100:103], v[140:143]
    ds_read_b64_tr_b16 a[232:233], v25 offset:32768
    v_mfma_f32_16x16x32_bf16 v[140:143], a[204:207], a[108:111], v[140:143]
    ds_read_b64_tr_b16 a[234:235], v25 offset:36864
    buffer_load_dwordx4 a[48:51], v9, s[24:27], s44 offen offset:0 sc1
    v_mfma_f32_16x16x32_bf16 v[136:139], a[204:207], a[104:107], v[136:139]
    ds_read_b64_tr_b16 a[236:237], v25 offset:40960
    v_mfma_f32_16x16x32_bf16 v[136:139], a[200:203], a[96:99], v[136:139]
    s_waitcnt lgkmcnt(11)
    ds_read_b64_tr_b16 a[238:239], v25 offset:45056
    v_mfma_f32_16x16x32_bf16 v[144:147], a[208:211], a[96:99], v[144:147]
    ds_read_b64_tr_b16 a[240:241], v26 offset:32768
    v_mfma_f32_16x16x32_bf16 v[144:147], a[212:215], a[104:107], v[144:147]
    ds_read_b64_tr_b16 a[242:243], v26 offset:36864
    buffer_load_dwordx4 a[52:55], v9, s[24:27], s44 offen offset:1024 sc1
    v_mfma_f32_16x16x32_bf16 v[148:151], a[212:215], a[108:111], v[148:151]
    s_add_u32 s44, s44, 131072
    ds_read_b64_tr_b16 a[244:245], v26 offset:40960
    v_mfma_f32_16x16x32_bf16 v[148:151], a[208:211], a[100:103], v[148:151]
    s_waitcnt lgkmcnt(11)
    ds_read_b64_tr_b16 a[246:247], v26 offset:45056
    v_mfma_f32_16x16x32_bf16 v[156:159], a[216:219], a[100:103], v[156:159]
    ds_read_b64_tr_b16 a[248:249], v27 offset:32768
    v_mfma_f32_16x16x32_bf16 v[156:159], a[220:223], a[108:111], v[156:159]
    ds_read_b64_tr_b16 a[250:251], v27 offset:36864
    buffer_load_dwordx4 v14, s[20:23], s45 offen offset:0 lds
    v_mfma_f32_16x16x32_bf16 v[152:155], a[220:223], a[104:107], v[152:155]
    ds_read_b64_tr_b16 a[252:253], v27 offset:40960
    v_mfma_f32_16x16x32_bf16 v[152:155], a[216:219], a[96:99], v[152:155]
    s_waitcnt lgkmcnt(11)
    ds_read_b64_tr_b16 a[254:255], v27 offset:45056
    s_waitcnt vmcnt(29)
    v_mfma_f32_16x16x32_bf16 v[96:99], a[224:227], a[112:115], v[96:99]
    ds_read_b64_tr_b16 a[192:193], v28 offset:32768
    v_mfma_f32_16x16x32_bf16 v[96:99], a[228:231], a[120:123], v[96:99]
    ds_read_b64_tr_b16 a[194:195], v28 offset:36864
    buffer_load_dwordx4 a[56:59], v9, s[24:27], s44 offen offset:0 sc1
    v_mfma_f32_16x16x32_bf16 v[100:103], a[228:231], a[124:127], v[100:103]
    ds_read_b64_tr_b16 a[196:197], v28 offset:40960
    v_mfma_f32_16x16x32_bf16 v[100:103], a[224:227], a[116:119], v[100:103]
    s_waitcnt lgkmcnt(11)
    ds_read_b64_tr_b16 a[198:199], v28 offset:45056
    v_mfma_f32_16x16x32_bf16 v[108:111], a[232:235], a[116:119], v[108:111]
    ds_read_b64_tr_b16 a[200:201], v29 offset:32768
    v_mfma_f32_16x16x32_bf16 v[108:111], a[236:239], a[124:127], v[108:111]
    ds_read_b64_tr_b16 a[202:203], v29 offset:36864
    buffer_load_dwordx4 a[60:63], v9, s[24:27], s44 offen offset:1024 sc1
    v_mfma_f32_16x16x32_bf16 v[104:107], a[236:239], a[120:123], v[104:107]
    s_add_u32 s44, s44, 131072
    ds_read_b64_tr_b16 a[204:205], v29 offset:40960
    v_mfma_f32_16x16x32_bf16 v[104:107], a[232:235], a[112:115], v[104:107]
    s_waitcnt lgkmcnt(11)
    ds_read_b64_tr_b16 a[206:207], v29 offset:45056
    v_mfma_f32_16x16x32_bf16 v[112:115], a[240:243], a[112:115], v[112:115]
    ds_read_b64_tr_b16 a[208:209], v30 offset:32768
    v_mfma_f32_16x16x32_bf16 v[112:115], a[244:247], a[120:123], v[112:115]
    ds_read_b64_tr_b16 a[210:211], v30 offset:36864
    buffer_load_dwordx4 v15, s[20:23], s45 offen offset:1024 lds
    v_mfma_f32_16x16x32_bf16 v[116:119], a[244:247], a[124:127], v[116:119]
    ds_read_b64_tr_b16 a[212:213], v30 offset:40960
    v_mfma_f32_16x16x32_bf16 v[116:119], a[240:243], a[116:119], v[116:119]
    s_waitcnt lgkmcnt(11)
    ds_read_b64_tr_b16 a[214:215], v30 offset:45056
    v_mfma_f32_16x16x32_bf16 v[124:127], a[248:251], a[116:119], v[124:127]
    ds_read_b64_tr_b16 a[216:217], v31 offset:32768
    v_mfma_f32_16x16x32_bf16 v[124:127], a[252:255], a[124:127], v[124:127]
    ds_read_b64_tr_b16 a[218:219], v31 offset:36864
    buffer_load_dwordx4 v16, s[20:23], s45 offen offset:2048 lds
    v_mfma_f32_16x16x32_bf16 v[120:123], a[252:255], a[120:123], v[120:123]
    ds_read_b64_tr_b16 a[220:221], v31 offset:40960
    v_mfma_f32_16x16x32_bf16 v[120:123], a[248:251], a[112:115], v[120:123]
    s_waitcnt lgkmcnt(11)
    ds_read_b64_tr_b16 a[222:223], v31 offset:45056
    v_mfma_f32_16x16x32_bf16 v[128:131], a[192:195], a[112:115], v[128:131]
    s_waitcnt vmcnt(27)
    s_barrier
    ds_read_b64_tr_b16 a[224:225], v162 offset:49152
    v_mfma_f32_16x16x32_bf16 v[128:131], a[196:199], a[120:123], v[128:131]
    ds_read_b64_tr_b16 a[226:227], v162 offset:53248
    buffer_load_dwordx4 v17, s[20:23], s45 offen offset:3072 lds
    v_mfma_f32_16x16x32_bf16 v[132:135], a[196:199], a[124:127], v[132:135]
    s_add_u32 s45, s45, 65536
    ds_read_b64_tr_b16 a[228:229], v162 offset:57344
    v_mfma_f32_16x16x32_bf16 v[132:135], a[192:195], a[116:119], v[132:135]
    s_waitcnt lgkmcnt(11)
    ds_read_b64_tr_b16 a[230:231], v162 offset:61440
    v_mfma_f32_16x16x32_bf16 v[140:143], a[200:203], a[116:119], v[140:143]
    s_add_u32 m0, s39, 65536
    ds_read_b64_tr_b16 a[232:233], v163 offset:49152
    v_mfma_f32_16x16x32_bf16 v[140:143], a[204:207], a[124:127], v[140:143]
    ds_read_b64_tr_b16 a[234:235], v163 offset:53248
    buffer_load_dwordx4 v14, s[20:23], s45 offen offset:0 lds
    v_mfma_f32_16x16x32_bf16 v[136:139], a[204:207], a[120:123], v[136:139]
    ds_read_b64_tr_b16 a[236:237], v163 offset:57344
    v_mfma_f32_16x16x32_bf16 v[136:139], a[200:203], a[112:115], v[136:139]
    s_waitcnt lgkmcnt(11)
    ds_read_b64_tr_b16 a[238:239], v163 offset:61440
    v_mfma_f32_16x16x32_bf16 v[144:147], a[208:211], a[112:115], v[144:147]
    ds_read_b64_tr_b16 a[240:241], v164 offset:49152
    v_mfma_f32_16x16x32_bf16 v[144:147], a[212:215], a[120:123], v[144:147]
    ds_read_b64_tr_b16 a[242:243], v164 offset:53248
    buffer_load_dwordx4 v15, s[20:23], s45 offen offset:1024 lds
    v_mfma_f32_16x16x32_bf16 v[148:151], a[212:215], a[124:127], v[148:151]
    ds_read_b64_tr_b16 a[244:245], v164 offset:57344
    v_mfma_f32_16x16x32_bf16 v[148:151], a[208:211], a[116:119], v[148:151]
    s_waitcnt lgkmcnt(11)
    ds_read_b64_tr_b16 a[246:247], v164 offset:61440
    v_mfma_f32_16x16x32_bf16 v[156:159], a[216:219], a[116:119], v[156:159]
    ds_read_b64_tr_b16 a[248:249], v165 offset:49152
    v_mfma_f32_16x16x32_bf16 v[156:159], a[220:223], a[124:127], v[156:159]
    ds_read_b64_tr_b16 a[250:251], v165 offset:53248
    buffer_load_dwordx4 v16, s[20:23], s45 offen offset:2048 lds
    v_mfma_f32_16x16x32_bf16 v[152:155], a[220:223], a[120:123], v[152:155]
    ds_read_b64_tr_b16 a[252:253], v165 offset:57344
    v_mfma_f32_16x16x32_bf16 v[152:155], a[216:219], a[112:115], v[152:155]
    s_waitcnt lgkmcnt(11)
    ds_read_b64_tr_b16 a[254:255], v165 offset:61440
    s_waitcnt vmcnt(27)
    v_mfma_f32_16x16x32_bf16 v[112:115], a[224:227], a[0:3], v[112:115]
    ds_read_b64_tr_b16 a[192:193], v166 offset:49152
    v_mfma_f32_16x16x32_bf16 v[112:115], a[228:231], a[8:11], v[112:115]
    ds_read_b64_tr_b16 a[194:195], v166 offset:53248
    buffer_load_dwordx4 v17, s[20:23], s45 offen offset:3072 lds
    v_mfma_f32_16x16x32_bf16 v[116:119], a[228:231], a[12:15], v[116:119]
    s_add_u32 s45, s45, 65536
    ds_read_b64_tr_b16 a[196:197], v166 offset:57344
    v_mfma_f32_16x16x32_bf16 v[116:119], a[224:227], a[4:7], v[116:119]
    s_waitcnt lgkmcnt(11)
    ds_read_b64_tr_b16 a[198:199], v166 offset:61440
    v_mfma_f32_16x16x32_bf16 v[124:127], a[232:235], a[4:7], v[124:127]
    s_add_u32 m0, s39, 16384
    ds_read_b64_tr_b16 a[200:201], v167 offset:49152
    v_mfma_f32_16x16x32_bf16 v[124:127], a[236:239], a[12:15], v[124:127]
    ds_read_b64_tr_b16 a[202:203], v167 offset:53248
    buffer_load_dwordx4 a[64:67], v9, s[24:27], s44 offen offset:0 sc1
    v_mfma_f32_16x16x32_bf16 v[120:123], a[236:239], a[8:11], v[120:123]
    ds_read_b64_tr_b16 a[204:205], v167 offset:57344
    v_mfma_f32_16x16x32_bf16 v[120:123], a[232:235], a[0:3], v[120:123]
    s_waitcnt lgkmcnt(11)
    ds_read_b64_tr_b16 a[206:207], v167 offset:61440
    v_mfma_f32_16x16x32_bf16 v[128:131], a[240:243], a[0:3], v[128:131]
    ds_read_b64_tr_b16 a[208:209], v26 offset:49152
    v_mfma_f32_16x16x32_bf16 v[128:131], a[244:247], a[8:11], v[128:131]
    ds_read_b64_tr_b16 a[210:211], v26 offset:53248
    buffer_load_dwordx4 a[68:71], v9, s[24:27], s44 offen offset:1024 sc1
    v_mfma_f32_16x16x32_bf16 v[132:135], a[244:247], a[12:15], v[132:135]
    s_add_u32 s44, s44, 131072
    ds_read_b64_tr_b16 a[212:213], v26 offset:57344
    v_mfma_f32_16x16x32_bf16 v[132:135], a[240:243], a[4:7], v[132:135]
    s_waitcnt lgkmcnt(11)
    ds_read_b64_tr_b16 a[214:215], v26 offset:61440
    v_mfma_f32_16x16x32_bf16 v[140:143], a[248:251], a[4:7], v[140:143]
    ds_read_b64_tr_b16 a[216:217], v27 offset:49152
    v_mfma_f32_16x16x32_bf16 v[140:143], a[252:255], a[12:15], v[140:143]
    ds_read_b64_tr_b16 a[218:219], v27 offset:53248
    buffer_load_dwordx4 a[72:75], v9, s[24:27], s44 offen offset:0 sc1
    v_mfma_f32_16x16x32_bf16 v[136:139], a[252:255], a[8:11], v[136:139]
    ds_read_b64_tr_b16 a[220:221], v27 offset:57344
    v_mfma_f32_16x16x32_bf16 v[136:139], a[248:251], a[0:3], v[136:139]
    s_waitcnt lgkmcnt(11)
    ds_read_b64_tr_b16 a[222:223], v27 offset:61440
    v_mfma_f32_16x16x32_bf16 v[144:147], a[192:195], a[0:3], v[144:147]
    ds_read_b64_tr_b16 a[224:225], v28 offset:49152
    v_mfma_f32_16x16x32_bf16 v[144:147], a[196:199], a[8:11], v[144:147]
    ds_read_b64_tr_b16 a[226:227], v28 offset:53248
    buffer_load_dwordx4 a[76:79], v9, s[24:27], s44 offen offset:1024 sc1
    v_mfma_f32_16x16x32_bf16 v[148:151], a[196:199], a[12:15], v[148:151]
    s_add_u32 s44, s44, 131072
    ds_read_b64_tr_b16 a[228:229], v28 offset:57344
    v_mfma_f32_16x16x32_bf16 v[148:151], a[192:195], a[4:7], v[148:151]
    s_waitcnt lgkmcnt(11)
    ds_read_b64_tr_b16 a[230:231], v28 offset:61440
    v_mfma_f32_16x16x32_bf16 v[156:159], a[200:203], a[4:7], v[156:159]
    ds_read_b64_tr_b16 a[232:233], v29 offset:49152
    v_mfma_f32_16x16x32_bf16 v[156:159], a[204:207], a[12:15], v[156:159]
    ds_read_b64_tr_b16 a[234:235], v29 offset:53248
    buffer_load_dwordx4 a[80:83], v9, s[24:27], s44 offen offset:0 sc1
    v_mfma_f32_16x16x32_bf16 v[152:155], a[204:207], a[8:11], v[152:155]
    ds_read_b64_tr_b16 a[236:237], v29 offset:57344
    v_mfma_f32_16x16x32_bf16 v[152:155], a[200:203], a[0:3], v[152:155]
    s_waitcnt lgkmcnt(11)
    ds_read_b64_tr_b16 a[238:239], v29 offset:61440
    s_waitcnt vmcnt(28)
    v_mfma_f32_16x16x32_bf16 v[112:115], a[208:211], a[16:19], v[112:115]
    ds_read_b64_tr_b16 a[240:241], v30 offset:49152
    v_mfma_f32_16x16x32_bf16 v[112:115], a[212:215], a[24:27], v[112:115]
    ds_read_b64_tr_b16 a[242:243], v30 offset:53248
    buffer_load_dwordx4 a[84:87], v9, s[24:27], s44 offen offset:1024 sc1
    v_mfma_f32_16x16x32_bf16 v[116:119], a[212:215], a[28:31], v[116:119]
    s_add_u32 s44, s44, 131072
    ds_read_b64_tr_b16 a[244:245], v30 offset:57344
    v_mfma_f32_16x16x32_bf16 v[116:119], a[208:211], a[20:23], v[116:119]
    s_waitcnt lgkmcnt(11)
    ds_read_b64_tr_b16 a[246:247], v30 offset:61440
    v_mfma_f32_16x16x32_bf16 v[124:127], a[216:219], a[20:23], v[124:127]
    ds_read_b64_tr_b16 a[248:249], v31 offset:49152
    v_mfma_f32_16x16x32_bf16 v[124:127], a[220:223], a[28:31], v[124:127]
    ds_read_b64_tr_b16 a[250:251], v31 offset:53248
    buffer_load_dwordx4 a[88:91], v9, s[24:27], s44 offen offset:0 sc1
    v_mfma_f32_16x16x32_bf16 v[120:123], a[220:223], a[24:27], v[120:123]
    ds_read_b64_tr_b16 a[252:253], v31 offset:57344
    v_mfma_f32_16x16x32_bf16 v[120:123], a[216:219], a[16:19], v[120:123]
    s_waitcnt lgkmcnt(11)
    ds_read_b64_tr_b16 a[254:255], v31 offset:61440
    v_mfma_f32_16x16x32_bf16 v[128:131], a[224:227], a[16:19], v[128:131]
    s_waitcnt vmcnt(23)
    s_barrier
    ds_read_b64_tr_b16 a[192:193], v3 offset:0
    v_mfma_f32_16x16x32_bf16 v[128:131], a[228:231], a[24:27], v[128:131]
    ds_read_b64_tr_b16 a[194:195], v3 offset:4096
    buffer_load_dwordx4 a[92:95], v9, s[24:27], s44 offen offset:1024 sc1
    v_mfma_f32_16x16x32_bf16 v[132:135], a[228:231], a[28:31], v[132:135]
    s_add_u32 s44, s44, 131072
    ds_read_b64_tr_b16 a[196:197], v3 offset:8192
    v_mfma_f32_16x16x32_bf16 v[132:135], a[224:227], a[20:23], v[132:135]
    s_waitcnt lgkmcnt(11)
    ds_read_b64_tr_b16 a[198:199], v3 offset:12288
    v_mfma_f32_16x16x32_bf16 v[140:143], a[232:235], a[20:23], v[140:143]
    ds_read_b64_tr_b16 a[200:201], v4 offset:0
    v_mfma_f32_16x16x32_bf16 v[140:143], a[236:239], a[28:31], v[140:143]
    ds_read_b64_tr_b16 a[202:203], v4 offset:4096
    buffer_load_dwordx4 v14, s[20:23], s45 offen offset:0 lds
    v_mfma_f32_16x16x32_bf16 v[136:139], a[236:239], a[24:27], v[136:139]
    ds_read_b64_tr_b16 a[204:205], v4 offset:8192
    v_mfma_f32_16x16x32_bf16 v[136:139], a[232:235], a[16:19], v[136:139]
    s_waitcnt lgkmcnt(11)
    ds_read_b64_tr_b16 a[206:207], v4 offset:12288
    v_mfma_f32_16x16x32_bf16 v[144:147], a[240:243], a[16:19], v[144:147]
    ds_read_b64_tr_b16 a[208:209], v5 offset:0
    v_mfma_f32_16x16x32_bf16 v[144:147], a[244:247], a[24:27], v[144:147]
    ds_read_b64_tr_b16 a[210:211], v5 offset:4096
    buffer_load_dwordx4 v15, s[20:23], s45 offen offset:1024 lds
    v_mfma_f32_16x16x32_bf16 v[148:151], a[244:247], a[28:31], v[148:151]
    ds_read_b64_tr_b16 a[212:213], v5 offset:8192
    v_mfma_f32_16x16x32_bf16 v[148:151], a[240:243], a[20:23], v[148:151]
    s_waitcnt lgkmcnt(11)
    ds_read_b64_tr_b16 a[214:215], v5 offset:12288
    v_mfma_f32_16x16x32_bf16 v[156:159], a[248:251], a[20:23], v[156:159]
    ds_read_b64_tr_b16 a[216:217], v6 offset:0
    v_mfma_f32_16x16x32_bf16 v[156:159], a[252:255], a[28:31], v[156:159]
    ds_read_b64_tr_b16 a[218:219], v6 offset:4096
    buffer_load_dwordx4 v16, s[20:23], s45 offen offset:2048 lds
    v_mfma_f32_16x16x32_bf16 v[152:155], a[252:255], a[24:27], v[152:155]
    ds_read_b64_tr_b16 a[220:221], v6 offset:8192
    v_mfma_f32_16x16x32_bf16 v[152:155], a[248:251], a[16:19], v[152:155]
    s_waitcnt lgkmcnt(11)
    ds_read_b64_tr_b16 a[222:223], v6 offset:12288
    s_waitcnt vmcnt(23)
    v_mfma_f32_16x16x32_bf16 v[112:115], a[192:195], a[32:35], v[112:115]
    ds_read_b64_tr_b16 a[224:225], v10 offset:0
    v_mfma_f32_16x16x32_bf16 v[112:115], a[196:199], a[40:43], v[112:115]
    ds_read_b64_tr_b16 a[226:227], v10 offset:4096
    buffer_load_dwordx4 v17, s[20:23], s45 offen offset:3072 lds
    v_mfma_f32_16x16x32_bf16 v[116:119], a[196:199], a[44:47], v[116:119]
    s_add_u32 s45, s45, 65536
    ds_read_b64_tr_b16 a[228:229], v10 offset:8192
    v_mfma_f32_16x16x32_bf16 v[116:119], a[192:195], a[36:39], v[116:119]
    s_waitcnt lgkmcnt(11)
    ds_read_b64_tr_b16 a[230:231], v10 offset:12288
    v_mfma_f32_16x16x32_bf16 v[124:127], a[200:203], a[36:39], v[124:127]
    s_add_u32 m0, s39, 81920
    ds_read_b64_tr_b16 a[232:233], v11 offset:0
    v_mfma_f32_16x16x32_bf16 v[124:127], a[204:207], a[44:47], v[124:127]
    ds_read_b64_tr_b16 a[234:235], v11 offset:4096
    buffer_load_dwordx4 v14, s[20:23], s45 offen offset:0 lds
    v_mfma_f32_16x16x32_bf16 v[120:123], a[204:207], a[40:43], v[120:123]
    ds_read_b64_tr_b16 a[236:237], v11 offset:8192
    v_mfma_f32_16x16x32_bf16 v[120:123], a[200:203], a[32:35], v[120:123]
    s_waitcnt lgkmcnt(11)
    ds_read_b64_tr_b16 a[238:239], v11 offset:12288
    v_mfma_f32_16x16x32_bf16 v[128:131], a[208:211], a[32:35], v[128:131]
    ds_read_b64_tr_b16 a[240:241], v3 offset:16384
    v_mfma_f32_16x16x32_bf16 v[128:131], a[212:215], a[40:43], v[128:131]
    ds_read_b64_tr_b16 a[242:243], v3 offset:20480
    buffer_load_dwordx4 v15, s[20:23], s45 offen offset:1024 lds
    v_mfma_f32_16x16x32_bf16 v[132:135], a[212:215], a[44:47], v[132:135]
    ds_read_b64_tr_b16 a[244:245], v3 offset:24576
    v_mfma_f32_16x16x32_bf16 v[132:135], a[208:211], a[36:39], v[132:135]
    s_waitcnt lgkmcnt(11)
    ds_read_b64_tr_b16 a[246:247], v3 offset:28672
    v_mfma_f32_16x16x32_bf16 v[140:143], a[216:219], a[36:39], v[140:143]
    ds_read_b64_tr_b16 a[248:249], v4 offset:16384
    v_mfma_f32_16x16x32_bf16 v[140:143], a[220:223], a[44:47], v[140:143]
    ds_read_b64_tr_b16 a[250:251], v4 offset:20480
    buffer_load_dwordx4 v16, s[20:23], s45 offen offset:2048 lds
    v_mfma_f32_16x16x32_bf16 v[136:139], a[220:223], a[40:43], v[136:139]
    ds_read_b64_tr_b16 a[252:253], v4 offset:24576
    v_mfma_f32_16x16x32_bf16 v[136:139], a[216:219], a[32:35], v[136:139]
    s_waitcnt lgkmcnt(11)
    ds_read_b64_tr_b16 a[254:255], v4 offset:28672
    v_mfma_f32_16x16x32_bf16 v[144:147], a[224:227], a[32:35], v[144:147]
    ds_read_b64_tr_b16 a[192:193], v5 offset:16384
    v_mfma_f32_16x16x32_bf16 v[144:147], a[228:231], a[40:43], v[144:147]
    ds_read_b64_tr_b16 a[194:195], v5 offset:20480
    buffer_load_dwordx4 v17, s[20:23], s45 offen offset:3072 lds
    v_mfma_f32_16x16x32_bf16 v[148:151], a[228:231], a[44:47], v[148:151]
    s_add_u32 s45, s45, 65536
    ds_read_b64_tr_b16 a[196:197], v5 offset:24576
    v_mfma_f32_16x16x32_bf16 v[148:151], a[224:227], a[36:39], v[148:151]
    s_waitcnt lgkmcnt(11)
    ds_read_b64_tr_b16 a[198:199], v5 offset:28672
    v_mfma_f32_16x16x32_bf16 v[156:159], a[232:235], a[36:39], v[156:159]
    ds_read_b64_tr_b16 a[200:201], v6 offset:16384
    v_mfma_f32_16x16x32_bf16 v[156:159], a[236:239], a[44:47], v[156:159]
    ds_read_b64_tr_b16 a[202:203], v6 offset:20480
    buffer_load_dwordx4 a[96:99], v9, s[24:27], s44 offen offset:0 sc1
    v_mfma_f32_16x16x32_bf16 v[152:155], a[236:239], a[40:43], v[152:155]
    ds_read_b64_tr_b16 a[204:205], v6 offset:24576
    v_mfma_f32_16x16x32_bf16 v[152:155], a[232:235], a[32:35], v[152:155]
    s_waitcnt lgkmcnt(11)
    ds_read_b64_tr_b16 a[206:207], v6 offset:28672
    s_waitcnt vmcnt(24)
    v_mfma_f32_16x16x32_bf16 v[112:115], a[240:243], a[48:51], v[112:115]
    ds_read_b64_tr_b16 a[208:209], v10 offset:16384
    v_mfma_f32_16x16x32_bf16 v[112:115], a[244:247], a[56:59], v[112:115]
    ds_read_b64_tr_b16 a[210:211], v10 offset:20480
    buffer_load_dwordx4 a[100:103], v9, s[24:27], s44 offen offset:1024 sc1
    v_mfma_f32_16x16x32_bf16 v[116:119], a[244:247], a[60:63], v[116:119]
    s_add_u32 s44, s44, 131072
    ds_read_b64_tr_b16 a[212:213], v10 offset:24576
    v_mfma_f32_16x16x32_bf16 v[116:119], a[240:243], a[52:55], v[116:119]
    s_waitcnt lgkmcnt(11)
    ds_read_b64_tr_b16 a[214:215], v10 offset:28672
    v_mfma_f32_16x16x32_bf16 v[124:127], a[248:251], a[52:55], v[124:127]
    ds_read_b64_tr_b16 a[216:217], v11 offset:16384
    v_mfma_f32_16x16x32_bf16 v[124:127], a[252:255], a[60:63], v[124:127]
    ds_read_b64_tr_b16 a[218:219], v11 offset:20480
    buffer_load_dwordx4 a[104:107], v9, s[24:27], s44 offen offset:0 sc1
    v_mfma_f32_16x16x32_bf16 v[120:123], a[252:255], a[56:59], v[120:123]
    ds_read_b64_tr_b16 a[220:221], v11 offset:24576
    v_mfma_f32_16x16x32_bf16 v[120:123], a[248:251], a[48:51], v[120:123]
    s_waitcnt lgkmcnt(11)
    ds_read_b64_tr_b16 a[222:223], v11 offset:28672
    v_mfma_f32_16x16x32_bf16 v[128:131], a[192:195], a[48:51], v[128:131]
    s_waitcnt vmcnt(19)
    s_barrier
    ds_read_b64_tr_b16 a[224:225], v162 offset:0
    v_mfma_f32_16x16x32_bf16 v[128:131], a[196:199], a[56:59], v[128:131]
    ds_read_b64_tr_b16 a[226:227], v162 offset:4096
    buffer_load_dwordx4 a[108:111], v9, s[24:27], s44 offen offset:1024 sc1
    v_mfma_f32_16x16x32_bf16 v[132:135], a[196:199], a[60:63], v[132:135]
    s_add_u32 s44, s44, 131072
    ds_read_b64_tr_b16 a[228:229], v162 offset:8192
    v_mfma_f32_16x16x32_bf16 v[132:135], a[192:195], a[52:55], v[132:135]
    s_waitcnt lgkmcnt(11)
    ds_read_b64_tr_b16 a[230:231], v162 offset:12288
    v_mfma_f32_16x16x32_bf16 v[140:143], a[200:203], a[52:55], v[140:143]
    ds_read_b64_tr_b16 a[232:233], v163 offset:0
    v_mfma_f32_16x16x32_bf16 v[140:143], a[204:207], a[60:63], v[140:143]
    ds_read_b64_tr_b16 a[234:235], v163 offset:4096
    buffer_load_dwordx4 a[112:115], v9, s[24:27], s44 offen offset:0 sc1
    v_mfma_f32_16x16x32_bf16 v[136:139], a[204:207], a[56:59], v[136:139]
    ds_read_b64_tr_b16 a[236:237], v163 offset:8192
    v_mfma_f32_16x16x32_bf16 v[136:139], a[200:203], a[48:51], v[136:139]
    s_waitcnt lgkmcnt(11)
    ds_read_b64_tr_b16 a[238:239], v163 offset:12288
    v_mfma_f32_16x16x32_bf16 v[144:147], a[208:211], a[48:51], v[144:147]
    ds_read_b64_tr_b16 a[240:241], v164 offset:0
    v_mfma_f32_16x16x32_bf16 v[144:147], a[212:215], a[56:59], v[144:147]
    ds_read_b64_tr_b16 a[242:243], v164 offset:4096
    buffer_load_dwordx4 a[116:119], v9, s[24:27], s44 offen offset:1024 sc1
    v_mfma_f32_16x16x32_bf16 v[148:151], a[212:215], a[60:63], v[148:151]
    s_add_u32 s44, s44, 131072
    ds_read_b64_tr_b16 a[244:245], v164 offset:8192
    v_mfma_f32_16x16x32_bf16 v[148:151], a[208:211], a[52:55], v[148:151]
    s_waitcnt lgkmcnt(11)
    ds_read_b64_tr_b16 a[246:247], v164 offset:12288
    v_mfma_f32_16x16x32_bf16 v[156:159], a[216:219], a[52:55], v[156:159]
    ds_read_b64_tr_b16 a[248:249], v165 offset:0
    v_mfma_f32_16x16x32_bf16 v[156:159], a[220:223], a[60:63], v[156:159]
    ds_read_b64_tr_b16 a[250:251], v165 offset:4096
    buffer_load_dwordx4 a[120:123], v9, s[24:27], s44 offen offset:0 sc1
    v_mfma_f32_16x16x32_bf16 v[152:155], a[220:223], a[56:59], v[152:155]
    ds_read_b64_tr_b16 a[252:253], v165 offset:8192
    v_mfma_f32_16x16x32_bf16 v[152:155], a[216:219], a[48:51], v[152:155]
    s_waitcnt lgkmcnt(11)
    ds_read_b64_tr_b16 a[254:255], v165 offset:12288
    s_waitcnt vmcnt(19)
    v_mfma_f32_16x16x32_bf16 v[112:115], a[224:227], a[64:67], v[112:115]
    ds_read_b64_tr_b16 a[192:193], v166 offset:0
    v_mfma_f32_16x16x32_bf16 v[112:115], a[228:231], a[72:75], v[112:115]
    ds_read_b64_tr_b16 a[194:195], v166 offset:4096
    buffer_load_dwordx4 a[124:127], v9, s[24:27], s44 offen offset:1024 sc1
    v_mfma_f32_16x16x32_bf16 v[116:119], a[228:231], a[76:79], v[116:119]
    s_add_u32 s44, s44, 131072
    ds_read_b64_tr_b16 a[196:197], v166 offset:8192
    v_mfma_f32_16x16x32_bf16 v[116:119], a[224:227], a[68:71], v[116:119]
    s_waitcnt lgkmcnt(11)
    ds_read_b64_tr_b16 a[198:199], v166 offset:12288
    v_mfma_f32_16x16x32_bf16 v[124:127], a[232:235], a[68:71], v[124:127]
    ds_read_b64_tr_b16 a[200:201], v167 offset:0
    v_mfma_f32_16x16x32_bf16 v[124:127], a[236:239], a[76:79], v[124:127]
    ds_read_b64_tr_b16 a[202:203], v167 offset:4096
    v_mfma_f32_16x16x32_bf16 v[120:123], a[236:239], a[72:75], v[120:123]
    ds_read_b64_tr_b16 a[204:205], v167 offset:8192
    v_mfma_f32_16x16x32_bf16 v[120:123], a[232:235], a[64:67], v[120:123]
    s_waitcnt lgkmcnt(11)
    ds_read_b64_tr_b16 a[206:207], v167 offset:12288
    v_mfma_f32_16x16x32_bf16 v[128:131], a[240:243], a[64:67], v[128:131]
    ds_read_b64_tr_b16 a[208:209], v26 offset:0
    v_mfma_f32_16x16x32_bf16 v[128:131], a[244:247], a[72:75], v[128:131]
    ds_read_b64_tr_b16 a[210:211], v26 offset:4096
    v_mfma_f32_16x16x32_bf16 v[132:135], a[244:247], a[76:79], v[132:135]
    ds_read_b64_tr_b16 a[212:213], v26 offset:8192
    v_mfma_f32_16x16x32_bf16 v[132:135], a[240:243], a[68:71], v[132:135]
    s_waitcnt lgkmcnt(11)
    ds_read_b64_tr_b16 a[214:215], v26 offset:12288
    v_mfma_f32_16x16x32_bf16 v[140:143], a[248:251], a[68:71], v[140:143]
    ds_read_b64_tr_b16 a[216:217], v27 offset:0
    v_mfma_f32_16x16x32_bf16 v[140:143], a[252:255], a[76:79], v[140:143]
    ds_read_b64_tr_b16 a[218:219], v27 offset:4096
    v_mfma_f32_16x16x32_bf16 v[136:139], a[252:255], a[72:75], v[136:139]
    ds_read_b64_tr_b16 a[220:221], v27 offset:8192
    v_mfma_f32_16x16x32_bf16 v[136:139], a[248:251], a[64:67], v[136:139]
    s_waitcnt lgkmcnt(11)
    ds_read_b64_tr_b16 a[222:223], v27 offset:12288
    v_mfma_f32_16x16x32_bf16 v[144:147], a[192:195], a[64:67], v[144:147]
    ds_read_b64_tr_b16 a[224:225], v28 offset:0
    v_mfma_f32_16x16x32_bf16 v[144:147], a[196:199], a[72:75], v[144:147]
    ds_read_b64_tr_b16 a[226:227], v28 offset:4096
    v_mfma_f32_16x16x32_bf16 v[148:151], a[196:199], a[76:79], v[148:151]
    ds_read_b64_tr_b16 a[228:229], v28 offset:8192
    v_mfma_f32_16x16x32_bf16 v[148:151], a[192:195], a[68:71], v[148:151]
    s_waitcnt lgkmcnt(11)
    ds_read_b64_tr_b16 a[230:231], v28 offset:12288
    v_mfma_f32_16x16x32_bf16 v[156:159], a[200:203], a[68:71], v[156:159]
    ds_read_b64_tr_b16 a[232:233], v29 offset:0
    v_mfma_f32_16x16x32_bf16 v[156:159], a[204:207], a[76:79], v[156:159]
    ds_read_b64_tr_b16 a[234:235], v29 offset:4096
    v_mfma_f32_16x16x32_bf16 v[152:155], a[204:207], a[72:75], v[152:155]
    ds_read_b64_tr_b16 a[236:237], v29 offset:8192
    v_mfma_f32_16x16x32_bf16 v[152:155], a[200:203], a[64:67], v[152:155]
    s_waitcnt lgkmcnt(11)
    ds_read_b64_tr_b16 a[238:239], v29 offset:12288
    s_waitcnt vmcnt(16)
    v_mfma_f32_16x16x32_bf16 v[112:115], a[208:211], a[80:83], v[112:115]
    ds_read_b64_tr_b16 a[240:241], v30 offset:0
    v_mfma_f32_16x16x32_bf16 v[112:115], a[212:215], a[88:91], v[112:115]
    ds_read_b64_tr_b16 a[242:243], v30 offset:4096
    v_mfma_f32_16x16x32_bf16 v[116:119], a[212:215], a[92:95], v[116:119]
    ds_read_b64_tr_b16 a[244:245], v30 offset:8192
    v_mfma_f32_16x16x32_bf16 v[116:119], a[208:211], a[84:87], v[116:119]
    s_waitcnt lgkmcnt(11)
    ds_read_b64_tr_b16 a[246:247], v30 offset:12288
    v_mfma_f32_16x16x32_bf16 v[124:127], a[216:219], a[84:87], v[124:127]
    ds_read_b64_tr_b16 a[248:249], v31 offset:0
    v_mfma_f32_16x16x32_bf16 v[124:127], a[220:223], a[92:95], v[124:127]
    ds_read_b64_tr_b16 a[250:251], v31 offset:4096
    v_mfma_f32_16x16x32_bf16 v[120:123], a[220:223], a[88:91], v[120:123]
    ds_read_b64_tr_b16 a[252:253], v31 offset:8192
    v_mfma_f32_16x16x32_bf16 v[120:123], a[216:219], a[80:83], v[120:123]
    s_waitcnt lgkmcnt(11)
    ds_read_b64_tr_b16 a[254:255], v31 offset:12288
    v_mfma_f32_16x16x32_bf16 v[128:131], a[224:227], a[80:83], v[128:131]
    s_waitcnt vmcnt(8)
    s_barrier
    ds_read_b64_tr_b16 a[192:193], v162 offset:16384
    v_mfma_f32_16x16x32_bf16 v[128:131], a[228:231], a[88:91], v[128:131]
    ds_read_b64_tr_b16 a[194:195], v162 offset:20480
    v_mfma_f32_16x16x32_bf16 v[132:135], a[228:231], a[92:95], v[132:135]
    ds_read_b64_tr_b16 a[196:197], v162 offset:24576
    v_mfma_f32_16x16x32_bf16 v[132:135], a[224:227], a[84:87], v[132:135]
    s_waitcnt lgkmcnt(11)
    ds_read_b64_tr_b16 a[198:199], v162 offset:28672
    v_mfma_f32_16x16x32_bf16 v[140:143], a[232:235], a[84:87], v[140:143]
    ds_read_b64_tr_b16 a[200:201], v163 offset:16384
    v_mfma_f32_16x16x32_bf16 v[140:143], a[236:239], a[92:95], v[140:143]
    ds_read_b64_tr_b16 a[202:203], v163 offset:20480
    v_mfma_f32_16x16x32_bf16 v[136:139], a[236:239], a[88:91], v[136:139]
    ds_read_b64_tr_b16 a[204:205], v163 offset:24576
    v_mfma_f32_16x16x32_bf16 v[136:139], a[232:235], a[80:83], v[136:139]
    s_waitcnt lgkmcnt(11)
    ds_read_b64_tr_b16 a[206:207], v163 offset:28672
    v_mfma_f32_16x16x32_bf16 v[144:147], a[240:243], a[80:83], v[144:147]
    s_xor_b32 s49, s40, 1
    ds_read_b64_tr_b16 a[208:209], v164 offset:16384
    v_mfma_f32_16x16x32_bf16 v[144:147], a[244:247], a[88:91], v[144:147]
    s_mul_i32 s49, s49, 49152
    ds_read_b64_tr_b16 a[210:211], v164 offset:20480
    v_mfma_f32_16x16x32_bf16 v[148:151], a[244:247], a[92:95], v[148:151]
    s_add_u32 s49, s49, 0
    ds_read_b64_tr_b16 a[212:213], v164 offset:24576
    buffer_store_dwordx4 v[168:171], v9, s[8:11], s49 offen offset:1024 sc1
    v_mfma_f32_16x16x32_bf16 v[148:151], a[240:243], a[84:87], v[148:151]
    s_waitcnt lgkmcnt(11)
    ds_read_b64_tr_b16 a[214:215], v164 offset:28672
    v_mfma_f32_16x16x32_bf16 v[156:159], a[248:251], a[84:87], v[156:159]
    ds_read_b64_tr_b16 a[216:217], v165 offset:16384
    v_mfma_f32_16x16x32_bf16 v[156:159], a[252:255], a[92:95], v[156:159]
    ds_read_b64_tr_b16 a[218:219], v165 offset:20480
    v_mfma_f32_16x16x32_bf16 v[152:155], a[252:255], a[88:91], v[152:155]
    ds_read_b64_tr_b16 a[220:221], v165 offset:24576
    buffer_store_dwordx4 v[172:175], v9, s[8:11], s49 offen offset:3072 sc1
    v_mfma_f32_16x16x32_bf16 v[152:155], a[248:251], a[80:83], v[152:155]
    s_waitcnt lgkmcnt(11)
    ds_read_b64_tr_b16 a[222:223], v165 offset:28672
    s_waitcnt vmcnt(6)
    v_mfma_f32_16x16x32_bf16 v[112:115], a[192:195], a[96:99], v[112:115]
    s_xor_b32 s49, s40, 2
    ds_read_b64_tr_b16 a[224:225], v166 offset:16384
    v_mfma_f32_16x16x32_bf16 v[112:115], a[196:199], a[104:107], v[112:115]
    s_mul_i32 s49, s49, 49152
    ds_read_b64_tr_b16 a[226:227], v166 offset:20480
    v_mfma_f32_16x16x32_bf16 v[116:119], a[196:199], a[108:111], v[116:119]
    s_add_u32 s49, s49, 4096
    ds_read_b64_tr_b16 a[228:229], v166 offset:24576
    buffer_store_dwordx4 v[176:179], v9, s[8:11], s49 offen offset:1024 sc1
    v_mfma_f32_16x16x32_bf16 v[116:119], a[192:195], a[100:103], v[116:119]
    s_waitcnt lgkmcnt(11)
    ds_read_b64_tr_b16 a[230:231], v166 offset:28672
    v_mfma_f32_16x16x32_bf16 v[124:127], a[200:203], a[100:103], v[124:127]
    ds_read_b64_tr_b16 a[232:233], v167 offset:16384
    v_mfma_f32_16x16x32_bf16 v[124:127], a[204:207], a[108:111], v[124:127]
    ds_read_b64_tr_b16 a[234:235], v167 offset:20480
    v_mfma_f32_16x16x32_bf16 v[120:123], a[204:207], a[104:107], v[120:123]
    ds_read_b64_tr_b16 a[236:237], v167 offset:24576
    buffer_store_dwordx4 v[180:183], v9, s[8:11], s49 offen offset:3072 sc1
    v_mfma_f32_16x16x32_bf16 v[120:123], a[200:203], a[96:99], v[120:123]
    s_waitcnt lgkmcnt(11)
    ds_read_b64_tr_b16 a[238:239], v167 offset:28672
    v_mfma_f32_16x16x32_bf16 v[128:131], a[208:211], a[96:99], v[128:131]
    s_xor_b32 s49, s40, 3
    ds_read_b64_tr_b16 a[240:241], v26 offset:16384
    v_mfma_f32_16x16x32_bf16 v[128:131], a[212:215], a[104:107], v[128:131]
    s_mul_i32 s49, s49, 49152
    ds_read_b64_tr_b16 a[242:243], v26 offset:20480
    v_mfma_f32_16x16x32_bf16 v[132:135], a[212:215], a[108:111], v[132:135]
    s_add_u32 s49, s49, 8192
    ds_read_b64_tr_b16 a[244:245], v26 offset:24576
    buffer_store_dwordx4 v[184:187], v9, s[8:11], s49 offen offset:1024 sc1
    v_mfma_f32_16x16x32_bf16 v[132:135], a[208:211], a[100:103], v[132:135]
    s_waitcnt lgkmcnt(11)
    ds_read_b64_tr_b16 a[246:247], v26 offset:28672
    v_mfma_f32_16x16x32_bf16 v[140:143], a[216:219], a[100:103], v[140:143]
    ds_read_b64_tr_b16 a[248:249], v27 offset:16384
    v_mfma_f32_16x16x32_bf16 v[140:143], a[220:223], a[108:111], v[140:143]
    ds_read_b64_tr_b16 a[250:251], v27 offset:20480
    v_mfma_f32_16x16x32_bf16 v[136:139], a[220:223], a[104:107], v[136:139]
    ds_read_b64_tr_b16 a[252:253], v27 offset:24576
    buffer_store_dwordx4 v[188:191], v9, s[8:11], s49 offen offset:3072 sc1
    v_mfma_f32_16x16x32_bf16 v[136:139], a[216:219], a[96:99], v[136:139]
    s_waitcnt lgkmcnt(11)
    ds_read_b64_tr_b16 a[254:255], v27 offset:28672
    v_mfma_f32_16x16x32_bf16 v[144:147], a[224:227], a[96:99], v[144:147]
    ds_read_b64_tr_b16 a[192:193], v28 offset:16384
    v_mfma_f32_16x16x32_bf16 v[144:147], a[228:231], a[104:107], v[144:147]
    ds_read_b64_tr_b16 a[194:195], v28 offset:20480
    v_mfma_f32_16x16x32_bf16 v[148:151], a[228:231], a[108:111], v[148:151]
    ds_read_b64_tr_b16 a[196:197], v28 offset:24576
    v_mfma_f32_16x16x32_bf16 v[148:151], a[224:227], a[100:103], v[148:151]
    s_waitcnt lgkmcnt(11)
    ds_read_b64_tr_b16 a[198:199], v28 offset:28672
    v_mfma_f32_16x16x32_bf16 v[156:159], a[232:235], a[100:103], v[156:159]
    ds_read_b64_tr_b16 a[200:201], v29 offset:16384
    v_mfma_f32_16x16x32_bf16 v[156:159], a[236:239], a[108:111], v[156:159]
    ds_read_b64_tr_b16 a[202:203], v29 offset:20480
    v_mfma_f32_16x16x32_bf16 v[152:155], a[236:239], a[104:107], v[152:155]
    ds_read_b64_tr_b16 a[204:205], v29 offset:24576
    v_mfma_f32_16x16x32_bf16 v[152:155], a[232:235], a[96:99], v[152:155]
    s_waitcnt lgkmcnt(11)
    ds_read_b64_tr_b16 a[206:207], v29 offset:28672
    s_waitcnt vmcnt(6)
    v_mfma_f32_16x16x32_bf16 v[112:115], a[240:243], a[112:115], v[112:115]
    ds_read_b64_tr_b16 a[208:209], v30 offset:16384
    v_mfma_f32_16x16x32_bf16 v[112:115], a[244:247], a[120:123], v[112:115]
    ds_read_b64_tr_b16 a[210:211], v30 offset:20480
    v_mfma_f32_16x16x32_bf16 v[116:119], a[244:247], a[124:127], v[116:119]
    ds_read_b64_tr_b16 a[212:213], v30 offset:24576
    v_mfma_f32_16x16x32_bf16 v[116:119], a[240:243], a[116:119], v[116:119]
    s_waitcnt lgkmcnt(11)
    ds_read_b64_tr_b16 a[214:215], v30 offset:28672
    v_mfma_f32_16x16x32_bf16 v[124:127], a[248:251], a[116:119], v[124:127]
    ds_read_b64_tr_b16 a[216:217], v31 offset:16384
    v_mfma_f32_16x16x32_bf16 v[124:127], a[252:255], a[124:127], v[124:127]
    ds_read_b64_tr_b16 a[218:219], v31 offset:20480
    v_mfma_f32_16x16x32_bf16 v[120:123], a[252:255], a[120:123], v[120:123]
    ds_read_b64_tr_b16 a[220:221], v31 offset:24576
    v_mfma_f32_16x16x32_bf16 v[120:123], a[248:251], a[112:115], v[120:123]
    s_waitcnt lgkmcnt(11)
    ds_read_b64_tr_b16 a[222:223], v31 offset:28672
    v_mfma_f32_16x16x32_bf16 v[128:131], a[192:195], a[112:115], v[128:131]
    ds_read_b64_tr_b16 a[224:225], v160 offset:49152
    v_mfma_f32_16x16x32_bf16 v[128:131], a[196:199], a[120:123], v[128:131]
    ds_read_b64_tr_b16 a[226:227], v160 offset:53248
    v_mfma_f32_16x16x32_bf16 v[132:135], a[196:199], a[124:127], v[132:135]
    ds_read_b64_tr_b16 a[228:229], v160 offset:57344
    v_mfma_f32_16x16x32_bf16 v[132:135], a[192:195], a[116:119], v[132:135]
    s_waitcnt lgkmcnt(11)
    ds_read_b64_tr_b16 a[230:231], v160 offset:61440
    v_mfma_f32_16x16x32_bf16 v[140:143], a[200:203], a[116:119], v[140:143]
    ds_read_b64_tr_b16 a[232:233], v161 offset:49152
    v_mfma_f32_16x16x32_bf16 v[140:143], a[204:207], a[124:127], v[140:143]
    ds_read_b64_tr_b16 a[234:235], v161 offset:53248
    v_mfma_f32_16x16x32_bf16 v[136:139], a[204:207], a[120:123], v[136:139]
    ds_read_b64_tr_b16 a[236:237], v161 offset:57344
    v_mfma_f32_16x16x32_bf16 v[136:139], a[200:203], a[112:115], v[136:139]
    s_waitcnt lgkmcnt(11)
    ds_read_b64_tr_b16 a[238:239], v161 offset:61440
    v_mfma_f32_16x16x32_bf16 v[144:147], a[208:211], a[112:115], v[144:147]
    ds_read_b64_tr_b16 a[240:241], v24 offset:49152
    v_mfma_f32_16x16x32_bf16 v[144:147], a[212:215], a[120:123], v[144:147]
    ds_read_b64_tr_b16 a[242:243], v24 offset:53248
    v_mfma_f32_16x16x32_bf16 v[148:151], a[212:215], a[124:127], v[148:151]
    ds_read_b64_tr_b16 a[244:245], v24 offset:57344
    v_mfma_f32_16x16x32_bf16 v[148:151], a[208:211], a[116:119], v[148:151]
    s_waitcnt lgkmcnt(11)
    ds_read_b64_tr_b16 a[246:247], v24 offset:61440
    v_mfma_f32_16x16x32_bf16 v[156:159], a[216:219], a[116:119], v[156:159]
    ds_read_b64_tr_b16 a[248:249], v25 offset:49152
    v_mfma_f32_16x16x32_bf16 v[156:159], a[220:223], a[124:127], v[156:159]
    ds_read_b64_tr_b16 a[250:251], v25 offset:53248
    v_mfma_f32_16x16x32_bf16 v[152:155], a[220:223], a[120:123], v[152:155]
    ds_read_b64_tr_b16 a[252:253], v25 offset:57344
    v_mfma_f32_16x16x32_bf16 v[152:155], a[216:219], a[112:115], v[152:155]
    s_waitcnt lgkmcnt(11)
    ds_read_b64_tr_b16 a[254:255], v25 offset:61440
    v_cvt_pk_bf16_f32 v48, v112, v113
    v_cvt_pk_bf16_f32 v49, v114, v115
    v_cvt_pk_bf16_f32 v50, v116, v117
    v_cvt_pk_bf16_f32 v51, v118, v119
    v_cvt_pk_bf16_f32 v52, v120, v121
    v_cvt_pk_bf16_f32 v53, v122, v123
    v_cvt_pk_bf16_f32 v54, v124, v125
    v_cvt_pk_bf16_f32 v55, v126, v127
    s_xor_b32 s49, s40, 1
    s_mul_i32 s49, s49, 49152
    s_add_u32 s49, s49, 0
    buffer_store_dwordx4 v[48:51], v9, s[8:11], s49 offen offset:0 sc1
    buffer_store_dwordx4 v[52:55], v9, s[8:11], s49 offen offset:2048 sc1
    v_cvt_pk_bf16_f32 v56, v128, v129
    v_cvt_pk_bf16_f32 v57, v130, v131
    v_cvt_pk_bf16_f32 v58, v132, v133
    v_cvt_pk_bf16_f32 v59, v134, v135
    v_cvt_pk_bf16_f32 v60, v136, v137
    v_cvt_pk_bf16_f32 v61, v138, v139
    v_cvt_pk_bf16_f32 v62, v140, v141
    v_cvt_pk_bf16_f32 v63, v142, v143
    s_xor_b32 s49, s40, 2
    s_mul_i32 s49, s49, 49152
    s_add_u32 s49, s49, 4096
    buffer_store_dwordx4 v[56:59], v9, s[8:11], s49 offen offset:0 sc1
    buffer_store_dwordx4 v[60:63], v9, s[8:11], s49 offen offset:2048 sc1
    v_cvt_pk_bf16_f32 v64, v144, v145
    v_cvt_pk_bf16_f32 v65, v146, v147
    v_cvt_pk_bf16_f32 v66, v148, v149
    v_cvt_pk_bf16_f32 v67, v150, v151
    v_cvt_pk_bf16_f32 v68, v152, v153
    v_cvt_pk_bf16_f32 v69, v154, v155
    v_cvt_pk_bf16_f32 v70, v156, v157
    v_cvt_pk_bf16_f32 v71, v158, v159
    s_xor_b32 s49, s40, 3
    s_mul_i32 s49, s49, 49152
    s_add_u32 s49, s49, 8192
    buffer_store_dwordx4 v[64:67], v9, s[8:11], s49 offen offset:0 sc1
    buffer_store_dwordx4 v[68:71], v9, s[8:11], s49 offen offset:2048 sc1
    v_mfma_f32_16x16x32_bf16 v[96:99], a[224:227], a[0:3], v[96:99]
    ds_read_b64_tr_b16 a[192:193], v1 offset:0
    v_mfma_f32_16x16x32_bf16 v[96:99], a[228:231], a[8:11], v[96:99]
    ds_read_b64_tr_b16 a[194:195], v1 offset:4096
    v_mfma_f32_16x16x32_bf16 v[100:103], a[228:231], a[12:15], v[100:103]
    ds_read_b64_tr_b16 a[196:197], v1 offset:8192
    v_mfma_f32_16x16x32_bf16 v[100:103], a[224:227], a[4:7], v[100:103]
    s_waitcnt lgkmcnt(11)
    ds_read_b64_tr_b16 a[198:199], v1 offset:12288
    v_mfma_f32_16x16x32_bf16 v[108:111], a[232:235], a[4:7], v[108:111]
    ds_read_b64_tr_b16 a[200:201], v2 offset:0
    v_mfma_f32_16x16x32_bf16 v[108:111], a[236:239], a[12:15], v[108:111]
    ds_read_b64_tr_b16 a[202:203], v2 offset:4096
    v_mfma_f32_16x16x32_bf16 v[104:107], a[236:239], a[8:11], v[104:107]
    ds_read_b64_tr_b16 a[204:205], v2 offset:8192
    v_mfma_f32_16x16x32_bf16 v[104:107], a[232:235], a[0:3], v[104:107]
    s_waitcnt lgkmcnt(11)
    ds_read_b64_tr_b16 a[206:207], v2 offset:12288
    v_mfma_f32_16x16x32_bf16 v[96:99], a[240:243], a[16:19], v[96:99]
    ds_read_b64_tr_b16 a[208:209], v1 offset:16384
    v_mfma_f32_16x16x32_bf16 v[96:99], a[244:247], a[24:27], v[96:99]
    ds_read_b64_tr_b16 a[210:211], v1 offset:20480
    v_mfma_f32_16x16x32_bf16 v[100:103], a[244:247], a[28:31], v[100:103]
    ds_read_b64_tr_b16 a[212:213], v1 offset:24576
    v_mfma_f32_16x16x32_bf16 v[100:103], a[240:243], a[20:23], v[100:103]
    s_waitcnt lgkmcnt(11)
    ds_read_b64_tr_b16 a[214:215], v1 offset:28672
    v_mfma_f32_16x16x32_bf16 v[108:111], a[248:251], a[20:23], v[108:111]
    ds_read_b64_tr_b16 a[216:217], v2 offset:16384
    v_mfma_f32_16x16x32_bf16 v[108:111], a[252:255], a[28:31], v[108:111]
    ds_read_b64_tr_b16 a[218:219], v2 offset:20480
    v_mfma_f32_16x16x32_bf16 v[104:107], a[252:255], a[24:27], v[104:107]
    ds_read_b64_tr_b16 a[220:221], v2 offset:24576
    v_mfma_f32_16x16x32_bf16 v[104:107], a[248:251], a[16:19], v[104:107]
    s_waitcnt lgkmcnt(11)
    ds_read_b64_tr_b16 a[222:223], v2 offset:28672
    v_mfma_f32_16x16x32_bf16 v[96:99], a[192:195], a[32:35], v[96:99]
    ds_read_b64_tr_b16 a[224:225], v160 offset:0
    v_mfma_f32_16x16x32_bf16 v[96:99], a[196:199], a[40:43], v[96:99]
    ds_read_b64_tr_b16 a[226:227], v160 offset:4096
    v_mfma_f32_16x16x32_bf16 v[100:103], a[196:199], a[44:47], v[100:103]
    ds_read_b64_tr_b16 a[228:229], v160 offset:8192
    v_mfma_f32_16x16x32_bf16 v[100:103], a[192:195], a[36:39], v[100:103]
    s_waitcnt lgkmcnt(11)
    ds_read_b64_tr_b16 a[230:231], v160 offset:12288
    v_mfma_f32_16x16x32_bf16 v[108:111], a[200:203], a[36:39], v[108:111]
    ds_read_b64_tr_b16 a[232:233], v161 offset:0
    v_mfma_f32_16x16x32_bf16 v[108:111], a[204:207], a[44:47], v[108:111]
    ds_read_b64_tr_b16 a[234:235], v161 offset:4096
    v_mfma_f32_16x16x32_bf16 v[104:107], a[204:207], a[40:43], v[104:107]
    ds_read_b64_tr_b16 a[236:237], v161 offset:8192
    v_mfma_f32_16x16x32_bf16 v[104:107], a[200:203], a[32:35], v[104:107]
    s_waitcnt lgkmcnt(11)
    ds_read_b64_tr_b16 a[238:239], v161 offset:12288
    s_waitcnt vmcnt(0)
    v_lshlrev_b32 v7, 2, v0
    s_mov_b64 exec, 3
    buffer_store_dword v22, v7, s[28:31], s51 offen sc1
    s_mov_b64 exec, -1
    v_mov_b32 v7, v12
    v_mfma_f32_16x16x32_bf16 v[96:99], a[208:211], a[48:51], v[96:99]
    ds_read_b64_tr_b16 a[240:241], v24 offset:0
    v_mfma_f32_16x16x32_bf16 v[96:99], a[212:215], a[56:59], v[96:99]
    ds_read_b64_tr_b16 a[242:243], v24 offset:4096
    v_mfma_f32_16x16x32_bf16 v[100:103], a[212:215], a[60:63], v[100:103]
    ds_read_b64_tr_b16 a[244:245], v24 offset:8192
    v_mfma_f32_16x16x32_bf16 v[100:103], a[208:211], a[52:55], v[100:103]
    s_waitcnt lgkmcnt(11)
    ds_read_b64_tr_b16 a[246:247], v24 offset:12288
    v_mfma_f32_16x16x32_bf16 v[108:111], a[216:219], a[52:55], v[108:111]
    ds_read_b64_tr_b16 a[248:249], v25 offset:0
    v_mfma_f32_16x16x32_bf16 v[108:111], a[220:223], a[60:63], v[108:111]
    ds_read_b64_tr_b16 a[250:251], v25 offset:4096
    v_mfma_f32_16x16x32_bf16 v[104:107], a[220:223], a[56:59], v[104:107]
    ds_read_b64_tr_b16 a[252:253], v25 offset:8192
    v_mfma_f32_16x16x32_bf16 v[104:107], a[216:219], a[48:51], v[104:107]
    s_waitcnt lgkmcnt(11)
    ds_read_b64_tr_b16 a[254:255], v25 offset:12288
    v_mfma_f32_16x16x32_bf16 v[96:99], a[224:227], a[64:67], v[96:99]
    ds_read_b64_tr_b16 a[192:193], v160 offset:16384
    v_mfma_f32_16x16x32_bf16 v[96:99], a[228:231], a[72:75], v[96:99]
    ds_read_b64_tr_b16 a[194:195], v160 offset:20480
    v_mfma_f32_16x16x32_bf16 v[100:103], a[228:231], a[76:79], v[100:103]
    ds_read_b64_tr_b16 a[196:197], v160 offset:24576
    v_mfma_f32_16x16x32_bf16 v[100:103], a[224:227], a[68:71], v[100:103]
    s_waitcnt lgkmcnt(11)
    ds_read_b64_tr_b16 a[198:199], v160 offset:28672
    v_mfma_f32_16x16x32_bf16 v[108:111], a[232:235], a[68:71], v[108:111]
    ds_read_b64_tr_b16 a[200:201], v161 offset:16384
    v_mfma_f32_16x16x32_bf16 v[108:111], a[236:239], a[76:79], v[108:111]
    ds_read_b64_tr_b16 a[202:203], v161 offset:20480
    v_mfma_f32_16x16x32_bf16 v[104:107], a[236:239], a[72:75], v[104:107]
    ds_read_b64_tr_b16 a[204:205], v161 offset:24576
    v_mfma_f32_16x16x32_bf16 v[104:107], a[232:235], a[64:67], v[104:107]
    s_waitcnt lgkmcnt(11)
    ds_read_b64_tr_b16 a[206:207], v161 offset:28672
    v_mfma_f32_16x16x32_bf16 v[96:99], a[240:243], a[80:83], v[96:99]
    ds_read_b64_tr_b16 a[208:209], v24 offset:16384
    v_mfma_f32_16x16x32_bf16 v[96:99], a[244:247], a[88:91], v[96:99]
    ds_read_b64_tr_b16 a[210:211], v24 offset:20480
    v_mfma_f32_16x16x32_bf16 v[100:103], a[244:247], a[92:95], v[100:103]
    ds_read_b64_tr_b16 a[212:213], v24 offset:24576
    v_mfma_f32_16x16x32_bf16 v[100:103], a[240:243], a[84:87], v[100:103]
    s_waitcnt lgkmcnt(11)
    ds_read_b64_tr_b16 a[214:215], v24 offset:28672
    v_mfma_f32_16x16x32_bf16 v[108:111], a[248:251], a[84:87], v[108:111]
    ds_read_b64_tr_b16 a[216:217], v25 offset:16384
    v_mfma_f32_16x16x32_bf16 v[108:111], a[252:255], a[92:95], v[108:111]
    ds_read_b64_tr_b16 a[218:219], v25 offset:20480
    v_mfma_f32_16x16x32_bf16 v[104:107], a[252:255], a[88:91], v[104:107]
    ds_read_b64_tr_b16 a[220:221], v25 offset:24576
    v_mfma_f32_16x16x32_bf16 v[104:107], a[248:251], a[80:83], v[104:107]
    s_waitcnt lgkmcnt(11)
    ds_read_b64_tr_b16 a[222:223], v25 offset:28672
    v_mfma_f32_16x16x32_bf16 v[96:99], a[192:195], a[96:99], v[96:99]
    v_mfma_f32_16x16x32_bf16 v[96:99], a[196:199], a[104:107], v[96:99]
    v_mfma_f32_16x16x32_bf16 v[100:103], a[196:199], a[108:111], v[100:103]
    v_mfma_f32_16x16x32_bf16 v[100:103], a[192:195], a[100:103], v[100:103]
    s_waitcnt lgkmcnt(8)
    v_mfma_f32_16x16x32_bf16 v[108:111], a[200:203], a[100:103], v[108:111]
    v_mfma_f32_16x16x32_bf16 v[108:111], a[204:207], a[108:111], v[108:111]
    v_mfma_f32_16x16x32_bf16 v[104:107], a[204:207], a[104:107], v[104:107]
    v_mfma_f32_16x16x32_bf16 v[104:107], a[200:203], a[96:99], v[104:107]
    s_waitcnt lgkmcnt(4)
    v_mfma_f32_16x16x32_bf16 v[96:99], a[208:211], a[112:115], v[96:99]
    v_mfma_f32_16x16x32_bf16 v[96:99], a[212:215], a[120:123], v[96:99]
    v_mfma_f32_16x16x32_bf16 v[100:103], a[212:215], a[124:127], v[100:103]
    v_mfma_f32_16x16x32_bf16 v[100:103], a[208:211], a[116:119], v[100:103]
    s_waitcnt lgkmcnt(0)
    v_mfma_f32_16x16x32_bf16 v[108:111], a[216:219], a[116:119], v[108:111]
    v_mfma_f32_16x16x32_bf16 v[108:111], a[220:223], a[124:127], v[108:111]
    v_mfma_f32_16x16x32_bf16 v[104:107], a[220:223], a[120:123], v[104:107]
    v_mfma_f32_16x16x32_bf16 v[104:107], a[216:219], a[112:115], v[104:107]
    s_mov_b32 s49, 262144
L_pp:
    buffer_load_dword v8, v7, s[28:31], s52 offen sc1
    s_sub_u32 s49, s49, 1
    s_cbranch_scc1 L_pp_x
    s_waitcnt vmcnt(0)
    v_cmp_ne_u32 vcc, v22, v8
    s_nop 1
    s_cbranch_vccnz L_pp
L_pp_x:
    s_movk_i32 s50, 0
    buffer_load_dwordx4 v[232:235], v9, s[92:95], s50 offen offset:1024 sc1
    buffer_load_dwordx4 v[236:239], v9, s[92:95], s50 offen offset:3072 sc1
    s_movk_i32 s50, 4096
    buffer_load_dwordx4 v[240:243], v9, s[92:95], s50 offen offset:1024 sc1
    buffer_load_dwordx4 v[244:247], v9, s[92:95], s50 offen offset:3072 sc1
    s_movk_i32 s50, 8192
    buffer_load_dwordx4 v[248:251], v9, s[92:95], s50 offen offset:1024 sc1
    buffer_load_dwordx4 v[252:255], v9, s[92:95], s50 offen offset:3072 sc1
    s_movk_i32 s50, 0
    buffer_load_dwordx4 v[208:211], v9, s[92:95], s50 offen offset:0 sc1
    buffer_load_dwordx4 v[212:215], v9, s[92:95], s50 offen offset:2048 sc1
    s_movk_i32 s50, 4096
    buffer_load_dwordx4 v[216:219], v9, s[92:95], s50 offen offset:0 sc1
    buffer_load_dwordx4 v[220:223], v9, s[92:95], s50 offen offset:2048 sc1
    s_movk_i32 s50, 8192
    buffer_load_dwordx4 v[224:227], v9, s[92:95], s50 offen offset:0 sc1
    buffer_load_dwordx4 v[228:231], v9, s[92:95], s50 offen offset:2048 sc1
    s_waitcnt vmcnt(10)
    v_lshlrev_b32 v112, 16, v232
    v_and_b32 v113, 0xffff0000, v232
    v_lshlrev_b32 v114, 16, v233
    v_and_b32 v115, 0xffff0000, v233
    v_lshlrev_b32 v116, 16, v234
    v_and_b32 v117, 0xffff0000, v234
    v_lshlrev_b32 v118, 16, v235
    v_and_b32 v119, 0xffff0000, v235
    v_lshlrev_b32 v120, 16, v236
    v_and_b32 v121, 0xffff0000, v236
    v_lshlrev_b32 v122, 16, v237
    v_and_b32 v123, 0xffff0000, v237
    v_lshlrev_b32 v124, 16, v238
    v_and_b32 v125, 0xffff0000, v238
    v_lshlrev_b32 v126, 16, v239
    v_and_b32 v127, 0xffff0000, v239
    v_pk_add_f32 v[32:33], v[32:33], v[112:113]
    v_pk_add_f32 v[34:35], v[34:35], v[114:115]
    v_pk_add_f32 v[36:37], v[36:37], v[116:117]
    v_pk_add_f32 v[38:39], v[38:39], v[118:119]
    v_pk_add_f32 v[40:41], v[40:41], v[120:121]
    v_pk_add_f32 v[42:43], v[42:43], v[122:123]
    v_pk_add_f32 v[44:45], v[44:45], v[124:125]
    v_pk_add_f32 v[46:47], v[46:47], v[126:127]
    s_waitcnt vmcnt(8)
    v_lshlrev_b32 v112, 16, v240
    v_and_b32 v113, 0xffff0000, v240
    v_lshlrev_b32 v114, 16, v241
    v_and_b32 v115, 0xffff0000, v241
    v_lshlrev_b32 v116, 16, v242
    v_and_b32 v117, 0xffff0000, v242
    v_lshlrev_b32 v118, 16, v243
    v_and_b32 v119, 0xffff0000, v243
    v_lshlrev_b32 v120, 16, v244
    v_and_b32 v121, 0xffff0000, v244
    v_lshlrev_b32 v122, 16, v245
    v_and_b32 v123, 0xffff0000, v245
    v_lshlrev_b32 v124, 16, v246
    v_and_b32 v125, 0xffff0000, v246
    v_lshlrev_b32 v126, 16, v247
    v_and_b32 v127, 0xffff0000, v247
    v_pk_add_f32 v[32:33], v[32:33], v[112:113]
    v_pk_add_f32 v[34:35], v[34:35], v[114:115]
    v_pk_add_f32 v[36:37], v[36:37], v[116:117]
    v_pk_add_f32 v[38:39], v[38:39], v[118:119]
    v_pk_add_f32 v[40:41], v[40:41], v[120:121]
    v_pk_add_f32 v[42:43], v[42:43], v[122:123]
    v_pk_add_f32 v[44:45], v[44:45], v[124:125]
    v_pk_add_f32 v[46:47], v[46:47], v[126:127]
    s_waitcnt vmcnt(6)
    v_lshlrev_b32 v112, 16, v248
    v_and_b32 v113, 0xffff0000, v248
    v_lshlrev_b32 v114, 16, v249
    v_and_b32 v115, 0xffff0000, v249
    v_lshlrev_b32 v116, 16, v250
    v_and_b32 v117, 0xffff0000, v250
    v_lshlrev_b32 v118, 16, v251
    v_and_b32 v119, 0xffff0000, v251
    v_lshlrev_b32 v120, 16, v252
    v_and_b32 v121, 0xffff0000, v252
    v_lshlrev_b32 v122, 16, v253
    v_and_b32 v123, 0xffff0000, v253
    v_lshlrev_b32 v124, 16, v254
    v_and_b32 v125, 0xffff0000, v254
    v_lshlrev_b32 v126, 16, v255
    v_and_b32 v127, 0xffff0000, v255
    v_pk_add_f32 v[32:33], v[32:33], v[112:113]
    v_pk_add_f32 v[34:35], v[34:35], v[114:115]
    v_pk_add_f32 v[36:37], v[36:37], v[116:117]
    v_pk_add_f32 v[38:39], v[38:39], v[118:119]
    v_pk_add_f32 v[40:41], v[40:41], v[120:121]
    v_pk_add_f32 v[42:43], v[42:43], v[122:123]
    v_pk_add_f32 v[44:45], v[44:45], v[124:125]
    v_pk_add_f32 v[46:47], v[46:47], v[126:127]
    v_pk_mul_f32 v[128:129], v[32:33], s[6:7]
    v_pk_mul_f32 v[130:131], v[34:35], s[6:7]
    v_pk_mul_f32 v[132:133], v[36:37], s[6:7]
    v_pk_mul_f32 v[134:135], v[38:39], s[6:7]
    v_pk_mul_f32 v[136:137], v[40:41], s[6:7]
    v_pk_mul_f32 v[138:139], v[42:43], s[6:7]
    v_pk_mul_f32 v[140:141], v[44:45], s[6:7]
    v_pk_mul_f32 v[142:143], v[46:47], s[6:7]
    v_exp_f32 v128, v128
    v_exp_f32 v129, v129
    v_exp_f32 v130, v130
    v_exp_f32 v131, v131
    v_exp_f32 v132, v132
    v_exp_f32 v133, v133
    v_exp_f32 v134, v134
    v_exp_f32 v135, v135
    v_exp_f32 v136, v136
    v_exp_f32 v137, v137
    v_exp_f32 v138, v138
    v_exp_f32 v139, v139
    v_exp_f32 v140, v140
    v_exp_f32 v141, v141
    v_exp_f32 v142, v142
    v_exp_f32 v143, v143
    v_pk_add_f32 v[128:129], v[128:129], 1.0 op_sel_hi:[1,0]
    v_pk_add_f32 v[130:131], v[130:131], 1.0 op_sel_hi:[1,0]
    v_pk_add_f32 v[132:133], v[132:133], 1.0 op_sel_hi:[1,0]
    v_pk_add_f32 v[134:135], v[134:135], 1.0 op_sel_hi:[1,0]
    v_pk_add_f32 v[136:137], v[136:137], 1.0 op_sel_hi:[1,0]
    v_pk_add_f32 v[138:139], v[138:139], 1.0 op_sel_hi:[1,0]
    v_pk_add_f32 v[140:141], v[140:141], 1.0 op_sel_hi:[1,0]
    v_pk_add_f32 v[142:143], v[142:143], 1.0 op_sel_hi:[1,0]
    v_rcp_f32 v128, v128
    v_rcp_f32 v129, v129
    v_rcp_f32 v130, v130
    v_rcp_f32 v131, v131
    v_rcp_f32 v132, v132
    v_rcp_f32 v133, v133
    v_rcp_f32 v134, v134
    v_rcp_f32 v135, v135
    v_rcp_f32 v136, v136
    v_rcp_f32 v137, v137
    v_rcp_f32 v138, v138
    v_rcp_f32 v139, v139
    v_rcp_f32 v140, v140
    v_rcp_f32 v141, v141
    v_rcp_f32 v142, v142
    v_rcp_f32 v143, v143
    s_nop 0
    v_pk_mul_f32 v[128:129], v[128:129], v[32:33]
    v_pk_mul_f32 v[130:131], v[130:131], v[34:35]
    v_pk_mul_f32 v[132:133], v[132:133], v[36:37]
    v_pk_mul_f32 v[134:135], v[134:135], v[38:39]
    v_pk_mul_f32 v[136:137], v[136:137], v[40:41]
    v_pk_mul_f32 v[138:139], v[138:139], v[42:43]
    v_pk_mul_f32 v[140:141], v[140:141], v[44:45]
    v_pk_mul_f32 v[142:143], v[142:143], v[46:47]
    s_waitcnt vmcnt(4)
    v_lshlrev_b32 v112, 16, v208
    v_and_b32 v113, 0xffff0000, v208
    v_lshlrev_b32 v114, 16, v209
    v_and_b32 v115, 0xffff0000, v209
    v_lshlrev_b32 v116, 16, v210
    v_and_b32 v117, 0xffff0000, v210
    v_lshlrev_b32 v118, 16, v211
    v_and_b32 v119, 0xffff0000, v211
    v_lshlrev_b32 v120, 16, v212
    v_and_b32 v121, 0xffff0000, v212
    v_lshlrev_b32 v122, 16, v213
    v_and_b32 v123, 0xffff0000, v213
    v_lshlrev_b32 v124, 16, v214
    v_and_b32 v125, 0xffff0000, v214
    v_lshlrev_b32 v126, 16, v215
    v_and_b32 v127, 0xffff0000, v215
    v_pk_add_f32 v[96:97], v[96:97], v[112:113]
    v_pk_add_f32 v[98:99], v[98:99], v[114:115]
    v_pk_add_f32 v[100:101], v[100:101], v[116:117]
    v_pk_add_f32 v[102:103], v[102:103], v[118:119]
    v_pk_add_f32 v[104:105], v[104:105], v[120:121]
    v_pk_add_f32 v[106:107], v[106:107], v[122:123]
    v_pk_add_f32 v[108:109], v[108:109], v[124:125]
    v_pk_add_f32 v[110:111], v[110:111], v[126:127]
    s_waitcnt vmcnt(2)
    v_lshlrev_b32 v112, 16, v216
    v_and_b32 v113, 0xffff0000, v216
    v_lshlrev_b32 v114, 16, v217
    v_and_b32 v115, 0xffff0000, v217
    v_lshlrev_b32 v116, 16, v218
    v_and_b32 v117, 0xffff0000, v218
    v_lshlrev_b32 v118, 16, v219
    v_and_b32 v119, 0xffff0000, v219
    v_lshlrev_b32 v120, 16, v220
    v_and_b32 v121, 0xffff0000, v220
    v_lshlrev_b32 v122, 16, v221
    v_and_b32 v123, 0xffff0000, v221
    v_lshlrev_b32 v124, 16, v222
    v_and_b32 v125, 0xffff0000, v222
    v_lshlrev_b32 v126, 16, v223
    v_and_b32 v127, 0xffff0000, v223
    v_pk_add_f32 v[96:97], v[96:97], v[112:113]
    v_pk_add_f32 v[98:99], v[98:99], v[114:115]
    v_pk_add_f32 v[100:101], v[100:101], v[116:117]
    v_pk_add_f32 v[102:103], v[102:103], v[118:119]
    v_pk_add_f32 v[104:105], v[104:105], v[120:121]
    v_pk_add_f32 v[106:107], v[106:107], v[122:123]
    v_pk_add_f32 v[108:109], v[108:109], v[124:125]
    v_pk_add_f32 v[110:111], v[110:111], v[126:127]
    s_waitcnt vmcnt(0)
    v_lshlrev_b32 v112, 16, v224
    v_and_b32 v113, 0xffff0000, v224
    v_lshlrev_b32 v114, 16, v225
    v_and_b32 v115, 0xffff0000, v225
    v_lshlrev_b32 v116, 16, v226
    v_and_b32 v117, 0xffff0000, v226
    v_lshlrev_b32 v118, 16, v227
    v_and_b32 v119, 0xffff0000, v227
    v_lshlrev_b32 v120, 16, v228
    v_and_b32 v121, 0xffff0000, v228
    v_lshlrev_b32 v122, 16, v229
    v_and_b32 v123, 0xffff0000, v229
    v_lshlrev_b32 v124, 16, v230
    v_and_b32 v125, 0xffff0000, v230
    v_lshlrev_b32 v126, 16, v231
    v_and_b32 v127, 0xffff0000, v231
    v_pk_add_f32 v[96:97], v[96:97], v[112:113]
    v_pk_add_f32 v[98:99], v[98:99], v[114:115]
    v_pk_add_f32 v[100:101], v[100:101], v[116:117]
    v_pk_add_f32 v[102:103], v[102:103], v[118:119]
    v_pk_add_f32 v[104:105], v[104:105], v[120:121]
    v_pk_add_f32 v[106:107], v[106:107], v[122:123]
    v_pk_add_f32 v[108:109], v[108:109], v[124:125]
    v_pk_add_f32 v[110:111], v[110:111], v[126:127]
    v_pk_fma_f32 v[128:129], v[128:129], v[96:97], v[80:81]
    v_pk_fma_f32 v[130:131], v[130:131], v[98:99], v[82:83]
    v_pk_fma_f32 v[132:133], v[132:133], v[100:101], v[84:85]
    v_pk_fma_f32 v[134:135], v[134:135], v[102:103], v[86:87]
    v_pk_fma_f32 v[136:137], v[136:137], v[104:105], v[88:89]
    v_pk_fma_f32 v[138:139], v[138:139], v[106:107], v[90:91]
    v_pk_fma_f32 v[140:141], v[140:141], v[108:109], v[92:93]
    v_pk_fma_f32 v[142:143], v[142:143], v[110:111], v[94:95]
    v_cvt_pk_bf16_f32 v112, v128, v129
    v_cvt_pk_bf16_f32 v113, v130, v131
    v_cvt_pk_bf16_f32 v114, v132, v133
    v_cvt_pk_bf16_f32 v115, v134, v135
    v_cvt_pk_bf16_f32 v116, v136, v137
    v_cvt_pk_bf16_f32 v117, v138, v139
    v_cvt_pk_bf16_f32 v118, v140, v141
    v_cvt_pk_bf16_f32 v119, v142, v143
    buffer_store_dwordx2 v[112:113], v18, s[12:15], 0 offen offset:0
    buffer_store_dwordx2 v[114:115], v19, s[12:15], 0 offen offset:0
    buffer_store_dwordx2 v[116:117], v18, s[12:15], 0 offen offset:32
    buffer_store_dwordx2 v[118:119], v19, s[12:15], 0 offen offset:32
L_end:
    s_endpgm
L_retry:
    s_mov_b32 s48, 1
    s_lshl_b32 s49, s36, 6
    v_add_u32 v0, s49, v0
    s_waitcnt vmcnt(0) lgkmcnt(0)
    s_barrier
    s_branch L_start
L_maxpass:
    s_waitcnt vmcnt(0) lgkmcnt(0)
    s_mov_b32 s45, 0
    s_mov_b32 m0, s39
    v_mov_b32 v176, 0xff800000
    v_mov_b32 v178, 0xff800000
    v_mov_b32 v180, 0xff800000
    v_mov_b32 v182, 0xff800000
L_mloop:
    s_barrier
    buffer_load_dwordx4 v1, s[8:11], s45 offen offset:0 lds
    buffer_load_dwordx4 v2, s[8:11], s45 offen offset:1024 lds
    buffer_load_dwordx4 v3, s[8:11], s45 offen offset:2048 lds
    buffer_load_dwordx4 v4, s[8:11], s45 offen offset:3072 lds
    s_waitcnt vmcnt(0)
    s_barrier
    ds_read_b128 a[192:195], v10 offset:8192
    ds_read_b128 a[196:199], v11 offset:8192
    ds_read_b128 a[200:203], v12 offset:8192
    ds_read_b128 a[204:207], v13 offset:8192
    ds_read_b128 a[208:211], v10 offset:12288
    ds_read_b128 a[212:215], v11 offset:12288
    ds_read_b128 a[216:219], v12 offset:12288
    ds_read_b128 a[220:223], v13 offset:12288
    s_waitcnt lgkmcnt(0)
    v_mfma_f32_16x16x32_bf16 v[96:99], a[192:195], v[32:35], 0
    v_mfma_f32_16x16x32_bf16 v[96:99], a[196:199], v[36:39], v[96:99]
    v_mfma_f32_16x16x32_bf16 v[96:99], a[200:203], v[40:43], v[96:99]
    v_mfma_f32_16x16x32_bf16 v[96:99], a[204:207], v[44:47], v[96:99]
    v_mfma_f32_16x16x32_bf16 v[104:107], a[204:207], v[60:63], 0
    v_mfma_f32_16x16x32_bf16 v[104:107], a[200:203], v[56:59], v[104:107]
    v_mfma_f32_16x16x32_bf16 v[104:107], a[196:199], v[52:55], v[104:107]
    v_mfma_f32_16x16x32_bf16 v[104:107], a[192:195], v[48:51], v[104:107]
    v_mfma_f32_16x16x32_bf16 v[112:115], a[192:195], v[64:67], 0
    v_mfma_f32_16x16x32_bf16 v[112:115], a[196:199], v[68:71], v[112:115]
    v_mfma_f32_16x16x32_bf16 v[112:115], a[200:203], v[72:75], v[112:115]
    v_mfma_f32_16x16x32_bf16 v[112:115], a[204:207], v[76:79], v[112:115]
    v_mfma_f32_16x16x32_bf16 v[120:123], a[204:207], v[92:95], 0
    v_mfma_f32_16x16x32_bf16 v[120:123], a[200:203], v[88:91], v[120:123]
    v_mfma_f32_16x16x32_bf16 v[120:123], a[196:199], v[84:87], v[120:123]
    v_mfma_f32_16x16x32_bf16 v[120:123], a[192:195], v[80:83], v[120:123]
    v_mfma_f32_16x16x32_bf16 v[124:127], a[208:211], v[80:83], 0
    v_mfma_f32_16x16x32_bf16 v[124:127], a[212:215], v[84:87], v[124:127]
    v_mfma_f32_16x16x32_bf16 v[124:127], a[216:219], v[88:91], v[124:127]
    v_mfma_f32_16x16x32_bf16 v[124:127], a[220:223], v[92:95], v[124:127]
    v_mfma_f32_16x16x32_bf16 v[116:119], a[220:223], v[76:79], 0
    v_mfma_f32_16x16x32_bf16 v[116:119], a[216:219], v[72:75], v[116:119]
    v_mfma_f32_16x16x32_bf16 v[116:119], a[212:215], v[68:71], v[116:119]
    v_mfma_f32_16x16x32_bf16 v[116:119], a[208:211], v[64:67], v[116:119]
    v_mfma_f32_16x16x32_bf16 v[108:111], a[208:211], v[48:51], 0
    v_mfma_f32_16x16x32_bf16 v[108:111], a[212:215], v[52:55], v[108:111]
    v_mfma_f32_16x16x32_bf16 v[108:111], a[216:219], v[56:59], v[108:111]
    v_mfma_f32_16x16x32_bf16 v[108:111], a[220:223], v[60:63], v[108:111]
    v_mfma_f32_16x16x32_bf16 v[100:103], a[220:223], v[44:47], 0
    v_mfma_f32_16x16x32_bf16 v[100:103], a[216:219], v[40:43], v[100:103]
    v_mfma_f32_16x16x32_bf16 v[100:103], a[212:215], v[36:39], v[100:103]
    v_mfma_f32_16x16x32_bf16 v[100:103], a[208:211], v[32:35], v[100:103]
    s_nop 7
    v_max3_f32 v176, v176, v96, v97
    v_max3_f32 v176, v176, v98, v99
    v_max3_f32 v176, v176, v100, v101
    v_max3_f32 v176, v176, v102, v103
    v_max3_f32 v178, v178, v104, v105
    v_max3_f32 v178, v178, v106, v107
    v_max3_f32 v178, v178, v108, v109
    v_max3_f32 v178, v178, v110, v111
    v_max3_f32 v180, v180, v112, v113
    v_max3_f32 v180, v180, v114, v115
    v_max3_f32 v180, v180, v116, v117
    v_max3_f32 v180, v180, v118, v119
    v_max3_f32 v182, v182, v120, v121
    v_max3_f32 v182, v182, v122, v123
    v_max3_f32 v182, v182, v124, v125
    v_max3_f32 v182, v182, v126, v127
    ds_read_b128 a[192:195], v10 offset:0
    ds_read_b128 a[196:199], v11 offset:0
    ds_read_b128 a[200:203], v12 offset:0
    ds_read_b128 a[204:207], v13 offset:0
    ds_read_b128 a[208:211], v10 offset:4096
    ds_read_b128 a[212:215], v11 offset:4096
    ds_read_b128 a[216:219], v12 offset:4096
    ds_read_b128 a[220:223], v13 offset:4096
    s_waitcnt lgkmcnt(0)
    v_mfma_f32_16x16x32_bf16 v[96:99], a[192:195], v[32:35], 0
    v_mfma_f32_16x16x32_bf16 v[96:99], a[196:199], v[36:39], v[96:99]
    v_mfma_f32_16x16x32_bf16 v[96:99], a[200:203], v[40:43], v[96:99]
    v_mfma_f32_16x16x32_bf16 v[96:99], a[204:207], v[44:47], v[96:99]
    v_mfma_f32_16x16x32_bf16 v[104:107], a[204:207], v[60:63], 0
    v_mfma_f32_16x16x32_bf16 v[104:107], a[200:203], v[56:59], v[104:107]
    v_mfma_f32_16x16x32_bf16 v[104:107], a[196:199], v[52:55], v[104:107]
    v_mfma_f32_16x16x32_bf16 v[104:107], a[192:195], v[48:51], v[104:107]
    v_mfma_f32_16x16x32_bf16 v[112:115], a[192:195], v[64:67], 0
    v_mfma_f32_16x16x32_bf16 v[112:115], a[196:199], v[68:71], v[112:115]
    v_mfma_f32_16x16x32_bf16 v[112:115], a[200:203], v[72:75], v[112:115]
    v_mfma_f32_16x16x32_bf16 v[112:115], a[204:207], v[76:79], v[112:115]
    v_mfma_f32_16x16x32_bf16 v[120:123], a[204:207], v[92:95], 0
    v_mfma_f32_16x16x32_bf16 v[120:123], a[200:203], v[88:91], v[120:123]
    v_mfma_f32_16x16x32_bf16 v[120:123], a[196:199], v[84:87], v[120:123]
    v_mfma_f32_16x16x32_bf16 v[120:123], a[192:195], v[80:83], v[120:123]
    v_mfma_f32_16x16x32_bf16 v[124:127], a[208:211], v[80:83], 0
    v_mfma_f32_16x16x32_bf16 v[124:127], a[212:215], v[84:87], v[124:127]
    v_mfma_f32_16x16x32_bf16 v[124:127], a[216:219], v[88:91], v[124:127]
    v_mfma_f32_16x16x32_bf16 v[124:127], a[220:223], v[92:95], v[124:127]
    v_mfma_f32_16x16x32_bf16 v[116:119], a[220:223], v[76:79], 0
    v_mfma_f32_16x16x32_bf16 v[116:119], a[216:219], v[72:75], v[116:119]
    v_mfma_f32_16x16x32_bf16 v[116:119], a[212:215], v[68:71], v[116:119]
    v_mfma_f32_16x16x32_bf16 v[116:119], a[208:211], v[64:67], v[116:119]
    v_mfma_f32_16x16x32_bf16 v[108:111], a[208:211], v[48:51], 0
    v_mfma_f32_16x16x32_bf16 v[108:111], a[212:215], v[52:55], v[108:111]
    v_mfma_f32_16x16x32_bf16 v[108:111], a[216:219], v[56:59], v[108:111]
    v_mfma_f32_16x16x32_bf16 v[108:111], a[220:223], v[60:63], v[108:111]
    v_mfma_f32_16x16x32_bf16 v[100:103], a[220:223], v[44:47], 0
    v_mfma_f32_16x16x32_bf16 v[100:103], a[216:219], v[40:43], v[100:103]
    v_mfma_f32_16x16x32_bf16 v[100:103], a[212:215], v[36:39], v[100:103]
    v_mfma_f32_16x16x32_bf16 v[100:103], a[208:211], v[32:35], v[100:103]
    s_nop 7
    v_max3_f32 v176, v176, v96, v97
    v_max3_f32 v176, v176, v98, v99
    v_max3_f32 v176, v176, v100, v101
    v_max3_f32 v176, v176, v102, v103
    v_max3_f32 v178, v178, v104, v105
    v_max3_f32 v178, v178, v106, v107
    v_max3_f32 v178, v178, v108, v109
    v_max3_f32 v178, v178, v110, v111
    v_max3_f32 v180, v180, v112, v113
    v_max3_f32 v180, v180, v114, v115
    v_max3_f32 v180, v180, v116, v117
    v_max3_f32 v180, v180, v118, v119
    v_max3_f32 v182, v182, v120, v121
    v_max3_f32 v182, v182, v122, v123
    v_max3_f32 v182, v182, v124, v125
    v_max3_f32 v182, v182, v126, v127
    s_cmp_eq_u32 s48, 33
    s_cbranch_scc1 L_mdone
    s_add_u32 s48, s48, 1
    s_sub_u32 s45, s45, 16384
    s_and_b32 s45, s45, 0x7ffff
    s_branch L_mloop
L_mdone:
    s_mov_b32 s48, 1
    s_mov_b32 s45, 49152
    ds_read_b128 a[192:195], v10 offset:8192
    ds_read_b128 a[196:199], v11 offset:8192
    ds_read_b128 a[200:203], v12 offset:8192
    ds_read_b128 a[204:207], v13 offset:8192
    ds_read_b128 a[208:211], v10 offset:12288
    ds_read_b128 a[212:215], v11 offset:12288
    ds_read_b128 a[216:219], v12 offset:12288
    ds_read_b128 a[220:223], v13 offset:12288
    s_branch L_redm
L_codeend:
.section .rodata,"a"
.p2align 6
.amdhsa_kernel recurrent_scan__gqa_block_cached__glu_gated_glu__prompt_kernel
  .amdhsa_next_free_vgpr 512
  .amdhsa_next_free_sgpr 102
  .amdhsa_accum_offset 256
  .amdhsa_group_segment_fixed_size 0
  .amdhsa_kernarg_size 96
  .amdhsa_user_sgpr_count 2
  .amdhsa_user_sgpr_kernarg_segment_ptr 1
  .amdhsa_system_sgpr_workgroup_id_x 1
.end_amdhsa_kernel
.text
```
